```python
import torch

def _softmax(x, axis=-1):
    return torch.softmax(x, dim=axis)
def _gelu(x):
    return torch.nn.functional.gelu(x, approximate="tanh")
def _silu(x):
    return torch.nn.functional.silu(x)
def _sigmoid(x):
    return torch.sigmoid(x)
def _layernorm(x, axis=-1, eps=1e-5):
    m = x.mean(dim=axis, keepdim=True)
    v = x.var(dim=axis, keepdim=True, unbiased=False)
    return (x - m) / torch.sqrt(v + eps)
def _scatter_add(tgt, idx, src, axis=0):
    return tgt.clone().index_add_(axis, idx, src)
def _segment_sum(src, seg, n):
    out = torch.zeros((n,) + src.shape[1:], dtype=src.dtype)
    return out.index_add_(0, seg, src)
def _pad(x, pw):
    flat = tuple(v for pair in reversed(pw) for v in pair)
    return torch.nn.functional.pad(x, flat)

kernel_name = 'concat_heads__grouped_kv_mqa__ssm_conv_h3__prompt'

def setup_inputs():

    _w = (lambda a: (lambda t: t.to(torch.bfloat16) if t.is_floating_point() else t)(torch.as_tensor(a)))
    def _A_setup():
        B, S, D, H = 1, 2048, 512, 32
        Dh = D // H
        return {
            "x": _w((lambda *s: torch.randn(*s, dtype=torch.bfloat16) * 0.05)(B, S, D)),
            "wq": _w((lambda *s: torch.randn(*s, dtype=torch.bfloat16) * 0.8)(D, H * Dh)),
            "wk": _w((lambda *s: torch.randn(*s, dtype=torch.bfloat16) * 0.8)(D, Dh)),
            "wv": _w((lambda *s: torch.randn(*s, dtype=torch.bfloat16) * 0.05)(D, Dh)),
            "wo": _w((lambda *s: torch.randn(*s, dtype=torch.bfloat16) * 0.05)(H * Dh, D)),
        }
    _A_in = _A_setup()

    def _B_setup():
        B, S, D = 1, 2048, 512
        ks = 4
        return {
            "q": _w((lambda *s: torch.randn(*s, dtype=torch.bfloat16) * 0.05)(B, S, D)),
            "k": _w((lambda *s: torch.randn(*s, dtype=torch.bfloat16) * 0.2)(B, S, D)),
            "v": _w((lambda *s: torch.randn(*s, dtype=torch.bfloat16) * 0.2)(B, S, D)),
            "shift_k": _w((lambda *s: torch.randn(*s, dtype=torch.bfloat16) * 0.2)(D, ks) * 0.5),
            "ssm_k": _w((lambda *s: torch.randn(*s, dtype=torch.bfloat16) * 0.4)(D, S) * (1.0 / S ** 0.5)),
            "ssm_D": _w((lambda *s: torch.randn(*s, dtype=torch.bfloat16) * 0.2)(D)),
        }
    _B_in = _B_setup()

    return {
        "A_x": _A_in["x"],
        "A_wq": _A_in["wq"],
        "A_wk": _A_in["wk"],
        "A_wv": _A_in["wv"],
        "A_wo": _A_in["wo"],
        "B_q": _B_in["q"],
        "B_k": _B_in["k"],
        "B_v": _B_in["v"],
        "B_shift_k": _B_in["shift_k"],
        "B_ssm_k": _B_in["ssm_k"],
        "B_ssm_D": _B_in["ssm_D"],
    }

def reference(A_x, A_wq, A_wk, A_wv, A_wo, B_q, B_k, B_v, B_shift_k, B_ssm_k, B_ssm_D):
    def _A_ref(x, wq, wk, wv, wo):
        B, S, D = x.shape
        H = 32
        Dh = D // H
        q = (lambda x, *d: x.permute(*d))((x @ wq).reshape(B, S, H, Dh), 0, 2, 1, 3)
        k = x @ wk
        v = x @ wv
        scores = torch.einsum("bhqd,bkd->bhqk", q, k) * (Dh ** -0.5)
        p = _softmax(scores, axis=-1)
        o = torch.einsum("bhqk,bkd->bhqd", p, v)
        return (lambda x, *d: x.permute(*d))(o, 0, 2, 1, 3).reshape(B, S, H * Dh) @ wo

    def _B_ref(q, k, v, shift_k, ssm_k, ssm_D):
        B, S, D = q.shape
        ks = shift_k.shape[-1]
        k_pad = _pad(k, ((0, 0), (ks - 1, 0), (0, 0)))
        k_shift = torch.zeros_like(k)
        for t in range(ks):
            k_shift = k_shift + k_pad[:, t:t + S, :] * shift_k[:, ks - 1 - t][None, None, :]
        kv = k_shift * v
        L = 2 * S
        kv_pad = _pad(kv, ((0, 0), (0, S), (0, 0)))
        kf_pad = _pad(ssm_k, ((0, 0), (0, S)))
        kv_f = (lambda x, axes=(-2,-1): torch.fft.rfft2(x.float(), dim=axes))(kv_pad[:, None, :, :], axes=(1, 2))
        kf_f = (lambda x, axes=(-2,-1): torch.fft.rfft2(x.float(), dim=axes))(kf_pad[:, None, :], axes=(1, 2))
        kf_f = (lambda x, *d: x.permute(*d))(kf_f, 1, 2, 0)
        y_f = kv_f * kf_f[None, :, :, :]
        y = (lambda x, s, axes=(-2,-1): torch.fft.irfft2(x, s=s, dim=axes).to(torch.bfloat16))(y_f, (1, L), axes=(1, 2))[:, 0, :S, :]
        y = y + kv * ssm_D[None, None, :]
        return q * y

    a = _A_ref(A_x, A_wq, A_wk, A_wv, A_wo)
    b = _B_ref(B_q, B_k, B_v, B_shift_k, B_ssm_k, B_ssm_D)
    return torch.concatenate([a, b], axis=-1)
```

```asm
; @launch kernel=concat_heads__grouped_kv_mqa__ssm_conv_h3__prompt_kernel grid=(256,1,1) block=(512,1,1) lds=160000
.amdgcn_target "amdgcn-amd-amdhsa--gfx950"
.text
.globl concat_heads__grouped_kv_mqa__ssm_conv_h3__prompt_kernel
.p2align 8
.type concat_heads__grouped_kv_mqa__ssm_conv_h3__prompt_kernel,@function
concat_heads__grouped_kv_mqa__ssm_conv_h3__prompt_kernel:
    s_cmp_ge_u32 s2, 256
    s_cbranch_scc1 K_END
    s_load_dwordx2 s[16:17], s[0:1], 104
    s_load_dwordx2 s[64:65], s[0:1], 0
    v_lshrrev_b32 v1, 6, v0
    v_and_b32 v6, 63, v0
    v_readfirstlane_b32 s3, v1
    s_and_b32 s32, s2, 7
    s_lshr_b32 s33, s2, 3
    s_lshl_b32 s32, s32, 5
    s_add_u32 s32, s32, s33
    s_mov_b32 s18, 52428800
    s_mov_b32 s19, 0x20000
    s_lshr_b32 s60, s32, 3
    s_and_b32 s61, s32, 7
    s_cmp_lt_u32 s3, 4
    s_cbranch_scc1 K_ATT
    s_load_dwordx2 s[84:85], s[0:1], 8
    s_load_dwordx2 s[68:69], s[0:1], 32
    s_load_dwordx2 s[24:25], s[0:1], 40
    s_load_dwordx2 s[72:73], s[0:1], 48
    s_load_dwordx2 s[76:77], s[0:1], 56
    s_load_dwordx2 s[80:81], s[0:1], 64
    s_load_dwordx4 s[4:7], s[0:1], 72
    s_load_dwordx2 s[28:29], s[0:1], 88
    s_mov_b32 s59, s33
    s_sub_u32 s33, s3, 4
    v_lshlrev_b32 v0, 4, v6
    s_lshr_b32 s58, s32, 5
    s_movk_i32 s47, 4096
    s_and_b32 s94, s59, 7
    s_lshl_b32 s95, s58, 2
    s_lshr_b32 s44, s59, 3
    s_add_u32 s95, s95, s44
    s_lshl_b32 s44, s95, 2
    s_add_u32 s44, s44, s33
    s_lshl_b32 s44, s44, 14
    s_lshl_b32 s45, s94, 7
    s_add_u32 s45, s45, s44
    v_lshrrev_b32 v251, 3, v6
    v_and_b32 v252, 7, v6
    v_lshl_add_u32 v246, v251, 10, s45
    v_lshl_add_u32 v246, v252, 4, v246
    v_subrev_u32 v247, 8192, v246
    s_lshl_b32 s44, s94, 2
    s_add_u32 s44, s44, s33
    v_and_b32 v251, 15, v6
    v_lshrrev_b32 v252, 4, v6
    s_lshl_b32 s45, s44, 7
    v_lshl_add_u32 v248, v251, 3, s45
    s_mul_i32 s44, s44, 67584
    s_lshl_b32 s45, s95, 7
    s_sub_u32 s44, s44, s45
    s_add_u32 s44, s44, 2772984
    v_mul_u32_u24 v249, 16896, v252
    v_lshlrev_b32 v253, 3, v251
    v_sub_u32 v249, v249, v253
    v_add_u32 v249, s44, v249
    s_lshl_b32 s44, s33, 5
    s_add_u32 s44, s44, 58112
    v_and_b32 v255, 16, v6
    v_lshrrev_b32 v252, 5, v6
    v_lshl_add_u32 v250, v251, 9, s44
    v_and_b32 v253, 0x70, v253
    v_lshl_add_u32 v255, v252, 7, v255
    v_and_b32 v251, 1, v6
    v_add3_u32 v250, v250, v253, v255
    v_or_b32 v252, v252, v251
    v_lshl_add_u32 v253, v251, 4, v250
    v_lshl_add_u32 v254, v252, 4, v250
    s_mul_i32 s94, s33, 2080
    s_add_u32 s94, s94, 58512
    v_and_b32 v251, 3, v6
    v_lshlrev_b32 v251, 8, v251
    v_add_u32 v251, 147456, v251
    v_mov_b32 v252, 1
    s_lshr_b32 s44, s2, 5
    s_lshl_b32 s44, s44, 3
    s_and_b32 s45, s2, 7
    s_add_u32 s44, s44, s45
    s_lshl_b32 s44, s44, 13
    s_bfe_u32 s45, s2, 0x20003
    s_lshl_b32 s45, s45, 8
    s_add_u32 s44, s44, s45
    v_lshl_add_u32 v136, v6, 2, s44
    s_lshr_b32 s44, s2, 3
    s_lshl_b32 s44, s44, 14
    s_and_b32 s45, s2, 7
    s_lshl_b32 s45, s45, 8
    s_add_u32 s44, s44, s45
    s_add_u32 s44, s44, 2228224
    v_and_b32 v174, 3, v6
    v_lshl_add_u32 v174, v174, 12, s44
    v_lshrrev_b32 v175, 2, v6
    v_lshl_add_u32 v137, v175, 4, v174
    s_bfe_u32 s44, s2, 0x20003
    s_lshl_b32 s44, s44, 3
    s_lshr_b32 s45, s2, 5
    s_add_u32 s44, s44, s45
    s_lshl_b32 s44, s44, 7
    s_and_b32 s45, s2, 7
    s_lshl_b32 s45, s45, 2
    s_add_u32 s44, s44, s45
    s_add_u32 s88, s44, 2760704
    s_lshr_b32 s36, s33, 1
    s_and_b32 s37, s33, 1
    s_mul_i32 s35, s36, 24960
    s_add_u32 s35, s35, 8192
    s_lshl_b32 s38, s32, 1
    s_add_u32 s38, s38, s36
    s_lshl_b32 s39, s38, 12
    s_lshl_b32 s44, s37, 10
    s_sub_u32 s42, s35, s44
    s_add_u32 s42, s42, 1024
    v_lshrrev_b32 v174, 4, v6
    v_and_b32 v175, 15, v6
    v_xor_b32 v175, v175, v174
    s_lshl_b32 s44, s60, 16
    v_lshl_add_u32 v176, v174, 10, s44
    s_and_b32 s51, s61, 6
    s_lshl_b32 s93, s33, 12
    s_mul_i32 s89, s33, 3
    s_lshl_b32 s51, s51, 1
    s_add_u32 s44, s89, 4
    s_and_b32 s45, s44, 3
    s_lshl_b32 s45, s45, 2
    s_add_u32 s44, s44, s51
    s_and_b32 s44, s44, 15
    s_lshl_b32 s44, s44, 12
    v_xor_b32 v177, s45, v175
    v_lshl_add_u32 v128, v177, 4, v176
    v_add_u32 v128, s44, v128
    s_add_u32 s44, s89, 5
    s_and_b32 s45, s44, 3
    s_lshl_b32 s45, s45, 2
    s_add_u32 s44, s44, s51
    s_and_b32 s44, s44, 15
    s_lshl_b32 s44, s44, 12
    v_xor_b32 v177, s45, v175
    v_lshl_add_u32 v129, v177, 4, v176
    v_add_u32 v129, s44, v129
    s_add_u32 s44, s89, 6
    s_and_b32 s45, s44, 3
    s_lshl_b32 s45, s45, 2
    s_add_u32 s44, s44, s51
    s_and_b32 s44, s44, 15
    s_lshl_b32 s44, s44, 12
    v_xor_b32 v177, s45, v175
    v_lshl_add_u32 v130, v177, 4, v176
    v_add_u32 v130, s44, v130
    s_lshl_b32 s89, s89, 10
    v_lshrrev_b32 v177, 3, v6
    v_and_b32 v178, 7, v6
    v_and_b32 v174, 1, v174
    v_lshlrev_b32 v174, 2, v174
    v_xor_b32 v178, v178, v174
    s_lshl_b32 s44, s33, 15
    s_lshl_b32 s45, s61, 7
    s_add_u32 s44, s44, s45
    v_lshlrev_b32 v177, 10, v177
    v_lshl_add_u32 v177, v178, 4, v177
    v_add_u32 v131, s44, v177
    v_add_u32 v132, 7168, v131
    v_add_u32 v133, 14336, v131
    v_add_u32 v134, 21504, v131
    s_mov_b32 s62, 0xffff0000
    v_lshlrev_b32 v9, 2, v6
    v_mov_b64 v[60:61], 0
    v_mov_b64 v[62:63], 0
    s_lshl_b32 s34, s33, 8
    s_add_u32 s34, s34, 147456
    v_add_u32 v1, s34, v9
    v_add_u32 v8, 148480, v9
    ds_write_b32 v1, v60
    ds_write_b32 v8, v60
    s_mov_b32 s52, 0xbf800000
    s_mov_b32 s56, 200000
    v_mov_b32 v22, s52
    v_mov_b32 v23, s52
    v_mov_b32 v24, s52
    v_mov_b32 v25, s52
    s_lshl_b32 s44, s33, 11
    v_add_u32 v26, s44, v0
    s_waitcnt lgkmcnt(0)
    s_mov_b32 s66, 2097152
    s_mov_b32 s67, 0x20000
    s_mov_b32 s86, 524288
    s_mov_b32 s87, 0x20000
    s_cmp_eq_u32 s3, 6
    s_cbranch_scc0 H_W1
    s_movk_i32 s45, 4096
    s_mov_b32 s70, 524288
    s_mov_b32 s71, 0x20000
    buffer_load_dword v140, v136, s[68:71], 0 offen offset:0
    buffer_load_dword v141, v136, s[68:71], 0 offen offset:1024
    buffer_load_dword v142, v136, s[68:71], 0 offen offset:2048
    buffer_load_dword v143, v136, s[68:71], 0 offen offset:3072
    buffer_load_dword v144, v136, s[68:71], s45 offen offset:0
    buffer_load_dword v145, v136, s[68:71], s45 offen offset:1024
    buffer_load_dword v146, v136, s[68:71], s45 offen offset:2048
    buffer_load_dword v147, v136, s[68:71], s45 offen offset:3072
    buffer_load_dword v138, off, s[16:19], s88 sc1
H_W1:
    v_lshrrev_b32 v191, 3, v6
    v_and_b32 v190, 7, v6
    v_lshlrev_b32 v191, 7, v191
    v_lshl_add_u32 v191, v190, 2, v191
    s_lshl_b32 s44, s33, 10
    s_add_u32 s44, s44, 2760704
    v_add_u32 v191, s44, v191
    buffer_load_dword v189, v191, s[16:19], 0 offen sc1
    s_mov_b32 s82, 4096
    s_mov_b32 s83, 0x20000
    buffer_load_dwordx2 v[212:213], v248, s[80:83], 0 offen
    s_add_u32 m0, s93, 16384
    s_mov_b32 s45, 0
    buffer_load_dwordx4 v131, s[84:87], s45 offen offset:0 lds
    buffer_load_dwordx4 v132, s[84:87], s45 offen offset:1024 lds
    buffer_load_dwordx4 v133, s[84:87], s45 offen offset:2048 lds
    buffer_load_dwordx4 v134, s[84:87], s45 offen offset:3072 lds
    s_add_u32 m0, s89, 4096
    s_movk_i32 s44, 0
    buffer_load_dwordx4 v128, s[64:67], s44 offen lds
    s_add_u32 m0, s89, 5120
    s_movk_i32 s44, 0
    buffer_load_dwordx4 v129, s[64:67], s44 offen lds
    s_add_u32 m0, s89, 6144
    s_movk_i32 s44, 0
    buffer_load_dwordx4 v130, s[64:67], s44 offen lds
    s_add_u32 m0, s93, 53248
    s_mov_b32 s45, 131072
    buffer_load_dwordx4 v131, s[84:87], s45 offen offset:0 lds
    buffer_load_dwordx4 v132, s[84:87], s45 offen offset:1024 lds
    buffer_load_dwordx4 v133, s[84:87], s45 offen offset:2048 lds
    buffer_load_dwordx4 v134, s[84:87], s45 offen offset:3072 lds
    s_add_u32 m0, s89, 40960
    s_movk_i32 s44, 256
    buffer_load_dwordx4 v128, s[64:67], s44 offen lds
    s_add_u32 m0, s89, 41984
    s_movk_i32 s44, 256
    buffer_load_dwordx4 v129, s[64:67], s44 offen lds
    s_add_u32 m0, s89, 43008
    s_movk_i32 s44, 256
    buffer_load_dwordx4 v130, s[64:67], s44 offen lds
    s_add_u32 m0, s93, 90112
    s_mov_b32 s45, 262144
    buffer_load_dwordx4 v131, s[84:87], s45 offen offset:0 lds
    buffer_load_dwordx4 v132, s[84:87], s45 offen offset:1024 lds
    buffer_load_dwordx4 v133, s[84:87], s45 offen offset:2048 lds
    buffer_load_dwordx4 v134, s[84:87], s45 offen offset:3072 lds
    s_add_u32 m0, s89, 77824
    s_movk_i32 s44, 512
    buffer_load_dwordx4 v128, s[64:67], s44 offen lds
    s_add_u32 m0, s89, 78848
    s_movk_i32 s44, 512
    buffer_load_dwordx4 v129, s[64:67], s44 offen lds
    s_add_u32 m0, s89, 79872
    s_movk_i32 s44, 512
    buffer_load_dwordx4 v130, s[64:67], s44 offen lds
    s_waitcnt vmcnt(14)
    s_waitcnt lgkmcnt(0)
    s_barrier
    s_add_u32 m0, s93, 126976
    s_mov_b32 s45, 393216
    buffer_load_dwordx4 v131, s[84:87], s45 offen offset:0 lds
    buffer_load_dwordx4 v132, s[84:87], s45 offen offset:1024 lds
    buffer_load_dwordx4 v133, s[84:87], s45 offen offset:2048 lds
    buffer_load_dwordx4 v134, s[84:87], s45 offen offset:3072 lds
    s_add_u32 m0, s89, 114688
    s_movk_i32 s44, 768
    buffer_load_dwordx4 v128, s[64:67], s44 offen lds
    s_add_u32 m0, s89, 115712
    s_movk_i32 s44, 768
    buffer_load_dwordx4 v129, s[64:67], s44 offen lds
    s_add_u32 m0, s89, 116736
    s_movk_i32 s44, 768
    buffer_load_dwordx4 v130, s[64:67], s44 offen lds
    s_lshl_b32 s44, s32, 2
    s_load_dword s40, s[4:5], s39
    s_load_dword s41, s[6:7], s44
    s_waitcnt vmcnt(14)
    s_barrier
    s_waitcnt vmcnt(7)
    s_barrier
    ds_write_b128 v26, v[22:25]
    ds_write_b128 v26, v[22:25] offset:1024
    s_waitcnt vmcnt(0)
    s_barrier
    v_mov_b32 v240, 0x0c0c0100
    s_mov_b32 exec_hi, 0
    v_mov_b32 v240, 0x0c0c0302
    s_mov_b32 exec_hi, -1
    s_movk_i32 s44, 0x3f80
    v_alignbit_b32 v240, v240, v240, v0
    v_perm_b32 v243, 1.0, 1.0, v240
    v_perm_b32 v244, s44, s44, v240
    v_perm_b32 v241, v213, v213, v240
    v_perm_b32 v242, v212, v212, v240
    s_mov_b32 vcc_lo, 0x3000003
    s_mov_b32 vcc_hi, 0x3000003
    v_cndmask_b32 v224, 0, v241, vcc
    v_cndmask_b32 v228, 0, v242, vcc
    v_cndmask_b32 v232, 0, v243, vcc
    v_cndmask_b32 v236, 0, v244, vcc
    s_mov_b32 vcc_lo, 0xc00000c
    s_mov_b32 vcc_hi, 0xc00000c
    v_cndmask_b32 v225, 0, v241, vcc
    v_cndmask_b32 v229, 0, v242, vcc
    v_cndmask_b32 v233, 0, v243, vcc
    v_cndmask_b32 v237, 0, v244, vcc
    s_mov_b32 vcc_lo, 0x30000030
    s_mov_b32 vcc_hi, 0x30000030
    v_cndmask_b32 v226, 0, v241, vcc
    v_cndmask_b32 v230, 0, v242, vcc
    v_cndmask_b32 v234, 0, v243, vcc
    v_cndmask_b32 v238, 0, v244, vcc
    s_mov_b32 vcc_lo, 0xc00000c0
    s_mov_b32 vcc_hi, 0xc00000c0
    v_cndmask_b32 v227, 0, v241, vcc
    v_cndmask_b32 v231, 0, v242, vcc
    v_cndmask_b32 v235, 0, v243, vcc
    v_cndmask_b32 v239, 0, v244, vcc
    s_waitcnt lgkmcnt(0)
    s_barrier
    s_branch H_GO
K_ATT:
    s_load_dwordx4 s[8:11], s[0:1], 16
    v_lshlrev_b32 v0, 4, v6
    s_getpc_b64 s[28:29]
K_PC:
    s_sub_u32 s28, s28, K_PC-concat_heads__grouped_kv_mqa__ssm_conv_h3__prompt_kernel
    s_subb_u32 s29, s29, 0
    s_lshr_b32 s30, s2, 3
    s_lshl_b32 s30, s30, 2
    s_add_u32 s30, s30, s3
    s_lshl_b32 s30, s30, 10
    v_lshl_add_u32 v16, v6, 4, s30
    v_min_u32 v16, K_CEND-concat_heads__grouped_kv_mqa__ssm_conv_h3__prompt_kernel-16, v16
    global_load_dwordx4 v[92:95], v16, s[28:29]
    v_lshrrev_b32 v16, 4, v6
    v_and_b32 v17, 15, v6
    v_xor_b32 v18, v17, v16
    s_lshl_b32 s28, s60, 16
    s_and_b32 s29, s61, 6
    s_lshl_b32 s29, s29, 13
    s_add_u32 s28, s28, s29
    s_lshl_b32 s29, s3, 8
    s_add_u32 s28, s28, s29
    v_lshl_add_u32 v20, v16, 10, s28
    s_mul_i32 s31, s3, 36864
    v_lshl_add_u32 v17, v17, 8, s31
    v_xor_b32 v19, 0, v18
    v_lshl_add_u32 v24, v19, 4, v20
    v_lshl_add_u32 v28, v19, 4, v17
    v_xor_b32 v19, 4, v18
    v_lshl_add_u32 v25, v19, 4, v20
    v_lshl_add_u32 v29, v19, 4, v17
    v_add_u32 v25, 3072, v25
    v_xor_b32 v19, 8, v18
    v_lshl_add_u32 v26, v19, 4, v20
    v_lshl_add_u32 v30, v19, 4, v17
    v_add_u32 v26, 6144, v26
    v_xor_b32 v19, 12, v18
    v_lshl_add_u32 v27, v19, 4, v20
    v_lshl_add_u32 v31, v19, 4, v17
    v_add_u32 v27, 9216, v27
    s_lshl_b32 s35, s3, 3
    s_mul_i32 s33, s33, 1
    s_add_u32 s35, s35, s33
    v_lshrrev_b32 v16, 3, v6
    v_add_u32 v16, s35, v16
    v_and_b32 v16, 31, v16
    v_and_b32 v17, 7, v6
    v_lshlrev_b32 v17, 2, v17
    v_lshl_add_u32 v14, v16, 7, v17
    v_add_u32 v14, 2752512, v14
    s_cmp_eq_u32 s3, 3
    s_cbranch_scc0 A_C1
    v_add_u32 v22, 156928, v0
    v_mov_b64 v[116:117], -1
    v_mov_b64 v[118:119], -1
    ds_write_b128 v22, v[116:119]
    ds_write_b128 v22, v[116:119] offset:1024
    ds_write_b128 v22, v[116:119] offset:2048
A_C1:
    s_waitcnt lgkmcnt(0)
    buffer_load_dword v12, v14, s[16:19], 0 offen sc1
    s_mov_b32 s66, 2097152
    s_mov_b32 s67, 0x20000
    s_mov_b32 m0, s31
    s_bitcmp0_b32 s61, 0
    s_cselect_b32 s96, s8, s10
    s_cselect_b32 s97, s9, s11
    s_mov_b32 s98, 16384
    s_mov_b32 s99, 0x20000
    buffer_load_dwordx4 v24, s[64:67], 0 offen offset:0 lds
    buffer_load_dwordx4 v25, s[64:67], 0 offen offset:1024 lds
    buffer_load_dwordx4 v26, s[64:67], 0 offen offset:2048 lds
    buffer_load_dwordx4 v27, s[64:67], 0 offen offset:3072 lds
    s_add_u32 m0, s31, 32768
    s_lshl_b32 s28, s3, 12
    buffer_load_dwordx4 v0, s[96:99], s28 offen offset:0 lds
    buffer_load_dwordx4 v0, s[96:99], s28 offen offset:1024 lds
    buffer_load_dwordx4 v0, s[96:99], s28 offen offset:2048 lds
    buffer_load_dwordx4 v0, s[96:99], s28 offen offset:3072 lds
    v_mov_b64 v[116:117], -1
    v_mov_b64 v[118:119], -1
    v_lshrrev_b32 v16, 4, v6
    v_bfe_u32 v17, v6, 2, 2
    v_lshl_add_u32 v17, v16, 3, v17
    v_lshl_add_u32 v17, v17, 5, s31
    v_and_b32 v19, 3, v6
    v_lshl_add_u32 v20, v19, 3, v17
    s_lshl_b32 s28, s3, 10
    s_cmp_eq_u32 s3, 3
    s_cselect_b32 s28, 0, s28
    s_add_u32 s28, s28, 156928
    v_add_u32 v22, s28, v0
    s_and_b32 s28, s61, 4
    s_lshl_b32 s28, s28, 8
    s_and_b32 s29, s61, 2
    s_lshl_b32 s29, s29, 7
    s_add_u32 s28, s28, s29
    s_and_b32 s29, s61, 6
    s_lshl_b32 s29, s29, 8
    s_add_u32 s29, s29, 65536
    s_bitcmp0_b32 s61, 0
    s_cselect_b32 s28, s28, s29
    s_cselect_b32 s29, 9, 7
    s_cselect_b32 s100, -1, 0xffff
    s_cselect_b32 s101, 0, 0xffff
    s_lshl_b32 s30, s60, 11
    s_add_u32 s28, s28, s30
    s_add_u32 s28, s28, 2097152
    v_lshrrev_b32 v16, 4, v6
    v_and_b32 v21, 15, v6
    v_lshlrev_b32 v16, s29, v16
    v_lshl_add_u32 v21, v21, 4, s28
    v_add_u32 v21, v21, v16
    s_lshl_b32 s28, s60, 7
    s_lshl_b32 s29, s61, 2
    s_add_u32 s28, s28, s29
    s_add_u32 s93, s28, 2752512
    s_and_b32 s35, s35, 31
    s_lshl_b32 s35, s35, 11
    s_add_u32 s36, s35, 2097152
    s_lshl_b32 s34, s32, 13
    s_lshl_b32 s46, s3, 11
    s_add_u32 s52, s34, s46
    s_add_u32 s54, s52, 4931584
    s_lshl_b32 s29, s32, 1
    s_lshr_b32 s30, s3, 1
    s_add_u32 s29, s29, s30
    s_mul_i32 s29, s29, 4224
    s_and_b32 s30, s46, 2048
    s_add_u32 s29, s29, s30
    s_add_u32 s53, s29, 2768896
    s_cmp_eq_u32 s3, 3
    s_cbranch_scc0 A_C3
    buffer_load_dword v15, off, s[16:19], s93 sc1
    s_mov_b64 exec, s[100:101]
    buffer_store_dwordx4 v[116:119], v21, s[16:19], 0 offen sc1
    s_mov_b64 exec, -1
A_C3:
    s_and_b32 s28, s3, 1
    s_lshr_b32 s29, s3, 1
    v_lshrrev_b32 v16, 5, v6
    v_bfe_u32 v17, v6, 2, 2
    v_lshl_add_u32 v18, v16, 6, v17
    v_lshlrev_b32 v18, 7, v18
    v_lshrrev_b32 v19, 1, v17
    v_xor_b32 v19, s28, v19
    v_lshl_add_u32 v18, v19, 6, v18
    v_bfe_u32 v19, v6, 4, 1
    v_lshl_add_u32 v18, v19, 5, v18
    v_and_b32 v19, 3, v6
    v_lshl_add_u32 v8, v19, 3, v18
    v_add_u32 v9, 73728, v8
    v_and_b32 v17, 31, v6
    s_lshl_b32 s28, s29, 13
    v_lshlrev_b32 v18, 8, v17
    v_add_u32 v18, s28, v18
    v_and_b32 v17, 15, v6
    v_lshlrev_b32 v19, 3, v16
    v_xor_b32 v17, v17, v19
    v_xor_b32 v19, 0, v17
    v_lshl_add_u32 v96, v19, 4, v18
    v_add_u32 v104, 73728, v96
    v_xor_b32 v19, 1, v17
    v_lshl_add_u32 v97, v19, 4, v18
    v_add_u32 v105, 73728, v97
    v_xor_b32 v19, 2, v17
    v_lshl_add_u32 v98, v19, 4, v18
    v_add_u32 v106, 73728, v98
    v_xor_b32 v19, 3, v17
    v_lshl_add_u32 v99, v19, 4, v18
    v_add_u32 v107, 73728, v99
    v_xor_b32 v19, 4, v17
    v_lshl_add_u32 v100, v19, 4, v18
    v_add_u32 v108, 73728, v100
    v_xor_b32 v19, 5, v17
    v_lshl_add_u32 v101, v19, 4, v18
    v_add_u32 v109, 73728, v101
    v_xor_b32 v19, 6, v17
    v_lshl_add_u32 v102, v19, 4, v18
    v_add_u32 v110, 73728, v102
    v_xor_b32 v19, 7, v17
    v_lshl_add_u32 v103, v19, 4, v18
    v_add_u32 v111, 73728, v103
    s_lshl_b32 s29, s29, 2
    s_and_b32 s30, s61, 1
    s_sub_u32 s29, s29, s30
    s_add_u32 s29, s29, 7
    s_and_b32 s30, s3, 1
    s_lshl_b32 s30, s30, 8
    s_add_u32 s30, s30, 148736
    v_bfe_u32 v17, v6, 3, 2
    v_add_u32 v17, s29, v17
    v_and_b32 v17, 7, v17
    v_lshl_add_u32 v18, v16, 9, s30
    v_and_b32 v19, 7, v6
    v_lshl_add_u32 v18, v19, 4, v18
    v_lshl_add_u32 v10, v17, 10, v18
    s_add_u32 s37, s36, 2048
    s_and_b32 s37, s37, 0x20ffff
    s_add_u32 s38, s37, 2048
    s_and_b32 s38, s38, 0x20ffff
    s_add_u32 s39, s38, 2048
    s_and_b32 s39, s39, 0x20ffff
    s_add_u32 s40, s39, 2048
    s_and_b32 s40, s40, 0x20ffff
    s_add_u32 s41, s40, 2048
    s_and_b32 s41, s41, 0x20ffff
    s_add_u32 s42, s41, 2048
    s_and_b32 s42, s42, 0x20ffff
    s_add_u32 s43, s42, 2048
    s_and_b32 s43, s43, 0x20ffff
    v_lshrrev_b32 v18, 5, v6
    v_and_b32 v19, 15, v6
    v_lshl_add_u32 v19, v18, 4, v19
    v_lshlrev_b32 v7, 4, v19
    v_add_u32 v7, 65536, v7
    s_mov_b32 s44, 0x0000ffff
    s_mov_b32 s45, 0x0000ffff
    v_bfe_u32 v16, v6, 3, 2
    v_and_b32 v17, 7, v6
    v_lshl_add_u32 v17, v16, 4, v17
    v_lshl_add_u32 v17, v18, 3, v17
    s_add_u32 s48, s46, 75776
    v_lshl_add_u32 v1, v17, 4, s48
    s_lshl_b32 s46, s3, 8
    v_lshl_add_u32 v3, v17, 2, s46
    v_mov_b32 v2, 0xdddddddd
    v_mov_b32 v4, 0
    v_mov_b32 v5, 0
    v_and_b32 v16, 27, v6
    v_cmp_eq_u32 vcc, 16, v16
    v_mov_b32 v17, 0x3f803f80
    v_cndmask_b32 v16, 0, v17, vcc
    v_cndmask_b32 v17, 0, v17, vcc
    s_movk_i32 s49, 300
    s_cmp_eq_u32 s3, 3
    s_cbranch_scc1 A_C2
    s_waitcnt vmcnt(0)
A_C2:
    s_waitcnt vmcnt(2)
    ds_read_b64_tr_b16 v[32:33], v20 offset:32768
    ds_read_b64_tr_b16 v[34:35], v20 offset:32896
    ds_read_b128 v[36:39], v28
    ds_read_b64_tr_b16 v[40:41], v20 offset:33792
    ds_read_b64_tr_b16 v[42:43], v20 offset:33920
    ds_read_b128 v[44:47], v29
    ds_read_b64_tr_b16 v[48:49], v20 offset:34816
    ds_read_b64_tr_b16 v[50:51], v20 offset:34944
    ds_read_b128 v[52:55], v30
    ds_read_b64_tr_b16 v[56:57], v20 offset:35840
    ds_read_b64_tr_b16 v[58:59], v20 offset:35968
    ds_read_b128 v[60:63], v31
    s_bitcmp0_b32 s61, 0
    s_cbranch_scc0 KCV
KCK:
    s_waitcnt lgkmcnt(9)
    v_mfma_f32_16x16x32_bf16 v[24:27], v[32:35], v[36:39], 0
    s_waitcnt lgkmcnt(6)
    v_mfma_f32_16x16x32_bf16 v[24:27], v[40:43], v[44:47], v[24:27]
    s_waitcnt lgkmcnt(3)
    v_mfma_f32_16x16x32_bf16 v[24:27], v[48:51], v[52:55], v[24:27]
    s_waitcnt lgkmcnt(0)
    v_mfma_f32_16x16x32_bf16 v[24:27], v[56:59], v[60:63], v[24:27]
    s_branch KCM
KCV:
    s_waitcnt lgkmcnt(9)
    v_mfma_f32_16x16x32_bf16 v[24:27], v[36:39], v[32:35], 0
    s_waitcnt lgkmcnt(6)
    v_mfma_f32_16x16x32_bf16 v[24:27], v[44:47], v[40:43], v[24:27]
    s_waitcnt lgkmcnt(3)
    v_mfma_f32_16x16x32_bf16 v[24:27], v[52:55], v[48:51], v[24:27]
    s_waitcnt lgkmcnt(0)
    v_mfma_f32_16x16x32_bf16 v[24:27], v[60:63], v[56:59], v[24:27]
KCM:
    s_cmp_eq_u32 s3, 3
    s_cbranch_scc1 KCR
    s_nop 5
    ds_write_b128 v22, v[24:27]
    s_branch KCD
KCR:
    s_waitcnt vmcnt(0)
    v_add_u32 v15, 1, v15
    s_mov_b64 exec, 1
    buffer_store_dword v15, off, s[16:19], s93 sc1
    s_mov_b64 exec, -1
    s_movk_i32 s28, 2000
KCP:
    ds_read_b128 v[32:35], v22 offset:0
    ds_read_b128 v[36:39], v22 offset:1024
    ds_read_b128 v[40:43], v22 offset:2048
    s_sub_u32 s28, s28, 1
    s_cbranch_scc1 KCD
    s_waitcnt lgkmcnt(0)
    v_max3_u32 v19, v32, v36, v40
    v_cmp_eq_u32 vcc, -1, v19
    s_cbranch_vccnz KCP
    v_pk_add_f32 v[32:33], v[32:33], v[36:37]
    v_pk_add_f32 v[34:35], v[34:35], v[38:39]
    v_pk_add_f32 v[24:25], v[24:25], v[40:41]
    v_pk_add_f32 v[26:27], v[26:27], v[42:43]
    v_pk_add_f32 v[24:25], v[24:25], v[32:33]
    v_pk_add_f32 v[26:27], v[26:27], v[34:35]
    s_bitcmp0_b32 s61, 0
    v_cvt_pk_bf16_f32 v44, v24, v25
    v_cvt_pk_bf16_f32 v45, v26, v27
    v_cvt_pk_bf16_f32 v46, v24, v25
    v_cvt_pk_bf16_f32 v47, v26, v27
    s_cbranch_scc0 KCSV
    s_nop 0
    v_permlane32_swap_b32 v44, v46
    v_permlane32_swap_b32 v45, v47
    s_branch KCST
KCSV:
    s_nop 0
    v_permlane16_swap_b32 v44, v46
    v_permlane16_swap_b32 v45, v47
KCST:
    s_mov_b64 exec, s[100:101]
    buffer_store_dwordx4 v[44:47], v21, s[16:19], 0 offen sc1
    s_mov_b64 exec, -1
KCD:
    v_mov_b64 v[128:129], v[16:17]
    v_mov_b64 v[130:131], v[16:17]
    v_mov_b64 v[132:133], v[16:17]
    v_mov_b64 v[134:135], v[16:17]
    v_mov_b64 v[136:137], v[16:17]
    v_mov_b64 v[138:139], v[16:17]
    v_mov_b64 v[140:141], v[16:17]
    v_mov_b64 v[142:143], v[16:17]
    v_mov_b64 v[144:145], v[16:17]
    v_mov_b64 v[146:147], v[16:17]
    v_mov_b64 v[148:149], v[16:17]
    v_mov_b64 v[150:151], v[16:17]
    v_mov_b64 v[152:153], v[16:17]
    v_mov_b64 v[154:155], v[16:17]
    v_mov_b64 v[156:157], v[16:17]
    v_mov_b64 v[158:159], v[16:17]
    v_mov_b64 v[160:161], v[16:17]
    v_mov_b64 v[162:163], v[16:17]
    v_mov_b64 v[164:165], v[16:17]
    v_mov_b64 v[166:167], v[16:17]
    v_mov_b64 v[168:169], v[16:17]
    v_mov_b64 v[170:171], v[16:17]
    v_mov_b64 v[172:173], v[16:17]
    v_mov_b64 v[174:175], v[16:17]
    v_mov_b64 v[176:177], v[16:17]
    v_mov_b64 v[178:179], v[16:17]
    v_mov_b64 v[180:181], v[16:17]
    v_mov_b64 v[182:183], v[16:17]
    v_mov_b64 v[184:185], v[16:17]
    v_mov_b64 v[186:187], v[16:17]
    v_mov_b64 v[188:189], v[16:17]
    v_mov_b64 v[190:191], v[16:17]
    v_mov_b64 v[192:193], v[16:17]
    v_mov_b64 v[194:195], v[16:17]
    v_mov_b64 v[196:197], v[16:17]
    v_mov_b64 v[198:199], v[16:17]
    v_mov_b64 v[200:201], v[16:17]
    v_mov_b64 v[202:203], v[16:17]
    v_mov_b64 v[204:205], v[16:17]
    v_mov_b64 v[206:207], v[16:17]
    v_mov_b64 v[208:209], v[16:17]
    v_mov_b64 v[210:211], v[16:17]
    v_mov_b64 v[212:213], v[16:17]
    v_mov_b64 v[214:215], v[16:17]
    v_mov_b64 v[216:217], v[16:17]
    v_mov_b64 v[218:219], v[16:17]
    v_mov_b64 v[220:221], v[16:17]
    v_mov_b64 v[222:223], v[16:17]
    v_mov_b64 v[224:225], v[16:17]
    v_mov_b64 v[226:227], v[16:17]
    v_mov_b64 v[228:229], v[16:17]
    v_mov_b64 v[230:231], v[16:17]
    v_mov_b64 v[232:233], v[16:17]
    v_mov_b64 v[234:235], v[16:17]
    v_mov_b64 v[236:237], v[16:17]
    v_mov_b64 v[238:239], v[16:17]
    v_mov_b64 v[240:241], v[16:17]
    v_mov_b64 v[242:243], v[16:17]
    v_mov_b64 v[244:245], v[16:17]
    v_mov_b64 v[246:247], v[16:17]
    v_mov_b64 v[248:249], v[16:17]
    v_mov_b64 v[250:251], v[16:17]
    v_mov_b64 v[252:253], v[16:17]
    v_mov_b64 v[254:255], v[16:17]
    s_barrier
    ds_read_b64_tr_b16 v[32:33], v8 offset:16384
    ds_read_b64_tr_b16 v[34:35], v8 offset:16896
    ds_read_b128 v[36:39], v96 offset:0
    ds_read_b64_tr_b16 v[40:41], v8 offset:17408
    ds_read_b64_tr_b16 v[42:43], v8 offset:17920
    ds_read_b128 v[44:47], v97 offset:0
    ds_read_b64_tr_b16 v[48:49], v8 offset:18432
    ds_read_b64_tr_b16 v[50:51], v8 offset:18944
    ds_read_b128 v[52:55], v98 offset:0
    ds_read_b64_tr_b16 v[56:57], v8 offset:19456
    ds_read_b64_tr_b16 v[58:59], v8 offset:19968
    ds_read_b128 v[60:63], v99 offset:0
    ds_read_b64_tr_b16 v[112:113], v8 offset:20480
    ds_read_b64_tr_b16 v[114:115], v8 offset:20992
    ds_read_b128 v[116:119], v100 offset:0
    s_waitcnt lgkmcnt(12)
    v_mfma_f32_32x32x16_bf16 v[16:31], v[32:35], v[36:39], 0
    ds_read_b64_tr_b16 v[120:121], v8 offset:21504
    ds_read_b64_tr_b16 v[122:123], v8 offset:22016
    ds_read_b128 v[124:127], v101 offset:0
    s_waitcnt lgkmcnt(12)
    v_mfma_f32_32x32x16_bf16 v[16:31], v[40:43], v[44:47], v[16:31]
    ds_read_b64_tr_b16 v[32:33], v8 offset:22528
    ds_read_b64_tr_b16 v[34:35], v8 offset:23040
    ds_read_b128 v[36:39], v102 offset:0
    s_waitcnt lgkmcnt(12)
    v_mfma_f32_32x32x16_bf16 v[16:31], v[48:51], v[52:55], v[16:31]
    ds_read_b64_tr_b16 v[40:41], v8 offset:23552
    ds_read_b64_tr_b16 v[42:43], v8 offset:24064
    ds_read_b128 v[44:47], v103 offset:0
    s_waitcnt lgkmcnt(12)
    v_mfma_f32_32x32x16_bf16 v[16:31], v[56:59], v[60:63], v[16:31]
    s_waitcnt lgkmcnt(9)
    v_mfma_f32_32x32x16_bf16 v[16:31], v[112:115], v[116:119], v[16:31]
    s_barrier
    buffer_load_dword v13, v14, s[16:19], 0 offen sc1
    ds_read_b64_tr_b16 v[48:49], v8 offset:53248
    ds_read_b64_tr_b16 v[50:51], v8 offset:53760
    ds_read_b128 v[52:55], v96 offset:36864
    ds_read_b64_tr_b16 v[56:57], v8 offset:54272
    ds_read_b64_tr_b16 v[58:59], v8 offset:54784
    ds_read_b128 v[60:63], v97 offset:36864
    s_waitcnt lgkmcnt(12)
    v_mfma_f32_32x32x16_bf16 v[16:31], v[120:123], v[124:127], v[16:31]
    ds_read_b64_tr_b16 v[112:113], v8 offset:55296
    ds_read_b64_tr_b16 v[114:115], v8 offset:55808
    ds_read_b128 v[116:119], v98 offset:36864
    s_waitcnt lgkmcnt(12)
    v_mfma_f32_32x32x16_bf16 v[16:31], v[32:35], v[36:39], v[16:31]
    ds_read_b64_tr_b16 v[120:121], v8 offset:56320
    ds_read_b64_tr_b16 v[122:123], v8 offset:56832
    ds_read_b128 v[124:127], v99 offset:36864
    s_waitcnt lgkmcnt(12)
    v_mfma_f32_32x32x16_bf16 v[16:31], v[40:43], v[44:47], v[16:31]
    ds_read_b64_tr_b16 v[32:33], v8 offset:57344
    ds_read_b64_tr_b16 v[34:35], v8 offset:57856
    ds_read_b128 v[36:39], v100 offset:36864
    s_waitcnt lgkmcnt(12)
    v_mfma_f32_32x32x16_bf16 v[16:31], v[48:51], v[52:55], v[16:31]
    ds_read_b64_tr_b16 v[40:41], v8 offset:58368
    ds_read_b64_tr_b16 v[42:43], v8 offset:58880
    ds_read_b128 v[44:47], v101 offset:36864
    s_waitcnt lgkmcnt(12)
    v_mfma_f32_32x32x16_bf16 v[16:31], v[56:59], v[60:63], v[16:31]
    ds_read_b64_tr_b16 v[48:49], v8 offset:59392
    ds_read_b64_tr_b16 v[50:51], v8 offset:59904
    ds_read_b128 v[52:55], v102 offset:36864
    s_waitcnt lgkmcnt(12)
    v_mfma_f32_32x32x16_bf16 v[16:31], v[112:115], v[116:119], v[16:31]
    ds_read_b64_tr_b16 v[56:57], v8 offset:60416
    ds_read_b64_tr_b16 v[58:59], v8 offset:60928
    ds_read_b128 v[60:63], v103 offset:36864
    s_waitcnt lgkmcnt(12)
    v_mfma_f32_32x32x16_bf16 v[16:31], v[120:123], v[124:127], v[16:31]
    s_waitcnt lgkmcnt(9)
    v_mfma_f32_32x32x16_bf16 v[16:31], v[32:35], v[36:39], v[16:31]
    s_barrier
    ds_read_b64_tr_b16 v[112:113], v9 offset:16384
    ds_read_b64_tr_b16 v[114:115], v9 offset:16896
    ds_read_b128 v[116:119], v104 offset:0
    ds_read_b64_tr_b16 v[120:121], v9 offset:17408
    ds_read_b64_tr_b16 v[122:123], v9 offset:17920
    ds_read_b128 v[124:127], v105 offset:0
    s_waitcnt lgkmcnt(12)
    v_mfma_f32_32x32x16_bf16 v[16:31], v[40:43], v[44:47], v[16:31]
    ds_read_b64_tr_b16 v[32:33], v9 offset:18432
    ds_read_b64_tr_b16 v[34:35], v9 offset:18944
    ds_read_b128 v[36:39], v106 offset:0
    s_waitcnt lgkmcnt(12)
    v_mfma_f32_32x32x16_bf16 v[16:31], v[48:51], v[52:55], v[16:31]
    ds_read_b64_tr_b16 v[40:41], v9 offset:19456
    ds_read_b64_tr_b16 v[42:43], v9 offset:19968
    ds_read_b128 v[44:47], v107 offset:0
    s_waitcnt lgkmcnt(12)
    v_mfma_f32_32x32x16_bf16 v[16:31], v[56:59], v[60:63], v[16:31]
    ds_read_b64_tr_b16 v[48:49], v9 offset:20480
    ds_read_b64_tr_b16 v[50:51], v9 offset:20992
    ds_read_b128 v[52:55], v108 offset:0
    s_waitcnt lgkmcnt(12)
    v_mfma_f32_32x32x16_bf16 v[16:31], v[112:115], v[116:119], v[16:31]
    ds_read_b64_tr_b16 v[56:57], v9 offset:21504
    ds_read_b64_tr_b16 v[58:59], v9 offset:22016
    ds_read_b128 v[60:63], v109 offset:0
    s_waitcnt lgkmcnt(12)
    v_mfma_f32_32x32x16_bf16 v[16:31], v[120:123], v[124:127], v[16:31]
    ds_read_b64_tr_b16 v[112:113], v9 offset:22528
    ds_read_b64_tr_b16 v[114:115], v9 offset:23040
    ds_read_b128 v[116:119], v110 offset:0
    s_waitcnt lgkmcnt(12)
    v_mfma_f32_32x32x16_bf16 v[16:31], v[32:35], v[36:39], v[16:31]
    ds_read_b64_tr_b16 v[120:121], v9 offset:23552
    ds_read_b64_tr_b16 v[122:123], v9 offset:24064
    ds_read_b128 v[124:127], v111 offset:0
    s_waitcnt lgkmcnt(12)
    v_mfma_f32_32x32x16_bf16 v[16:31], v[40:43], v[44:47], v[16:31]
    s_waitcnt lgkmcnt(9)
    v_mfma_f32_32x32x16_bf16 v[16:31], v[48:51], v[52:55], v[16:31]
    s_barrier
    ds_read_b64_tr_b16 v[32:33], v9 offset:53248
    ds_read_b64_tr_b16 v[34:35], v9 offset:53760
    ds_read_b128 v[36:39], v104 offset:36864
    ds_read_b64_tr_b16 v[40:41], v9 offset:54272
    ds_read_b64_tr_b16 v[42:43], v9 offset:54784
    ds_read_b128 v[44:47], v105 offset:36864
    s_waitcnt lgkmcnt(12)
    v_mfma_f32_32x32x16_bf16 v[16:31], v[56:59], v[60:63], v[16:31]
    ds_read_b64_tr_b16 v[48:49], v9 offset:55296
    ds_read_b64_tr_b16 v[50:51], v9 offset:55808
    ds_read_b128 v[52:55], v106 offset:36864
    s_waitcnt lgkmcnt(12)
    v_mfma_f32_32x32x16_bf16 v[16:31], v[112:115], v[116:119], v[16:31]
    ds_read_b64_tr_b16 v[56:57], v9 offset:56320
    ds_read_b64_tr_b16 v[58:59], v9 offset:56832
    ds_read_b128 v[60:63], v107 offset:36864
    s_waitcnt lgkmcnt(12)
    v_mfma_f32_32x32x16_bf16 v[16:31], v[120:123], v[124:127], v[16:31]
    ds_read_b64_tr_b16 v[112:113], v9 offset:57344
    ds_read_b64_tr_b16 v[114:115], v9 offset:57856
    ds_read_b128 v[116:119], v108 offset:36864
    s_waitcnt lgkmcnt(12)
    v_mfma_f32_32x32x16_bf16 v[16:31], v[32:35], v[36:39], v[16:31]
    ds_read_b64_tr_b16 v[120:121], v9 offset:58368
    ds_read_b64_tr_b16 v[122:123], v9 offset:58880
    ds_read_b128 v[124:127], v109 offset:36864
    s_waitcnt lgkmcnt(12)
    v_mfma_f32_32x32x16_bf16 v[16:31], v[40:43], v[44:47], v[16:31]
    ds_read_b64_tr_b16 v[32:33], v9 offset:59392
    ds_read_b64_tr_b16 v[34:35], v9 offset:59904
    ds_read_b128 v[36:39], v110 offset:36864
    s_waitcnt lgkmcnt(12)
    v_mfma_f32_32x32x16_bf16 v[16:31], v[48:51], v[52:55], v[16:31]
    ds_read_b64_tr_b16 v[40:41], v9 offset:60416
    ds_read_b64_tr_b16 v[42:43], v9 offset:60928
    ds_read_b128 v[44:47], v111 offset:36864
    s_waitcnt lgkmcnt(12)
    v_mfma_f32_32x32x16_bf16 v[16:31], v[56:59], v[60:63], v[16:31]
    s_waitcnt lgkmcnt(9)
    v_mfma_f32_32x32x16_bf16 v[16:31], v[112:115], v[116:119], v[16:31]
    s_waitcnt vmcnt(0)
    v_cmp_eq_u32 vcc, v13, v12
    s_cbranch_vccnz ASLOW
AOK:
    buffer_load_dwordx4 v[64:67], v0, s[16:19], s36 offen offset:0 sc1
    buffer_load_dwordx4 v[68:71], v0, s[16:19], s36 offen offset:1024 sc1
    s_mov_b64 exec, s[44:45]
    buffer_load_dwordx4 v[128:131], v7, s[16:19], s36 offen offset:0 sc1
    buffer_load_dwordx4 v[132:135], v7, s[16:19], s36 offen offset:512 sc1
    buffer_load_dwordx4 v[136:139], v7, s[16:19], s36 offen offset:1024 sc1
    buffer_load_dwordx4 v[140:143], v7, s[16:19], s36 offen offset:1536 sc1
    s_mov_b64 exec, -1
    s_waitcnt lgkmcnt(6)
    v_mfma_f32_32x32x16_bf16 v[16:31], v[120:123], v[124:127], v[16:31]
    buffer_load_dwordx4 v[72:75], v0, s[16:19], s37 offen offset:0 sc1
    buffer_load_dwordx4 v[76:79], v0, s[16:19], s37 offen offset:1024 sc1
    s_mov_b64 exec, s[44:45]
    buffer_load_dwordx4 v[144:147], v7, s[16:19], s37 offen offset:0 sc1
    buffer_load_dwordx4 v[148:151], v7, s[16:19], s37 offen offset:512 sc1
    buffer_load_dwordx4 v[152:155], v7, s[16:19], s37 offen offset:1024 sc1
    buffer_load_dwordx4 v[156:159], v7, s[16:19], s37 offen offset:1536 sc1
    s_mov_b64 exec, -1
    s_waitcnt lgkmcnt(3)
    v_mfma_f32_32x32x16_bf16 v[16:31], v[32:35], v[36:39], v[16:31]
    buffer_load_dwordx4 v[80:83], v0, s[16:19], s38 offen offset:0 sc1
    buffer_load_dwordx4 v[84:87], v0, s[16:19], s38 offen offset:1024 sc1
    s_mov_b64 exec, s[44:45]
    buffer_load_dwordx4 v[160:163], v7, s[16:19], s38 offen offset:0 sc1
    buffer_load_dwordx4 v[164:167], v7, s[16:19], s38 offen offset:512 sc1
    buffer_load_dwordx4 v[168:171], v7, s[16:19], s38 offen offset:1024 sc1
    buffer_load_dwordx4 v[172:175], v7, s[16:19], s38 offen offset:1536 sc1
    s_mov_b64 exec, -1
    s_waitcnt lgkmcnt(0)
    v_mfma_f32_32x32x16_bf16 v[16:31], v[40:43], v[44:47], v[16:31]
    s_mov_b32 s28, 0x3eb8aa3b
    s_mov_b32 s29, 0x3eb8aa3b
    s_nop 7
    s_nop 2
    v_pk_mul_f32 v[16:17], v[16:17], s[28:29]
    v_pk_mul_f32 v[18:19], v[18:19], s[28:29]
    v_pk_mul_f32 v[20:21], v[20:21], s[28:29]
    v_pk_mul_f32 v[22:23], v[22:23], s[28:29]
    v_cvt_pk_bf16_f32 v32, v16, v17
    v_cvt_pk_bf16_f32 v33, v18, v19
    v_cvt_pk_bf16_f32 v34, v20, v21
    v_cvt_pk_bf16_f32 v35, v22, v23
    ds_write_b128 v10, v[32:35] offset:0
    v_pk_mul_f32 v[24:25], v[24:25], s[28:29]
    v_pk_mul_f32 v[26:27], v[26:27], s[28:29]
    v_pk_mul_f32 v[28:29], v[28:29], s[28:29]
    v_pk_mul_f32 v[30:31], v[30:31], s[28:29]
    v_cvt_pk_bf16_f32 v36, v24, v25
    v_cvt_pk_bf16_f32 v37, v26, v27
    v_cvt_pk_bf16_f32 v38, v28, v29
    v_cvt_pk_bf16_f32 v39, v30, v31
    ds_write_b128 v10, v[36:39] offset:128
    v_mov_b64 v[16:17], -1
    v_mov_b64 v[18:19], -1
    buffer_store_dwordx4 v[16:19], v0, s[16:19], s52 offen offset:0 sc1
    buffer_store_dwordx4 v[16:19], v0, s[16:19], s52 offen offset:1024 sc1
    buffer_store_dwordx4 v[16:19], v0, s[16:19], s53 offen offset:0 sc1
    buffer_store_dwordx4 v[16:19], v0, s[16:19], s53 offen offset:1024 sc1
    v_add_u32 v20, 148736, v0
    s_waitcnt lgkmcnt(0)
    s_barrier
    ds_read_b128 v[8:11], v20
    s_cmp_eq_u32 s3, 3
    s_cbranch_scc0 FLIP1
    v_add_u32 v15, 1, v15
    s_mov_b64 exec, 1
    buffer_store_dword v15, off, s[16:19], s93 sc1
    s_mov_b64 exec, -1
FLIP1:
    v_add_u32 v15, 148736, v0
    s_waitcnt vmcnt(16)
    v_max3_u32 v12, v64, v68, v128
    v_max3_u32 v13, v132, v136, v140
    v_max_u32 v12, v12, v13
    v_cmp_eq_u32 vcc, -1, v12
    s_cbranch_vccnz GR0
GOK0:
    s_waitcnt lgkmcnt(0)
    v_mfma_f32_32x32x16_bf16 v[16:31], v[64:67], v[8:11], 0
    v_mfma_f32_32x32x8_bf16 v[48:63], v[4:5], v[4:5], 0
    s_nop 7
    s_nop 2
    s_setprio 1
    v_exp_f32 v16, v16
    v_exp_f32 v17, v17
    v_exp_f32 v18, v18
    v_exp_f32 v19, v19
    v_exp_f32 v20, v20
    v_mfma_f32_32x32x16_bf16 v[32:47], v[68:71], v[8:11], 0
    v_exp_f32 v21, v21
    v_exp_f32 v22, v22
    v_exp_f32 v23, v23
    v_exp_f32 v24, v24
    v_exp_f32 v25, v25
    v_exp_f32 v26, v26
    v_exp_f32 v27, v27
    v_exp_f32 v28, v28
    v_exp_f32 v29, v29
    v_exp_f32 v30, v30
    v_smfmac_f32_32x32x32_bf16 v[48:63], v[128:131], v[16:23], v2
    v_exp_f32 v31, v31
    buffer_load_dwordx4 v[88:91], v0, s[16:19], s39 offen offset:0 sc1
    buffer_load_dwordx4 v[92:95], v0, s[16:19], s39 offen offset:1024 sc1
    s_mov_b64 exec, s[44:45]
    buffer_load_dwordx4 v[176:179], v7, s[16:19], s39 offen offset:0 sc1
    buffer_load_dwordx4 v[180:183], v7, s[16:19], s39 offen offset:512 sc1
    buffer_load_dwordx4 v[184:187], v7, s[16:19], s39 offen offset:1024 sc1
    buffer_load_dwordx4 v[188:191], v7, s[16:19], s39 offen offset:1536 sc1
    s_mov_b64 exec, -1
    v_exp_f32 v32, v32
    v_exp_f32 v33, v33
    v_smfmac_f32_32x32x32_bf16 v[48:63], v[132:135], v[24:31], v2
    v_exp_f32 v34, v34
    v_exp_f32 v35, v35
    v_exp_f32 v36, v36
    s_waitcnt vmcnt(16)
    v_max3_u32 v12, v72, v76, v144
    v_max3_u32 v13, v148, v152, v156
    v_max_u32 v12, v12, v13
    v_cmp_eq_u32 vcc, -1, v12
    s_cbranch_vccnz GR1
GOK1:
    v_mfma_f32_32x32x16_bf16 v[16:31], v[72:75], v[8:11], 0
    v_exp_f32 v37, v37
    v_exp_f32 v38, v38
    v_exp_f32 v39, v39
    v_exp_f32 v40, v40
    v_exp_f32 v41, v41
    v_exp_f32 v42, v42
    v_exp_f32 v43, v43
    v_exp_f32 v44, v44
    v_exp_f32 v45, v45
    v_exp_f32 v46, v46
    v_smfmac_f32_32x32x32_bf16 v[48:63], v[136:139], v[32:39], v2
    v_exp_f32 v47, v47
    v_exp_f32 v16, v16
    v_exp_f32 v17, v17
    v_smfmac_f32_32x32x32_bf16 v[48:63], v[140:143], v[40:47], v2
    v_exp_f32 v18, v18
    v_exp_f32 v19, v19
    v_exp_f32 v20, v20
    v_mfma_f32_32x32x16_bf16 v[32:47], v[76:79], v[8:11], 0
    v_exp_f32 v21, v21
    v_exp_f32 v22, v22
    v_exp_f32 v23, v23
    v_exp_f32 v24, v24
    v_exp_f32 v25, v25
    v_exp_f32 v26, v26
    v_exp_f32 v27, v27
    v_exp_f32 v28, v28
    v_exp_f32 v29, v29
    v_exp_f32 v30, v30
    v_smfmac_f32_32x32x32_bf16 v[48:63], v[144:147], v[16:23], v2
    v_exp_f32 v31, v31
    buffer_load_dwordx4 v[96:99], v0, s[16:19], s40 offen offset:0 sc1
    buffer_load_dwordx4 v[100:103], v0, s[16:19], s40 offen offset:1024 sc1
    s_mov_b64 exec, s[44:45]
    buffer_load_dwordx4 v[192:195], v7, s[16:19], s40 offen offset:0 sc1
    buffer_load_dwordx4 v[196:199], v7, s[16:19], s40 offen offset:512 sc1
    buffer_load_dwordx4 v[200:203], v7, s[16:19], s40 offen offset:1024 sc1
    buffer_load_dwordx4 v[204:207], v7, s[16:19], s40 offen offset:1536 sc1
    s_mov_b64 exec, -1
    v_exp_f32 v32, v32
    v_exp_f32 v33, v33
    v_smfmac_f32_32x32x32_bf16 v[48:63], v[148:151], v[24:31], v2
    v_exp_f32 v34, v34
    v_exp_f32 v35, v35
    v_exp_f32 v36, v36
    s_waitcnt vmcnt(16)
    v_max3_u32 v12, v80, v84, v160
    v_max3_u32 v13, v164, v168, v172
    v_max_u32 v12, v12, v13
    v_cmp_eq_u32 vcc, -1, v12
    s_cbranch_vccnz GR2
GOK2:
    v_mfma_f32_32x32x16_bf16 v[16:31], v[80:83], v[8:11], 0
    v_exp_f32 v37, v37
    v_exp_f32 v38, v38
    v_exp_f32 v39, v39
    v_exp_f32 v40, v40
    v_exp_f32 v41, v41
    v_exp_f32 v42, v42
    v_exp_f32 v43, v43
    v_exp_f32 v44, v44
    v_exp_f32 v45, v45
    v_exp_f32 v46, v46
    v_smfmac_f32_32x32x32_bf16 v[48:63], v[152:155], v[32:39], v2
    v_exp_f32 v47, v47
    v_exp_f32 v16, v16
    v_exp_f32 v17, v17
    v_smfmac_f32_32x32x32_bf16 v[48:63], v[156:159], v[40:47], v2
    v_exp_f32 v18, v18
    v_exp_f32 v19, v19
    v_exp_f32 v20, v20
    v_mfma_f32_32x32x16_bf16 v[32:47], v[84:87], v[8:11], 0
    v_exp_f32 v21, v21
    v_exp_f32 v22, v22
    v_exp_f32 v23, v23
    v_exp_f32 v24, v24
    v_exp_f32 v25, v25
    v_exp_f32 v26, v26
    v_exp_f32 v27, v27
    v_exp_f32 v28, v28
    v_exp_f32 v29, v29
    v_exp_f32 v30, v30
    v_smfmac_f32_32x32x32_bf16 v[48:63], v[160:163], v[16:23], v2
    v_exp_f32 v31, v31
    buffer_load_dwordx4 v[104:107], v0, s[16:19], s41 offen offset:0 sc1
    buffer_load_dwordx4 v[108:111], v0, s[16:19], s41 offen offset:1024 sc1
    s_mov_b64 exec, s[44:45]
    buffer_load_dwordx4 v[208:211], v7, s[16:19], s41 offen offset:0 sc1
    buffer_load_dwordx4 v[212:215], v7, s[16:19], s41 offen offset:512 sc1
    buffer_load_dwordx4 v[216:219], v7, s[16:19], s41 offen offset:1024 sc1
    buffer_load_dwordx4 v[220:223], v7, s[16:19], s41 offen offset:1536 sc1
    s_mov_b64 exec, -1
    v_exp_f32 v32, v32
    v_exp_f32 v33, v33
    v_smfmac_f32_32x32x32_bf16 v[48:63], v[164:167], v[24:31], v2
    v_exp_f32 v34, v34
    v_exp_f32 v35, v35
    v_exp_f32 v36, v36
    s_waitcnt vmcnt(12)
    v_max3_u32 v12, v88, v92, v176
    v_max3_u32 v13, v180, v184, v188
    v_max_u32 v12, v12, v13
    v_cmp_eq_u32 vcc, -1, v12
    s_cbranch_vccnz GR3
GOK3:
    v_mfma_f32_32x32x16_bf16 v[16:31], v[88:91], v[8:11], 0
    v_exp_f32 v37, v37
    v_exp_f32 v38, v38
    v_exp_f32 v39, v39
    v_exp_f32 v40, v40
    v_exp_f32 v41, v41
    v_exp_f32 v42, v42
    v_exp_f32 v43, v43
    v_exp_f32 v44, v44
    v_exp_f32 v45, v45
    v_exp_f32 v46, v46
    v_smfmac_f32_32x32x32_bf16 v[48:63], v[168:171], v[32:39], v2
    v_exp_f32 v47, v47
    v_exp_f32 v16, v16
    v_exp_f32 v17, v17
    v_smfmac_f32_32x32x32_bf16 v[48:63], v[172:175], v[40:47], v2
    v_exp_f32 v18, v18
    v_exp_f32 v19, v19
    v_exp_f32 v20, v20
    v_mfma_f32_32x32x16_bf16 v[32:47], v[92:95], v[8:11], 0
    v_exp_f32 v21, v21
    v_exp_f32 v22, v22
    v_exp_f32 v23, v23
    v_exp_f32 v24, v24
    v_exp_f32 v25, v25
    v_exp_f32 v26, v26
    v_exp_f32 v27, v27
    v_exp_f32 v28, v28
    v_exp_f32 v29, v29
    v_exp_f32 v30, v30
    v_smfmac_f32_32x32x32_bf16 v[48:63], v[176:179], v[16:23], v2
    v_exp_f32 v31, v31
    buffer_load_dwordx4 v[112:115], v0, s[16:19], s42 offen offset:0 sc1
    buffer_load_dwordx4 v[116:119], v0, s[16:19], s42 offen offset:1024 sc1
    s_mov_b64 exec, s[44:45]
    buffer_load_dwordx4 v[224:227], v7, s[16:19], s42 offen offset:0 sc1
    buffer_load_dwordx4 v[228:231], v7, s[16:19], s42 offen offset:512 sc1
    buffer_load_dwordx4 v[232:235], v7, s[16:19], s42 offen offset:1024 sc1
    buffer_load_dwordx4 v[236:239], v7, s[16:19], s42 offen offset:1536 sc1
    s_mov_b64 exec, -1
    v_exp_f32 v32, v32
    v_exp_f32 v33, v33
    v_smfmac_f32_32x32x32_bf16 v[48:63], v[180:183], v[24:31], v2
    v_exp_f32 v34, v34
    v_exp_f32 v35, v35
    v_exp_f32 v36, v36
    s_waitcnt vmcnt(12)
    v_max3_u32 v12, v96, v100, v192
    v_max3_u32 v13, v196, v200, v204
    v_max_u32 v12, v12, v13
    v_cmp_eq_u32 vcc, -1, v12
    s_cbranch_vccnz GR4
GOK4:
    v_mfma_f32_32x32x16_bf16 v[16:31], v[96:99], v[8:11], 0
    v_exp_f32 v37, v37
    v_exp_f32 v38, v38
    v_exp_f32 v39, v39
    v_exp_f32 v40, v40
    v_exp_f32 v41, v41
    v_exp_f32 v42, v42
    v_exp_f32 v43, v43
    v_exp_f32 v44, v44
    v_exp_f32 v45, v45
    v_exp_f32 v46, v46
    v_smfmac_f32_32x32x32_bf16 v[48:63], v[184:187], v[32:39], v2
    v_exp_f32 v47, v47
    v_exp_f32 v16, v16
    v_exp_f32 v17, v17
    v_smfmac_f32_32x32x32_bf16 v[48:63], v[188:191], v[40:47], v2
    v_exp_f32 v18, v18
    v_exp_f32 v19, v19
    v_exp_f32 v20, v20
    v_mfma_f32_32x32x16_bf16 v[32:47], v[100:103], v[8:11], 0
    v_exp_f32 v21, v21
    v_exp_f32 v22, v22
    v_exp_f32 v23, v23
    v_exp_f32 v24, v24
    v_exp_f32 v25, v25
    v_exp_f32 v26, v26
    v_exp_f32 v27, v27
    v_exp_f32 v28, v28
    v_exp_f32 v29, v29
    v_exp_f32 v30, v30
    v_smfmac_f32_32x32x32_bf16 v[48:63], v[192:195], v[16:23], v2
    v_exp_f32 v31, v31
    buffer_load_dwordx4 v[120:123], v0, s[16:19], s43 offen offset:0 sc1
    buffer_load_dwordx4 v[124:127], v0, s[16:19], s43 offen offset:1024 sc1
    s_mov_b64 exec, s[44:45]
    buffer_load_dwordx4 v[240:243], v7, s[16:19], s43 offen offset:0 sc1
    buffer_load_dwordx4 v[244:247], v7, s[16:19], s43 offen offset:512 sc1
    buffer_load_dwordx4 v[248:251], v7, s[16:19], s43 offen offset:1024 sc1
    buffer_load_dwordx4 v[252:255], v7, s[16:19], s43 offen offset:1536 sc1
    s_mov_b64 exec, -1
    ds_write_b32 v3, v2 offset:7168
    v_exp_f32 v32, v32
    v_exp_f32 v33, v33
    v_smfmac_f32_32x32x32_bf16 v[48:63], v[196:199], v[24:31], v2
    v_exp_f32 v34, v34
    v_exp_f32 v35, v35
    v_exp_f32 v36, v36
    s_waitcnt vmcnt(12)
    v_max3_u32 v12, v104, v108, v208
    v_max3_u32 v13, v212, v216, v220
    v_max_u32 v12, v12, v13
    v_cmp_eq_u32 vcc, -1, v12
    s_cbranch_vccnz GR5
GOK5:
    v_mfma_f32_32x32x16_bf16 v[16:31], v[104:107], v[8:11], 0
    v_exp_f32 v37, v37
    v_exp_f32 v38, v38
    v_exp_f32 v39, v39
    v_exp_f32 v40, v40
    v_exp_f32 v41, v41
    v_exp_f32 v42, v42
    v_exp_f32 v43, v43
    v_exp_f32 v44, v44
    v_exp_f32 v45, v45
    v_exp_f32 v46, v46
    v_smfmac_f32_32x32x32_bf16 v[48:63], v[200:203], v[32:39], v2
    v_exp_f32 v47, v47
    v_exp_f32 v16, v16
    v_exp_f32 v17, v17
    v_smfmac_f32_32x32x32_bf16 v[48:63], v[204:207], v[40:47], v2
    v_exp_f32 v18, v18
    v_exp_f32 v19, v19
    v_exp_f32 v20, v20
    v_mfma_f32_32x32x16_bf16 v[32:47], v[108:111], v[8:11], 0
    v_exp_f32 v21, v21
    v_exp_f32 v22, v22
    v_exp_f32 v23, v23
    v_exp_f32 v24, v24
    v_exp_f32 v25, v25
    v_exp_f32 v26, v26
    v_exp_f32 v27, v27
    v_exp_f32 v28, v28
    v_exp_f32 v29, v29
    v_exp_f32 v30, v30
    v_smfmac_f32_32x32x32_bf16 v[48:63], v[208:211], v[16:23], v2
    v_exp_f32 v31, v31
    v_exp_f32 v32, v32
    v_exp_f32 v33, v33
    v_smfmac_f32_32x32x32_bf16 v[48:63], v[212:215], v[24:31], v2
    v_exp_f32 v34, v34
    v_exp_f32 v35, v35
    v_exp_f32 v36, v36
    s_waitcnt vmcnt(6)
    v_max3_u32 v12, v112, v116, v224
    v_max3_u32 v13, v228, v232, v236
    v_max_u32 v12, v12, v13
    v_cmp_eq_u32 vcc, -1, v12
    s_cbranch_vccnz GR6
GOK6:
    v_mfma_f32_32x32x16_bf16 v[16:31], v[112:115], v[8:11], 0
    v_exp_f32 v37, v37
    v_exp_f32 v38, v38
    v_exp_f32 v39, v39
    v_exp_f32 v40, v40
    v_exp_f32 v41, v41
    v_exp_f32 v42, v42
    v_exp_f32 v43, v43
    v_exp_f32 v44, v44
    v_exp_f32 v45, v45
    v_exp_f32 v46, v46
    v_smfmac_f32_32x32x32_bf16 v[48:63], v[216:219], v[32:39], v2
    v_exp_f32 v47, v47
    v_exp_f32 v16, v16
    v_exp_f32 v17, v17
    v_smfmac_f32_32x32x32_bf16 v[48:63], v[220:223], v[40:47], v2
    v_exp_f32 v18, v18
    v_exp_f32 v19, v19
    v_exp_f32 v20, v20
    v_mfma_f32_32x32x16_bf16 v[32:47], v[116:119], v[8:11], 0
    v_exp_f32 v21, v21
    v_exp_f32 v22, v22
    v_exp_f32 v23, v23
    v_exp_f32 v24, v24
    v_exp_f32 v25, v25
    v_exp_f32 v26, v26
    v_exp_f32 v27, v27
    v_exp_f32 v28, v28
    v_exp_f32 v29, v29
    v_exp_f32 v30, v30
    v_smfmac_f32_32x32x32_bf16 v[48:63], v[224:227], v[16:23], v2
    v_exp_f32 v31, v31
    v_exp_f32 v32, v32
    v_exp_f32 v33, v33
    v_smfmac_f32_32x32x32_bf16 v[48:63], v[228:231], v[24:31], v2
    v_exp_f32 v34, v34
    v_exp_f32 v35, v35
    v_exp_f32 v36, v36
    s_waitcnt vmcnt(0)
    v_max3_u32 v12, v120, v124, v240
    v_max3_u32 v13, v244, v248, v252
    v_max_u32 v12, v12, v13
    v_cmp_eq_u32 vcc, -1, v12
    s_cbranch_vccnz GR7
GOK7:
    v_mfma_f32_32x32x16_bf16 v[16:31], v[120:123], v[8:11], 0
    v_exp_f32 v37, v37
    v_exp_f32 v38, v38
    v_exp_f32 v39, v39
    v_exp_f32 v40, v40
    v_exp_f32 v41, v41
    v_exp_f32 v42, v42
    v_exp_f32 v43, v43
    v_exp_f32 v44, v44
    v_exp_f32 v45, v45
    v_exp_f32 v46, v46
    v_smfmac_f32_32x32x32_bf16 v[48:63], v[232:235], v[32:39], v2
    v_exp_f32 v47, v47
    v_exp_f32 v16, v16
    v_exp_f32 v17, v17
    v_smfmac_f32_32x32x32_bf16 v[48:63], v[236:239], v[40:47], v2
    v_exp_f32 v18, v18
    v_exp_f32 v19, v19
    v_exp_f32 v20, v20
    v_mfma_f32_32x32x16_bf16 v[32:47], v[124:127], v[8:11], 0
    v_exp_f32 v21, v21
    ds_read_b128 v[8:11], v15 offset:1024
    v_exp_f32 v22, v22
    v_exp_f32 v23, v23
    v_exp_f32 v24, v24
    v_exp_f32 v25, v25
    v_exp_f32 v26, v26
    v_exp_f32 v27, v27
    v_exp_f32 v28, v28
    v_exp_f32 v29, v29
    v_exp_f32 v30, v30
    v_smfmac_f32_32x32x32_bf16 v[48:63], v[240:243], v[16:23], v2
    v_exp_f32 v31, v31
    v_exp_f32 v32, v32
    v_exp_f32 v33, v33
    v_smfmac_f32_32x32x32_bf16 v[48:63], v[244:247], v[24:31], v2
    v_exp_f32 v34, v34
    v_exp_f32 v35, v35
    v_exp_f32 v36, v36
    s_waitcnt lgkmcnt(0)
    v_mfma_f32_32x32x16_bf16 v[16:31], v[64:67], v[8:11], 0
    v_exp_f32 v37, v37
    v_exp_f32 v38, v38
    v_exp_f32 v39, v39
    v_exp_f32 v40, v40
    v_exp_f32 v41, v41
    v_exp_f32 v42, v42
    v_exp_f32 v43, v43
    v_exp_f32 v44, v44
    v_exp_f32 v45, v45
    v_exp_f32 v46, v46
    v_smfmac_f32_32x32x32_bf16 v[48:63], v[248:251], v[32:39], v2
    v_exp_f32 v47, v47
    v_exp_f32 v16, v16
    v_exp_f32 v17, v17
    v_smfmac_f32_32x32x32_bf16 v[48:63], v[252:255], v[40:47], v2
    v_exp_f32 v18, v18
    v_exp_f32 v19, v19
    v_exp_f32 v20, v20
    v_mfma_f32_32x32x16_bf16 v[32:47], v[68:71], v[8:11], 0
    v_exp_f32 v21, v21
    v_exp_f32 v22, v22
    v_exp_f32 v23, v23
    v_exp_f32 v24, v24
    v_exp_f32 v25, v25
    v_exp_f32 v26, v26
    v_exp_f32 v27, v27
    v_exp_f32 v28, v28
    ds_write_b128 v1, v[48:51] offset:0
    v_exp_f32 v29, v29
    ds_write_b128 v1, v[52:55] offset:1024
    v_exp_f32 v30, v30
    ds_write_b32 v3, v56 offset:0
    v_mfma_f32_32x32x8_bf16 v[48:63], v[4:5], v[4:5], 0
    v_exp_f32 v31, v31
    v_exp_f32 v32, v32
    v_exp_f32 v33, v33
    v_smfmac_f32_32x32x32_bf16 v[48:63], v[128:131], v[16:23], v2
    v_exp_f32 v34, v34
    v_exp_f32 v35, v35
    v_exp_f32 v36, v36
    v_smfmac_f32_32x32x32_bf16 v[48:63], v[132:135], v[24:31], v2
    v_exp_f32 v37, v37
    v_exp_f32 v38, v38
    v_exp_f32 v39, v39
    v_mfma_f32_32x32x16_bf16 v[16:31], v[72:75], v[8:11], 0
    v_exp_f32 v40, v40
    v_exp_f32 v41, v41
    v_exp_f32 v42, v42
    v_exp_f32 v43, v43
    v_smfmac_f32_32x32x32_bf16 v[48:63], v[136:139], v[32:39], v2
    v_exp_f32 v44, v44
    v_exp_f32 v45, v45
    v_exp_f32 v46, v46
    v_exp_f32 v47, v47
    s_nop 2
    v_exp_f32 v16, v16
    v_exp_f32 v17, v17
    v_smfmac_f32_32x32x32_bf16 v[48:63], v[140:143], v[40:47], v2
    v_exp_f32 v18, v18
    v_exp_f32 v19, v19
    v_exp_f32 v20, v20
    v_mfma_f32_32x32x16_bf16 v[32:47], v[76:79], v[8:11], 0
    v_exp_f32 v21, v21
    v_exp_f32 v22, v22
    v_exp_f32 v23, v23
    v_exp_f32 v24, v24
    v_exp_f32 v25, v25
    v_exp_f32 v26, v26
    v_exp_f32 v27, v27
    v_exp_f32 v28, v28
    v_exp_f32 v29, v29
    v_exp_f32 v30, v30
    v_smfmac_f32_32x32x32_bf16 v[48:63], v[144:147], v[16:23], v2
    v_exp_f32 v31, v31
    v_exp_f32 v32, v32
    v_exp_f32 v33, v33
    v_smfmac_f32_32x32x32_bf16 v[48:63], v[148:151], v[24:31], v2
    v_exp_f32 v34, v34
    v_exp_f32 v35, v35
    v_exp_f32 v36, v36
    v_mfma_f32_32x32x16_bf16 v[16:31], v[80:83], v[8:11], 0
    v_exp_f32 v37, v37
    v_exp_f32 v38, v38
    v_exp_f32 v39, v39
    v_exp_f32 v40, v40
    v_exp_f32 v41, v41
    v_exp_f32 v42, v42
    v_exp_f32 v43, v43
    v_exp_f32 v44, v44
    v_exp_f32 v45, v45
    v_exp_f32 v46, v46
    v_smfmac_f32_32x32x32_bf16 v[48:63], v[152:155], v[32:39], v2
    v_exp_f32 v47, v47
    v_exp_f32 v16, v16
    v_exp_f32 v17, v17
    v_smfmac_f32_32x32x32_bf16 v[48:63], v[156:159], v[40:47], v2
    v_exp_f32 v18, v18
    v_exp_f32 v19, v19
    v_exp_f32 v20, v20
    v_mfma_f32_32x32x16_bf16 v[32:47], v[84:87], v[8:11], 0
    v_exp_f32 v21, v21
    v_exp_f32 v22, v22
    v_exp_f32 v23, v23
    v_exp_f32 v24, v24
    v_exp_f32 v25, v25
    v_exp_f32 v26, v26
    v_exp_f32 v27, v27
    v_exp_f32 v28, v28
    v_exp_f32 v29, v29
    v_exp_f32 v30, v30
    v_smfmac_f32_32x32x32_bf16 v[48:63], v[160:163], v[16:23], v2
    v_exp_f32 v31, v31
    v_exp_f32 v32, v32
    v_exp_f32 v33, v33
    v_smfmac_f32_32x32x32_bf16 v[48:63], v[164:167], v[24:31], v2
    v_exp_f32 v34, v34
    v_exp_f32 v35, v35
    v_exp_f32 v36, v36
    v_mfma_f32_32x32x16_bf16 v[16:31], v[88:91], v[8:11], 0
    v_exp_f32 v37, v37
    v_exp_f32 v38, v38
    v_exp_f32 v39, v39
    v_exp_f32 v40, v40
    v_exp_f32 v41, v41
    v_exp_f32 v42, v42
    v_exp_f32 v43, v43
    v_exp_f32 v44, v44
    v_exp_f32 v45, v45
    v_exp_f32 v46, v46
    v_smfmac_f32_32x32x32_bf16 v[48:63], v[168:171], v[32:39], v2
    v_exp_f32 v47, v47
    v_exp_f32 v16, v16
    v_exp_f32 v17, v17
    v_smfmac_f32_32x32x32_bf16 v[48:63], v[172:175], v[40:47], v2
    v_exp_f32 v18, v18
    v_exp_f32 v19, v19
    v_exp_f32 v20, v20
    v_mfma_f32_32x32x16_bf16 v[32:47], v[92:95], v[8:11], 0
    v_exp_f32 v21, v21
    v_exp_f32 v22, v22
    v_exp_f32 v23, v23
    v_exp_f32 v24, v24
    v_exp_f32 v25, v25
    v_exp_f32 v26, v26
    v_exp_f32 v27, v27
    v_exp_f32 v28, v28
    v_exp_f32 v29, v29
    v_exp_f32 v30, v30
    v_smfmac_f32_32x32x32_bf16 v[48:63], v[176:179], v[16:23], v2
    v_exp_f32 v31, v31
    v_exp_f32 v32, v32
    v_exp_f32 v33, v33
    v_smfmac_f32_32x32x32_bf16 v[48:63], v[180:183], v[24:31], v2
    v_exp_f32 v34, v34
    v_exp_f32 v35, v35
    v_exp_f32 v36, v36
    v_mfma_f32_32x32x16_bf16 v[16:31], v[96:99], v[8:11], 0
    v_exp_f32 v37, v37
    v_exp_f32 v38, v38
    v_exp_f32 v39, v39
    v_exp_f32 v40, v40
    v_exp_f32 v41, v41
    v_exp_f32 v42, v42
    v_exp_f32 v43, v43
    v_exp_f32 v44, v44
    v_exp_f32 v45, v45
    v_exp_f32 v46, v46
    v_smfmac_f32_32x32x32_bf16 v[48:63], v[184:187], v[32:39], v2
    v_exp_f32 v47, v47
    v_exp_f32 v16, v16
    v_exp_f32 v17, v17
    v_smfmac_f32_32x32x32_bf16 v[48:63], v[188:191], v[40:47], v2
    v_exp_f32 v18, v18
    v_exp_f32 v19, v19
    v_exp_f32 v20, v20
    v_mfma_f32_32x32x16_bf16 v[32:47], v[100:103], v[8:11], 0
    v_exp_f32 v21, v21
    v_exp_f32 v22, v22
    v_exp_f32 v23, v23
    v_exp_f32 v24, v24
    v_exp_f32 v25, v25
    v_exp_f32 v26, v26
    v_exp_f32 v27, v27
    v_exp_f32 v28, v28
    v_exp_f32 v29, v29
    v_exp_f32 v30, v30
    v_smfmac_f32_32x32x32_bf16 v[48:63], v[192:195], v[16:23], v2
    v_exp_f32 v31, v31
    v_exp_f32 v32, v32
    v_exp_f32 v33, v33
    v_smfmac_f32_32x32x32_bf16 v[48:63], v[196:199], v[24:31], v2
    v_exp_f32 v34, v34
    v_exp_f32 v35, v35
    v_exp_f32 v36, v36
    v_mfma_f32_32x32x16_bf16 v[16:31], v[104:107], v[8:11], 0
    v_exp_f32 v37, v37
    v_exp_f32 v38, v38
    v_exp_f32 v39, v39
    v_exp_f32 v40, v40
    v_exp_f32 v41, v41
    v_exp_f32 v42, v42
    v_exp_f32 v43, v43
    v_exp_f32 v44, v44
    v_exp_f32 v45, v45
    v_exp_f32 v46, v46
    v_smfmac_f32_32x32x32_bf16 v[48:63], v[200:203], v[32:39], v2
    v_exp_f32 v47, v47
    v_exp_f32 v16, v16
    v_exp_f32 v17, v17
    v_smfmac_f32_32x32x32_bf16 v[48:63], v[204:207], v[40:47], v2
    v_exp_f32 v18, v18
    v_exp_f32 v19, v19
    v_exp_f32 v20, v20
    v_mfma_f32_32x32x16_bf16 v[32:47], v[108:111], v[8:11], 0
    v_exp_f32 v21, v21
    v_exp_f32 v22, v22
    v_exp_f32 v23, v23
    v_exp_f32 v24, v24
    v_exp_f32 v25, v25
    v_exp_f32 v26, v26
    v_exp_f32 v27, v27
    v_exp_f32 v28, v28
    v_exp_f32 v29, v29
    v_exp_f32 v30, v30
    v_smfmac_f32_32x32x32_bf16 v[48:63], v[208:211], v[16:23], v2
    v_exp_f32 v31, v31
    v_exp_f32 v32, v32
    v_exp_f32 v33, v33
    v_smfmac_f32_32x32x32_bf16 v[48:63], v[212:215], v[24:31], v2
    v_exp_f32 v34, v34
    v_exp_f32 v35, v35
    v_exp_f32 v36, v36
    v_mfma_f32_32x32x16_bf16 v[16:31], v[112:115], v[8:11], 0
    v_exp_f32 v37, v37
    v_exp_f32 v38, v38
    v_exp_f32 v39, v39
    v_exp_f32 v40, v40
    v_exp_f32 v41, v41
    v_exp_f32 v42, v42
    v_exp_f32 v43, v43
    v_exp_f32 v44, v44
    v_exp_f32 v45, v45
    v_exp_f32 v46, v46
    v_smfmac_f32_32x32x32_bf16 v[48:63], v[216:219], v[32:39], v2
    v_exp_f32 v47, v47
    v_exp_f32 v16, v16
    v_exp_f32 v17, v17
    v_smfmac_f32_32x32x32_bf16 v[48:63], v[220:223], v[40:47], v2
    v_exp_f32 v18, v18
    v_exp_f32 v19, v19
    v_exp_f32 v20, v20
    v_mfma_f32_32x32x16_bf16 v[32:47], v[116:119], v[8:11], 0
    v_exp_f32 v21, v21
    v_exp_f32 v22, v22
    v_exp_f32 v23, v23
    v_exp_f32 v24, v24
    v_exp_f32 v25, v25
    v_exp_f32 v26, v26
    v_exp_f32 v27, v27
    v_exp_f32 v28, v28
    v_exp_f32 v29, v29
    v_exp_f32 v30, v30
    v_smfmac_f32_32x32x32_bf16 v[48:63], v[224:227], v[16:23], v2
    v_exp_f32 v31, v31
    v_exp_f32 v32, v32
    v_exp_f32 v33, v33
    v_smfmac_f32_32x32x32_bf16 v[48:63], v[228:231], v[24:31], v2
    v_exp_f32 v34, v34
    v_exp_f32 v35, v35
    v_exp_f32 v36, v36
    v_mfma_f32_32x32x16_bf16 v[16:31], v[120:123], v[8:11], 0
    v_exp_f32 v37, v37
    v_exp_f32 v38, v38
    v_exp_f32 v39, v39
    v_exp_f32 v40, v40
    v_exp_f32 v41, v41
    v_exp_f32 v42, v42
    v_exp_f32 v43, v43
    v_exp_f32 v44, v44
    v_exp_f32 v45, v45
    v_exp_f32 v46, v46
    v_smfmac_f32_32x32x32_bf16 v[48:63], v[232:235], v[32:39], v2
    v_exp_f32 v47, v47
    v_exp_f32 v16, v16
    v_exp_f32 v17, v17
    v_smfmac_f32_32x32x32_bf16 v[48:63], v[236:239], v[40:47], v2
    v_exp_f32 v18, v18
    v_exp_f32 v19, v19
    v_exp_f32 v20, v20
    v_mfma_f32_32x32x16_bf16 v[32:47], v[124:127], v[8:11], 0
    v_exp_f32 v21, v21
    ds_read_b128 v[8:11], v15 offset:2048
    v_exp_f32 v22, v22
    v_exp_f32 v23, v23
    v_exp_f32 v24, v24
    v_exp_f32 v25, v25
    v_exp_f32 v26, v26
    v_exp_f32 v27, v27
    v_exp_f32 v28, v28
    v_exp_f32 v29, v29
    v_exp_f32 v30, v30
    v_smfmac_f32_32x32x32_bf16 v[48:63], v[240:243], v[16:23], v2
    v_exp_f32 v31, v31
    v_exp_f32 v32, v32
    v_exp_f32 v33, v33
    v_smfmac_f32_32x32x32_bf16 v[48:63], v[244:247], v[24:31], v2
    v_exp_f32 v34, v34
    v_exp_f32 v35, v35
    v_exp_f32 v36, v36
    s_waitcnt lgkmcnt(0)
    v_mfma_f32_32x32x16_bf16 v[16:31], v[64:67], v[8:11], 0
    v_exp_f32 v37, v37
    v_exp_f32 v38, v38
    v_exp_f32 v39, v39
    v_exp_f32 v40, v40
    v_exp_f32 v41, v41
    v_exp_f32 v42, v42
    v_exp_f32 v43, v43
    v_exp_f32 v44, v44
    v_exp_f32 v45, v45
    v_exp_f32 v46, v46
    v_smfmac_f32_32x32x32_bf16 v[48:63], v[248:251], v[32:39], v2
    v_exp_f32 v47, v47
    v_exp_f32 v16, v16
    v_exp_f32 v17, v17
    v_smfmac_f32_32x32x32_bf16 v[48:63], v[252:255], v[40:47], v2
    v_exp_f32 v18, v18
    v_exp_f32 v19, v19
    v_exp_f32 v20, v20
    v_mfma_f32_32x32x16_bf16 v[32:47], v[68:71], v[8:11], 0
    v_exp_f32 v21, v21
    v_exp_f32 v22, v22
    v_exp_f32 v23, v23
    v_exp_f32 v24, v24
    v_exp_f32 v25, v25
    v_exp_f32 v26, v26
    v_exp_f32 v27, v27
    v_exp_f32 v28, v28
    ds_write_b128 v1, v[48:51] offset:8192
    v_exp_f32 v29, v29
    ds_write_b128 v1, v[52:55] offset:9216
    v_exp_f32 v30, v30
    ds_write_b32 v3, v56 offset:1024
    v_mfma_f32_32x32x8_bf16 v[48:63], v[4:5], v[4:5], 0
    v_exp_f32 v31, v31
    v_exp_f32 v32, v32
    v_exp_f32 v33, v33
    v_smfmac_f32_32x32x32_bf16 v[48:63], v[128:131], v[16:23], v2
    v_exp_f32 v34, v34
    v_exp_f32 v35, v35
    v_exp_f32 v36, v36
    v_smfmac_f32_32x32x32_bf16 v[48:63], v[132:135], v[24:31], v2
    v_exp_f32 v37, v37
    v_exp_f32 v38, v38
    v_exp_f32 v39, v39
    v_mfma_f32_32x32x16_bf16 v[16:31], v[72:75], v[8:11], 0
    v_exp_f32 v40, v40
    v_exp_f32 v41, v41
    v_exp_f32 v42, v42
    v_exp_f32 v43, v43
    v_smfmac_f32_32x32x32_bf16 v[48:63], v[136:139], v[32:39], v2
    v_exp_f32 v44, v44
    v_exp_f32 v45, v45
    v_exp_f32 v46, v46
    v_exp_f32 v47, v47
    s_nop 2
    v_exp_f32 v16, v16
    v_exp_f32 v17, v17
    v_smfmac_f32_32x32x32_bf16 v[48:63], v[140:143], v[40:47], v2
    v_exp_f32 v18, v18
    v_exp_f32 v19, v19
    v_exp_f32 v20, v20
    v_mfma_f32_32x32x16_bf16 v[32:47], v[76:79], v[8:11], 0
    v_exp_f32 v21, v21
    v_exp_f32 v22, v22
    v_exp_f32 v23, v23
    v_exp_f32 v24, v24
    v_exp_f32 v25, v25
    v_exp_f32 v26, v26
    v_exp_f32 v27, v27
    v_exp_f32 v28, v28
    v_exp_f32 v29, v29
    v_exp_f32 v30, v30
    v_smfmac_f32_32x32x32_bf16 v[48:63], v[144:147], v[16:23], v2
    v_exp_f32 v31, v31
    v_exp_f32 v32, v32
    v_exp_f32 v33, v33
    v_smfmac_f32_32x32x32_bf16 v[48:63], v[148:151], v[24:31], v2
    v_exp_f32 v34, v34
    v_exp_f32 v35, v35
    v_exp_f32 v36, v36
    v_mfma_f32_32x32x16_bf16 v[16:31], v[80:83], v[8:11], 0
    v_exp_f32 v37, v37
    v_exp_f32 v38, v38
    v_exp_f32 v39, v39
    v_exp_f32 v40, v40
    v_exp_f32 v41, v41
    v_exp_f32 v42, v42
    v_exp_f32 v43, v43
    v_exp_f32 v44, v44
    v_exp_f32 v45, v45
    v_exp_f32 v46, v46
    v_smfmac_f32_32x32x32_bf16 v[48:63], v[152:155], v[32:39], v2
    v_exp_f32 v47, v47
    v_exp_f32 v16, v16
    v_exp_f32 v17, v17
    v_smfmac_f32_32x32x32_bf16 v[48:63], v[156:159], v[40:47], v2
    v_exp_f32 v18, v18
    v_exp_f32 v19, v19
    v_exp_f32 v20, v20
    v_mfma_f32_32x32x16_bf16 v[32:47], v[84:87], v[8:11], 0
    v_exp_f32 v21, v21
    v_exp_f32 v22, v22
    v_exp_f32 v23, v23
    v_exp_f32 v24, v24
    v_exp_f32 v25, v25
    v_exp_f32 v26, v26
    v_exp_f32 v27, v27
    v_exp_f32 v28, v28
    v_exp_f32 v29, v29
    v_exp_f32 v30, v30
    v_smfmac_f32_32x32x32_bf16 v[48:63], v[160:163], v[16:23], v2
    v_exp_f32 v31, v31
    v_exp_f32 v32, v32
    v_exp_f32 v33, v33
    v_smfmac_f32_32x32x32_bf16 v[48:63], v[164:167], v[24:31], v2
    v_exp_f32 v34, v34
    v_exp_f32 v35, v35
    v_exp_f32 v36, v36
    v_mfma_f32_32x32x16_bf16 v[16:31], v[88:91], v[8:11], 0
    v_exp_f32 v37, v37
    v_exp_f32 v38, v38
    v_exp_f32 v39, v39
    v_exp_f32 v40, v40
    v_exp_f32 v41, v41
    v_exp_f32 v42, v42
    v_exp_f32 v43, v43
    v_exp_f32 v44, v44
    v_exp_f32 v45, v45
    v_exp_f32 v46, v46
    v_smfmac_f32_32x32x32_bf16 v[48:63], v[168:171], v[32:39], v2
    v_exp_f32 v47, v47
    v_exp_f32 v16, v16
    v_exp_f32 v17, v17
    v_smfmac_f32_32x32x32_bf16 v[48:63], v[172:175], v[40:47], v2
    v_exp_f32 v18, v18
    v_exp_f32 v19, v19
    v_exp_f32 v20, v20
    v_mfma_f32_32x32x16_bf16 v[32:47], v[92:95], v[8:11], 0
    v_exp_f32 v21, v21
    v_exp_f32 v22, v22
    v_exp_f32 v23, v23
    v_exp_f32 v24, v24
    v_exp_f32 v25, v25
    v_exp_f32 v26, v26
    v_exp_f32 v27, v27
    v_exp_f32 v28, v28
    v_exp_f32 v29, v29
    v_exp_f32 v30, v30
    v_smfmac_f32_32x32x32_bf16 v[48:63], v[176:179], v[16:23], v2
    v_exp_f32 v31, v31
    v_exp_f32 v32, v32
    v_exp_f32 v33, v33
    v_smfmac_f32_32x32x32_bf16 v[48:63], v[180:183], v[24:31], v2
    v_exp_f32 v34, v34
    v_exp_f32 v35, v35
    v_exp_f32 v36, v36
    v_mfma_f32_32x32x16_bf16 v[16:31], v[96:99], v[8:11], 0
    v_exp_f32 v37, v37
    v_exp_f32 v38, v38
    v_exp_f32 v39, v39
    v_exp_f32 v40, v40
    v_exp_f32 v41, v41
    v_exp_f32 v42, v42
    v_exp_f32 v43, v43
    v_exp_f32 v44, v44
    v_exp_f32 v45, v45
    v_exp_f32 v46, v46
    v_smfmac_f32_32x32x32_bf16 v[48:63], v[184:187], v[32:39], v2
    v_exp_f32 v47, v47
    v_exp_f32 v16, v16
    v_exp_f32 v17, v17
    v_smfmac_f32_32x32x32_bf16 v[48:63], v[188:191], v[40:47], v2
    v_exp_f32 v18, v18
    v_exp_f32 v19, v19
    v_exp_f32 v20, v20
    v_mfma_f32_32x32x16_bf16 v[32:47], v[100:103], v[8:11], 0
    v_exp_f32 v21, v21
    v_exp_f32 v22, v22
    v_exp_f32 v23, v23
    v_exp_f32 v24, v24
    v_exp_f32 v25, v25
    v_exp_f32 v26, v26
    v_exp_f32 v27, v27
    v_exp_f32 v28, v28
    v_exp_f32 v29, v29
    v_exp_f32 v30, v30
    v_smfmac_f32_32x32x32_bf16 v[48:63], v[192:195], v[16:23], v2
    v_exp_f32 v31, v31
    v_exp_f32 v32, v32
    v_exp_f32 v33, v33
    v_smfmac_f32_32x32x32_bf16 v[48:63], v[196:199], v[24:31], v2
    v_exp_f32 v34, v34
    v_exp_f32 v35, v35
    v_exp_f32 v36, v36
    v_mfma_f32_32x32x16_bf16 v[16:31], v[104:107], v[8:11], 0
    v_exp_f32 v37, v37
    v_exp_f32 v38, v38
    v_exp_f32 v39, v39
    v_exp_f32 v40, v40
    v_exp_f32 v41, v41
    v_exp_f32 v42, v42
    v_exp_f32 v43, v43
    v_exp_f32 v44, v44
    v_exp_f32 v45, v45
    v_exp_f32 v46, v46
    v_smfmac_f32_32x32x32_bf16 v[48:63], v[200:203], v[32:39], v2
    v_exp_f32 v47, v47
    v_exp_f32 v16, v16
    v_exp_f32 v17, v17
    v_smfmac_f32_32x32x32_bf16 v[48:63], v[204:207], v[40:47], v2
    v_exp_f32 v18, v18
    v_exp_f32 v19, v19
    v_exp_f32 v20, v20
    v_mfma_f32_32x32x16_bf16 v[32:47], v[108:111], v[8:11], 0
    v_exp_f32 v21, v21
    v_exp_f32 v22, v22
    v_exp_f32 v23, v23
    v_exp_f32 v24, v24
    v_exp_f32 v25, v25
    v_exp_f32 v26, v26
    v_exp_f32 v27, v27
    v_exp_f32 v28, v28
    v_exp_f32 v29, v29
    v_exp_f32 v30, v30
    v_smfmac_f32_32x32x32_bf16 v[48:63], v[208:211], v[16:23], v2
    v_exp_f32 v31, v31
    v_exp_f32 v32, v32
    v_exp_f32 v33, v33
    v_smfmac_f32_32x32x32_bf16 v[48:63], v[212:215], v[24:31], v2
    v_exp_f32 v34, v34
    v_exp_f32 v35, v35
    v_exp_f32 v36, v36
    v_mfma_f32_32x32x16_bf16 v[16:31], v[112:115], v[8:11], 0
    v_exp_f32 v37, v37
    v_exp_f32 v38, v38
    v_exp_f32 v39, v39
    v_exp_f32 v40, v40
    v_exp_f32 v41, v41
    v_exp_f32 v42, v42
    v_exp_f32 v43, v43
    v_exp_f32 v44, v44
    v_exp_f32 v45, v45
    v_exp_f32 v46, v46
    v_smfmac_f32_32x32x32_bf16 v[48:63], v[216:219], v[32:39], v2
    v_exp_f32 v47, v47
    v_exp_f32 v16, v16
    v_exp_f32 v17, v17
    v_smfmac_f32_32x32x32_bf16 v[48:63], v[220:223], v[40:47], v2
    v_exp_f32 v18, v18
    v_exp_f32 v19, v19
    v_exp_f32 v20, v20
    v_mfma_f32_32x32x16_bf16 v[32:47], v[116:119], v[8:11], 0
    v_exp_f32 v21, v21
    v_exp_f32 v22, v22
    v_exp_f32 v23, v23
    v_exp_f32 v24, v24
    v_exp_f32 v25, v25
    v_exp_f32 v26, v26
    v_exp_f32 v27, v27
    v_exp_f32 v28, v28
    v_exp_f32 v29, v29
    v_exp_f32 v30, v30
    v_smfmac_f32_32x32x32_bf16 v[48:63], v[224:227], v[16:23], v2
    v_exp_f32 v31, v31
    v_exp_f32 v32, v32
    v_exp_f32 v33, v33
    v_smfmac_f32_32x32x32_bf16 v[48:63], v[228:231], v[24:31], v2
    v_exp_f32 v34, v34
    v_exp_f32 v35, v35
    v_exp_f32 v36, v36
    v_mfma_f32_32x32x16_bf16 v[16:31], v[120:123], v[8:11], 0
    v_exp_f32 v37, v37
    v_exp_f32 v38, v38
    v_exp_f32 v39, v39
    v_exp_f32 v40, v40
    v_exp_f32 v41, v41
    v_exp_f32 v42, v42
    v_exp_f32 v43, v43
    v_exp_f32 v44, v44
    v_exp_f32 v45, v45
    v_exp_f32 v46, v46
    v_smfmac_f32_32x32x32_bf16 v[48:63], v[232:235], v[32:39], v2
    v_exp_f32 v47, v47
    v_exp_f32 v16, v16
    v_exp_f32 v17, v17
    v_smfmac_f32_32x32x32_bf16 v[48:63], v[236:239], v[40:47], v2
    v_exp_f32 v18, v18
    v_exp_f32 v19, v19
    v_exp_f32 v20, v20
    v_mfma_f32_32x32x16_bf16 v[32:47], v[124:127], v[8:11], 0
    v_exp_f32 v21, v21
    ds_read_b128 v[8:11], v15 offset:3072
    v_exp_f32 v22, v22
    v_exp_f32 v23, v23
    v_exp_f32 v24, v24
    v_exp_f32 v25, v25
    v_exp_f32 v26, v26
    v_exp_f32 v27, v27
    v_exp_f32 v28, v28
    v_exp_f32 v29, v29
    v_exp_f32 v30, v30
    v_smfmac_f32_32x32x32_bf16 v[48:63], v[240:243], v[16:23], v2
    v_exp_f32 v31, v31
    v_exp_f32 v32, v32
    v_exp_f32 v33, v33
    v_smfmac_f32_32x32x32_bf16 v[48:63], v[244:247], v[24:31], v2
    v_exp_f32 v34, v34
    v_exp_f32 v35, v35
    v_exp_f32 v36, v36
    s_waitcnt lgkmcnt(0)
    v_mfma_f32_32x32x16_bf16 v[16:31], v[64:67], v[8:11], 0
    v_exp_f32 v37, v37
    v_exp_f32 v38, v38
    v_exp_f32 v39, v39
    v_exp_f32 v40, v40
    v_exp_f32 v41, v41
    v_exp_f32 v42, v42
    v_exp_f32 v43, v43
    v_exp_f32 v44, v44
    v_exp_f32 v45, v45
    v_exp_f32 v46, v46
    v_smfmac_f32_32x32x32_bf16 v[48:63], v[248:251], v[32:39], v2
    v_exp_f32 v47, v47
    v_exp_f32 v16, v16
    v_exp_f32 v17, v17
    v_smfmac_f32_32x32x32_bf16 v[48:63], v[252:255], v[40:47], v2
    v_exp_f32 v18, v18
    v_exp_f32 v19, v19
    v_exp_f32 v20, v20
    v_mfma_f32_32x32x16_bf16 v[32:47], v[68:71], v[8:11], 0
    v_exp_f32 v21, v21
    v_exp_f32 v22, v22
    v_exp_f32 v23, v23
    v_exp_f32 v24, v24
    v_exp_f32 v25, v25
    v_exp_f32 v26, v26
    v_exp_f32 v27, v27
    v_exp_f32 v28, v28
    ds_write_b128 v1, v[48:51] offset:16384
    v_exp_f32 v29, v29
    ds_write_b128 v1, v[52:55] offset:17408
    v_exp_f32 v30, v30
    ds_write_b32 v3, v56 offset:2048
    v_mfma_f32_32x32x8_bf16 v[48:63], v[4:5], v[4:5], 0
    v_exp_f32 v31, v31
    v_exp_f32 v32, v32
    v_exp_f32 v33, v33
    v_smfmac_f32_32x32x32_bf16 v[48:63], v[128:131], v[16:23], v2
    v_exp_f32 v34, v34
    v_exp_f32 v35, v35
    v_exp_f32 v36, v36
    v_smfmac_f32_32x32x32_bf16 v[48:63], v[132:135], v[24:31], v2
    v_exp_f32 v37, v37
    v_exp_f32 v38, v38
    v_exp_f32 v39, v39
    v_mfma_f32_32x32x16_bf16 v[16:31], v[72:75], v[8:11], 0
    v_exp_f32 v40, v40
    v_exp_f32 v41, v41
    v_exp_f32 v42, v42
    v_exp_f32 v43, v43
    v_smfmac_f32_32x32x32_bf16 v[48:63], v[136:139], v[32:39], v2
    v_exp_f32 v44, v44
    v_exp_f32 v45, v45
    v_exp_f32 v46, v46
    v_exp_f32 v47, v47
    s_nop 2
    v_exp_f32 v16, v16
    v_exp_f32 v17, v17
    v_smfmac_f32_32x32x32_bf16 v[48:63], v[140:143], v[40:47], v2
    v_exp_f32 v18, v18
    v_exp_f32 v19, v19
    v_exp_f32 v20, v20
    v_mfma_f32_32x32x16_bf16 v[32:47], v[76:79], v[8:11], 0
    v_exp_f32 v21, v21
    v_exp_f32 v22, v22
    v_exp_f32 v23, v23
    v_exp_f32 v24, v24
    v_exp_f32 v25, v25
    v_exp_f32 v26, v26
    v_exp_f32 v27, v27
    v_exp_f32 v28, v28
    v_exp_f32 v29, v29
    v_exp_f32 v30, v30
    v_smfmac_f32_32x32x32_bf16 v[48:63], v[144:147], v[16:23], v2
    v_exp_f32 v31, v31
    v_exp_f32 v32, v32
    v_exp_f32 v33, v33
    v_smfmac_f32_32x32x32_bf16 v[48:63], v[148:151], v[24:31], v2
    v_exp_f32 v34, v34
    v_exp_f32 v35, v35
    v_exp_f32 v36, v36
    v_mfma_f32_32x32x16_bf16 v[16:31], v[80:83], v[8:11], 0
    v_exp_f32 v37, v37
    v_exp_f32 v38, v38
    v_exp_f32 v39, v39
    v_exp_f32 v40, v40
    v_exp_f32 v41, v41
    v_exp_f32 v42, v42
    v_exp_f32 v43, v43
    v_exp_f32 v44, v44
    v_exp_f32 v45, v45
    v_exp_f32 v46, v46
    v_smfmac_f32_32x32x32_bf16 v[48:63], v[152:155], v[32:39], v2
    v_exp_f32 v47, v47
    v_exp_f32 v16, v16
    v_exp_f32 v17, v17
    v_smfmac_f32_32x32x32_bf16 v[48:63], v[156:159], v[40:47], v2
    v_exp_f32 v18, v18
    v_exp_f32 v19, v19
    v_exp_f32 v20, v20
    v_mfma_f32_32x32x16_bf16 v[32:47], v[84:87], v[8:11], 0
    v_exp_f32 v21, v21
    v_exp_f32 v22, v22
    v_exp_f32 v23, v23
    v_exp_f32 v24, v24
    v_exp_f32 v25, v25
    v_exp_f32 v26, v26
    v_exp_f32 v27, v27
    v_exp_f32 v28, v28
    v_exp_f32 v29, v29
    v_exp_f32 v30, v30
    v_smfmac_f32_32x32x32_bf16 v[48:63], v[160:163], v[16:23], v2
    v_exp_f32 v31, v31
    v_exp_f32 v32, v32
    v_exp_f32 v33, v33
    v_smfmac_f32_32x32x32_bf16 v[48:63], v[164:167], v[24:31], v2
    v_exp_f32 v34, v34
    v_exp_f32 v35, v35
    v_exp_f32 v36, v36
    v_mfma_f32_32x32x16_bf16 v[16:31], v[88:91], v[8:11], 0
    v_exp_f32 v37, v37
    v_exp_f32 v38, v38
    v_exp_f32 v39, v39
    v_exp_f32 v40, v40
    v_exp_f32 v41, v41
    v_exp_f32 v42, v42
    v_exp_f32 v43, v43
    v_exp_f32 v44, v44
    v_exp_f32 v45, v45
    v_exp_f32 v46, v46
    v_smfmac_f32_32x32x32_bf16 v[48:63], v[168:171], v[32:39], v2
    v_exp_f32 v47, v47
    v_exp_f32 v16, v16
    v_exp_f32 v17, v17
    v_smfmac_f32_32x32x32_bf16 v[48:63], v[172:175], v[40:47], v2
    v_exp_f32 v18, v18
    v_exp_f32 v19, v19
    v_exp_f32 v20, v20
    v_mfma_f32_32x32x16_bf16 v[32:47], v[92:95], v[8:11], 0
    v_exp_f32 v21, v21
    v_exp_f32 v22, v22
    v_exp_f32 v23, v23
    v_exp_f32 v24, v24
    v_exp_f32 v25, v25
    v_exp_f32 v26, v26
    v_exp_f32 v27, v27
    v_exp_f32 v28, v28
    v_exp_f32 v29, v29
    v_exp_f32 v30, v30
    v_smfmac_f32_32x32x32_bf16 v[48:63], v[176:179], v[16:23], v2
    v_exp_f32 v31, v31
    v_exp_f32 v32, v32
    v_exp_f32 v33, v33
    v_smfmac_f32_32x32x32_bf16 v[48:63], v[180:183], v[24:31], v2
    v_exp_f32 v34, v34
    v_exp_f32 v35, v35
    v_exp_f32 v36, v36
    v_mfma_f32_32x32x16_bf16 v[16:31], v[96:99], v[8:11], 0
    v_exp_f32 v37, v37
    v_exp_f32 v38, v38
    v_exp_f32 v39, v39
    v_exp_f32 v40, v40
    v_exp_f32 v41, v41
    v_exp_f32 v42, v42
    v_exp_f32 v43, v43
    v_exp_f32 v44, v44
    v_exp_f32 v45, v45
    v_exp_f32 v46, v46
    v_smfmac_f32_32x32x32_bf16 v[48:63], v[184:187], v[32:39], v2
    v_exp_f32 v47, v47
    v_exp_f32 v16, v16
    v_exp_f32 v17, v17
    v_smfmac_f32_32x32x32_bf16 v[48:63], v[188:191], v[40:47], v2
    v_exp_f32 v18, v18
    v_exp_f32 v19, v19
    v_exp_f32 v20, v20
    v_mfma_f32_32x32x16_bf16 v[32:47], v[100:103], v[8:11], 0
    v_exp_f32 v21, v21
    v_exp_f32 v22, v22
    v_exp_f32 v23, v23
    v_exp_f32 v24, v24
    v_exp_f32 v25, v25
    v_exp_f32 v26, v26
    v_exp_f32 v27, v27
    v_exp_f32 v28, v28
    v_exp_f32 v29, v29
    v_exp_f32 v30, v30
    v_smfmac_f32_32x32x32_bf16 v[48:63], v[192:195], v[16:23], v2
    v_exp_f32 v31, v31
    v_exp_f32 v32, v32
    v_exp_f32 v33, v33
    v_smfmac_f32_32x32x32_bf16 v[48:63], v[196:199], v[24:31], v2
    v_exp_f32 v34, v34
    v_exp_f32 v35, v35
    v_exp_f32 v36, v36
    v_mfma_f32_32x32x16_bf16 v[16:31], v[104:107], v[8:11], 0
    v_exp_f32 v37, v37
    v_exp_f32 v38, v38
    v_exp_f32 v39, v39
    v_exp_f32 v40, v40
    v_exp_f32 v41, v41
    v_exp_f32 v42, v42
    v_exp_f32 v43, v43
    v_exp_f32 v44, v44
    v_exp_f32 v45, v45
    v_exp_f32 v46, v46
    v_smfmac_f32_32x32x32_bf16 v[48:63], v[200:203], v[32:39], v2
    v_exp_f32 v47, v47
    v_exp_f32 v16, v16
    v_exp_f32 v17, v17
    v_smfmac_f32_32x32x32_bf16 v[48:63], v[204:207], v[40:47], v2
    v_exp_f32 v18, v18
    v_exp_f32 v19, v19
    v_exp_f32 v20, v20
    v_mfma_f32_32x32x16_bf16 v[32:47], v[108:111], v[8:11], 0
    v_exp_f32 v21, v21
    v_exp_f32 v22, v22
    v_exp_f32 v23, v23
    v_exp_f32 v24, v24
    v_exp_f32 v25, v25
    v_exp_f32 v26, v26
    v_exp_f32 v27, v27
    v_exp_f32 v28, v28
    v_exp_f32 v29, v29
    v_exp_f32 v30, v30
    v_smfmac_f32_32x32x32_bf16 v[48:63], v[208:211], v[16:23], v2
    v_exp_f32 v31, v31
    v_exp_f32 v32, v32
    v_exp_f32 v33, v33
    v_smfmac_f32_32x32x32_bf16 v[48:63], v[212:215], v[24:31], v2
    v_exp_f32 v34, v34
    v_exp_f32 v35, v35
    v_exp_f32 v36, v36
    v_mfma_f32_32x32x16_bf16 v[16:31], v[112:115], v[8:11], 0
    v_exp_f32 v37, v37
    v_exp_f32 v38, v38
    v_exp_f32 v39, v39
    v_exp_f32 v40, v40
    v_exp_f32 v41, v41
    v_exp_f32 v42, v42
    v_exp_f32 v43, v43
    v_exp_f32 v44, v44
    v_exp_f32 v45, v45
    v_exp_f32 v46, v46
    v_smfmac_f32_32x32x32_bf16 v[48:63], v[216:219], v[32:39], v2
    v_exp_f32 v47, v47
    v_exp_f32 v16, v16
    v_exp_f32 v17, v17
    v_smfmac_f32_32x32x32_bf16 v[48:63], v[220:223], v[40:47], v2
    v_exp_f32 v18, v18
    v_exp_f32 v19, v19
    v_exp_f32 v20, v20
    v_mfma_f32_32x32x16_bf16 v[32:47], v[116:119], v[8:11], 0
    v_exp_f32 v21, v21
    v_exp_f32 v22, v22
    v_exp_f32 v23, v23
    v_exp_f32 v24, v24
    v_exp_f32 v25, v25
    v_exp_f32 v26, v26
    v_exp_f32 v27, v27
    v_exp_f32 v28, v28
    v_exp_f32 v29, v29
    v_exp_f32 v30, v30
    v_smfmac_f32_32x32x32_bf16 v[48:63], v[224:227], v[16:23], v2
    v_exp_f32 v31, v31
    v_exp_f32 v32, v32
    v_exp_f32 v33, v33
    v_smfmac_f32_32x32x32_bf16 v[48:63], v[228:231], v[24:31], v2
    v_exp_f32 v34, v34
    v_exp_f32 v35, v35
    v_exp_f32 v36, v36
    v_mfma_f32_32x32x16_bf16 v[16:31], v[120:123], v[8:11], 0
    v_exp_f32 v37, v37
    v_exp_f32 v38, v38
    v_exp_f32 v39, v39
    v_exp_f32 v40, v40
    v_exp_f32 v41, v41
    v_exp_f32 v42, v42
    v_exp_f32 v43, v43
    v_exp_f32 v44, v44
    v_exp_f32 v45, v45
    v_exp_f32 v46, v46
    v_smfmac_f32_32x32x32_bf16 v[48:63], v[232:235], v[32:39], v2
    v_exp_f32 v47, v47
    v_exp_f32 v16, v16
    v_exp_f32 v17, v17
    v_smfmac_f32_32x32x32_bf16 v[48:63], v[236:239], v[40:47], v2
    v_exp_f32 v18, v18
    v_exp_f32 v19, v19
    v_exp_f32 v20, v20
    v_mfma_f32_32x32x16_bf16 v[32:47], v[124:127], v[8:11], 0
    v_exp_f32 v21, v21
    ds_read_b128 v[8:11], v15 offset:4096
    v_exp_f32 v22, v22
    v_exp_f32 v23, v23
    v_exp_f32 v24, v24
    v_exp_f32 v25, v25
    v_exp_f32 v26, v26
    v_exp_f32 v27, v27
    v_exp_f32 v28, v28
    v_exp_f32 v29, v29
    v_exp_f32 v30, v30
    v_smfmac_f32_32x32x32_bf16 v[48:63], v[240:243], v[16:23], v2
    v_exp_f32 v31, v31
    v_exp_f32 v32, v32
    v_exp_f32 v33, v33
    v_smfmac_f32_32x32x32_bf16 v[48:63], v[244:247], v[24:31], v2
    v_exp_f32 v34, v34
    v_exp_f32 v35, v35
    v_exp_f32 v36, v36
    s_waitcnt lgkmcnt(0)
    v_mfma_f32_32x32x16_bf16 v[16:31], v[64:67], v[8:11], 0
    v_exp_f32 v37, v37
    v_exp_f32 v38, v38
    v_exp_f32 v39, v39
    v_exp_f32 v40, v40
    v_exp_f32 v41, v41
    v_exp_f32 v42, v42
    v_exp_f32 v43, v43
    v_exp_f32 v44, v44
    v_exp_f32 v45, v45
    v_exp_f32 v46, v46
    v_smfmac_f32_32x32x32_bf16 v[48:63], v[248:251], v[32:39], v2
    v_exp_f32 v47, v47
    v_exp_f32 v16, v16
    v_exp_f32 v17, v17
    v_smfmac_f32_32x32x32_bf16 v[48:63], v[252:255], v[40:47], v2
    v_exp_f32 v18, v18
    v_exp_f32 v19, v19
    v_exp_f32 v20, v20
    v_mfma_f32_32x32x16_bf16 v[32:47], v[68:71], v[8:11], 0
    v_exp_f32 v21, v21
    v_exp_f32 v22, v22
    v_exp_f32 v23, v23
    v_exp_f32 v24, v24
    v_exp_f32 v25, v25
    v_exp_f32 v26, v26
    v_exp_f32 v27, v27
    v_exp_f32 v28, v28
    ds_write_b128 v1, v[48:51] offset:24576
    v_exp_f32 v29, v29
    ds_write_b128 v1, v[52:55] offset:25600
    v_exp_f32 v30, v30
    ds_write_b32 v3, v56 offset:3072
    v_mfma_f32_32x32x8_bf16 v[48:63], v[4:5], v[4:5], 0
    v_exp_f32 v31, v31
    v_exp_f32 v32, v32
    v_exp_f32 v33, v33
    v_smfmac_f32_32x32x32_bf16 v[48:63], v[128:131], v[16:23], v2
    v_exp_f32 v34, v34
    v_exp_f32 v35, v35
    v_exp_f32 v36, v36
    v_smfmac_f32_32x32x32_bf16 v[48:63], v[132:135], v[24:31], v2
    v_exp_f32 v37, v37
    v_exp_f32 v38, v38
    v_exp_f32 v39, v39
    v_mfma_f32_32x32x16_bf16 v[16:31], v[72:75], v[8:11], 0
    v_exp_f32 v40, v40
    v_exp_f32 v41, v41
    v_exp_f32 v42, v42
    v_exp_f32 v43, v43
    v_smfmac_f32_32x32x32_bf16 v[48:63], v[136:139], v[32:39], v2
    v_exp_f32 v44, v44
    v_exp_f32 v45, v45
    v_exp_f32 v46, v46
    v_exp_f32 v47, v47
    s_nop 2
    v_exp_f32 v16, v16
    v_exp_f32 v17, v17
    v_smfmac_f32_32x32x32_bf16 v[48:63], v[140:143], v[40:47], v2
    v_exp_f32 v18, v18
    v_exp_f32 v19, v19
    v_exp_f32 v20, v20
    v_mfma_f32_32x32x16_bf16 v[32:47], v[76:79], v[8:11], 0
    v_exp_f32 v21, v21
    v_exp_f32 v22, v22
    v_exp_f32 v23, v23
    v_exp_f32 v24, v24
    v_exp_f32 v25, v25
    v_exp_f32 v26, v26
    v_exp_f32 v27, v27
    v_exp_f32 v28, v28
    v_exp_f32 v29, v29
    v_exp_f32 v30, v30
    v_smfmac_f32_32x32x32_bf16 v[48:63], v[144:147], v[16:23], v2
    v_exp_f32 v31, v31
    v_exp_f32 v32, v32
    v_exp_f32 v33, v33
    v_smfmac_f32_32x32x32_bf16 v[48:63], v[148:151], v[24:31], v2
    v_exp_f32 v34, v34
    v_exp_f32 v35, v35
    v_exp_f32 v36, v36
    v_mfma_f32_32x32x16_bf16 v[16:31], v[80:83], v[8:11], 0
    v_exp_f32 v37, v37
    v_exp_f32 v38, v38
    v_exp_f32 v39, v39
    v_exp_f32 v40, v40
    v_exp_f32 v41, v41
    v_exp_f32 v42, v42
    v_exp_f32 v43, v43
    v_exp_f32 v44, v44
    v_exp_f32 v45, v45
    v_exp_f32 v46, v46
    v_smfmac_f32_32x32x32_bf16 v[48:63], v[152:155], v[32:39], v2
    v_exp_f32 v47, v47
    v_exp_f32 v16, v16
    v_exp_f32 v17, v17
    v_smfmac_f32_32x32x32_bf16 v[48:63], v[156:159], v[40:47], v2
    v_exp_f32 v18, v18
    v_exp_f32 v19, v19
    v_exp_f32 v20, v20
    v_mfma_f32_32x32x16_bf16 v[32:47], v[84:87], v[8:11], 0
    v_exp_f32 v21, v21
    v_exp_f32 v22, v22
    v_exp_f32 v23, v23
    v_exp_f32 v24, v24
    v_exp_f32 v25, v25
    v_exp_f32 v26, v26
    v_exp_f32 v27, v27
    v_exp_f32 v28, v28
    v_exp_f32 v29, v29
    v_exp_f32 v30, v30
    v_smfmac_f32_32x32x32_bf16 v[48:63], v[160:163], v[16:23], v2
    v_exp_f32 v31, v31
    v_exp_f32 v32, v32
    v_exp_f32 v33, v33
    v_smfmac_f32_32x32x32_bf16 v[48:63], v[164:167], v[24:31], v2
    v_exp_f32 v34, v34
    v_exp_f32 v35, v35
    v_exp_f32 v36, v36
    v_mfma_f32_32x32x16_bf16 v[16:31], v[88:91], v[8:11], 0
    v_exp_f32 v37, v37
    v_exp_f32 v38, v38
    v_exp_f32 v39, v39
    v_exp_f32 v40, v40
    v_exp_f32 v41, v41
    v_exp_f32 v42, v42
    v_exp_f32 v43, v43
    v_exp_f32 v44, v44
    v_exp_f32 v45, v45
    v_exp_f32 v46, v46
    v_smfmac_f32_32x32x32_bf16 v[48:63], v[168:171], v[32:39], v2
    v_exp_f32 v47, v47
    v_exp_f32 v16, v16
    v_exp_f32 v17, v17
    v_smfmac_f32_32x32x32_bf16 v[48:63], v[172:175], v[40:47], v2
    v_exp_f32 v18, v18
    v_exp_f32 v19, v19
    v_exp_f32 v20, v20
    v_mfma_f32_32x32x16_bf16 v[32:47], v[92:95], v[8:11], 0
    v_exp_f32 v21, v21
    v_exp_f32 v22, v22
    v_exp_f32 v23, v23
    v_exp_f32 v24, v24
    v_exp_f32 v25, v25
    v_exp_f32 v26, v26
    v_exp_f32 v27, v27
    v_exp_f32 v28, v28
    v_exp_f32 v29, v29
    v_exp_f32 v30, v30
    v_smfmac_f32_32x32x32_bf16 v[48:63], v[176:179], v[16:23], v2
    v_exp_f32 v31, v31
    v_exp_f32 v32, v32
    v_exp_f32 v33, v33
    v_smfmac_f32_32x32x32_bf16 v[48:63], v[180:183], v[24:31], v2
    v_exp_f32 v34, v34
    v_exp_f32 v35, v35
    v_exp_f32 v36, v36
    v_mfma_f32_32x32x16_bf16 v[16:31], v[96:99], v[8:11], 0
    v_exp_f32 v37, v37
    v_exp_f32 v38, v38
    v_exp_f32 v39, v39
    v_exp_f32 v40, v40
    v_exp_f32 v41, v41
    v_exp_f32 v42, v42
    v_exp_f32 v43, v43
    v_exp_f32 v44, v44
    v_exp_f32 v45, v45
    v_exp_f32 v46, v46
    v_smfmac_f32_32x32x32_bf16 v[48:63], v[184:187], v[32:39], v2
    v_exp_f32 v47, v47
    v_exp_f32 v16, v16
    v_exp_f32 v17, v17
    v_smfmac_f32_32x32x32_bf16 v[48:63], v[188:191], v[40:47], v2
    v_exp_f32 v18, v18
    v_exp_f32 v19, v19
    v_exp_f32 v20, v20
    v_mfma_f32_32x32x16_bf16 v[32:47], v[100:103], v[8:11], 0
    v_exp_f32 v21, v21
    v_exp_f32 v22, v22
    v_exp_f32 v23, v23
    v_exp_f32 v24, v24
    v_exp_f32 v25, v25
    v_exp_f32 v26, v26
    v_exp_f32 v27, v27
    v_exp_f32 v28, v28
    v_exp_f32 v29, v29
    v_exp_f32 v30, v30
    v_smfmac_f32_32x32x32_bf16 v[48:63], v[192:195], v[16:23], v2
    v_exp_f32 v31, v31
    v_exp_f32 v32, v32
    v_exp_f32 v33, v33
    v_smfmac_f32_32x32x32_bf16 v[48:63], v[196:199], v[24:31], v2
    v_exp_f32 v34, v34
    v_exp_f32 v35, v35
    v_exp_f32 v36, v36
    v_mfma_f32_32x32x16_bf16 v[16:31], v[104:107], v[8:11], 0
    v_exp_f32 v37, v37
    v_exp_f32 v38, v38
    v_exp_f32 v39, v39
    v_exp_f32 v40, v40
    v_exp_f32 v41, v41
    v_exp_f32 v42, v42
    v_exp_f32 v43, v43
    v_exp_f32 v44, v44
    v_exp_f32 v45, v45
    v_exp_f32 v46, v46
    v_smfmac_f32_32x32x32_bf16 v[48:63], v[200:203], v[32:39], v2
    v_exp_f32 v47, v47
    v_exp_f32 v16, v16
    v_exp_f32 v17, v17
    v_smfmac_f32_32x32x32_bf16 v[48:63], v[204:207], v[40:47], v2
    v_exp_f32 v18, v18
    v_exp_f32 v19, v19
    v_exp_f32 v20, v20
    v_mfma_f32_32x32x16_bf16 v[32:47], v[108:111], v[8:11], 0
    v_exp_f32 v21, v21
    v_exp_f32 v22, v22
    v_exp_f32 v23, v23
    v_exp_f32 v24, v24
    v_exp_f32 v25, v25
    v_exp_f32 v26, v26
    v_exp_f32 v27, v27
    v_exp_f32 v28, v28
    v_exp_f32 v29, v29
    v_exp_f32 v30, v30
    v_smfmac_f32_32x32x32_bf16 v[48:63], v[208:211], v[16:23], v2
    v_exp_f32 v31, v31
    v_exp_f32 v32, v32
    v_exp_f32 v33, v33
    v_smfmac_f32_32x32x32_bf16 v[48:63], v[212:215], v[24:31], v2
    v_exp_f32 v34, v34
    v_exp_f32 v35, v35
    v_exp_f32 v36, v36
    v_mfma_f32_32x32x16_bf16 v[16:31], v[112:115], v[8:11], 0
    v_exp_f32 v37, v37
    v_exp_f32 v38, v38
    v_exp_f32 v39, v39
    v_exp_f32 v40, v40
    v_exp_f32 v41, v41
    v_exp_f32 v42, v42
    v_exp_f32 v43, v43
    v_exp_f32 v44, v44
    v_exp_f32 v45, v45
    v_exp_f32 v46, v46
    v_smfmac_f32_32x32x32_bf16 v[48:63], v[216:219], v[32:39], v2
    v_exp_f32 v47, v47
    v_exp_f32 v16, v16
    v_exp_f32 v17, v17
    v_smfmac_f32_32x32x32_bf16 v[48:63], v[220:223], v[40:47], v2
    v_exp_f32 v18, v18
    v_exp_f32 v19, v19
    v_exp_f32 v20, v20
    v_mfma_f32_32x32x16_bf16 v[32:47], v[116:119], v[8:11], 0
    v_exp_f32 v21, v21
    v_exp_f32 v22, v22
    v_exp_f32 v23, v23
    v_exp_f32 v24, v24
    v_exp_f32 v25, v25
    v_exp_f32 v26, v26
    v_exp_f32 v27, v27
    v_exp_f32 v28, v28
    v_exp_f32 v29, v29
    v_exp_f32 v30, v30
    v_smfmac_f32_32x32x32_bf16 v[48:63], v[224:227], v[16:23], v2
    v_exp_f32 v31, v31
    v_exp_f32 v32, v32
    v_exp_f32 v33, v33
    v_smfmac_f32_32x32x32_bf16 v[48:63], v[228:231], v[24:31], v2
    v_exp_f32 v34, v34
    v_exp_f32 v35, v35
    v_exp_f32 v36, v36
    v_mfma_f32_32x32x16_bf16 v[16:31], v[120:123], v[8:11], 0
    v_exp_f32 v37, v37
    v_exp_f32 v38, v38
    v_exp_f32 v39, v39
    v_exp_f32 v40, v40
    v_exp_f32 v41, v41
    v_exp_f32 v42, v42
    v_exp_f32 v43, v43
    v_exp_f32 v44, v44
    v_exp_f32 v45, v45
    v_exp_f32 v46, v46
    v_smfmac_f32_32x32x32_bf16 v[48:63], v[232:235], v[32:39], v2
    v_exp_f32 v47, v47
    v_exp_f32 v16, v16
    v_exp_f32 v17, v17
    v_smfmac_f32_32x32x32_bf16 v[48:63], v[236:239], v[40:47], v2
    v_exp_f32 v18, v18
    v_exp_f32 v19, v19
    v_exp_f32 v20, v20
    v_mfma_f32_32x32x16_bf16 v[32:47], v[124:127], v[8:11], 0
    v_exp_f32 v21, v21
    ds_read_b128 v[8:11], v15 offset:5120
    v_exp_f32 v22, v22
    v_exp_f32 v23, v23
    v_exp_f32 v24, v24
    v_exp_f32 v25, v25
    v_exp_f32 v26, v26
    v_exp_f32 v27, v27
    v_exp_f32 v28, v28
    v_exp_f32 v29, v29
    v_exp_f32 v30, v30
    v_smfmac_f32_32x32x32_bf16 v[48:63], v[240:243], v[16:23], v2
    v_exp_f32 v31, v31
    v_exp_f32 v32, v32
    v_exp_f32 v33, v33
    v_smfmac_f32_32x32x32_bf16 v[48:63], v[244:247], v[24:31], v2
    v_exp_f32 v34, v34
    v_exp_f32 v35, v35
    v_exp_f32 v36, v36
    s_waitcnt lgkmcnt(0)
    v_mfma_f32_32x32x16_bf16 v[16:31], v[64:67], v[8:11], 0
    v_exp_f32 v37, v37
    v_exp_f32 v38, v38
    v_exp_f32 v39, v39
    v_exp_f32 v40, v40
    v_exp_f32 v41, v41
    v_exp_f32 v42, v42
    v_exp_f32 v43, v43
    v_exp_f32 v44, v44
    v_exp_f32 v45, v45
    v_exp_f32 v46, v46
    v_smfmac_f32_32x32x32_bf16 v[48:63], v[248:251], v[32:39], v2
    v_exp_f32 v47, v47
    v_exp_f32 v16, v16
    v_exp_f32 v17, v17
    v_smfmac_f32_32x32x32_bf16 v[48:63], v[252:255], v[40:47], v2
    v_exp_f32 v18, v18
    v_exp_f32 v19, v19
    v_exp_f32 v20, v20
    v_mfma_f32_32x32x16_bf16 v[32:47], v[68:71], v[8:11], 0
    v_exp_f32 v21, v21
    v_exp_f32 v22, v22
    v_exp_f32 v23, v23
    v_exp_f32 v24, v24
    v_exp_f32 v25, v25
    v_exp_f32 v26, v26
    v_exp_f32 v27, v27
    v_exp_f32 v28, v28
    ds_write_b128 v1, v[48:51] offset:32768
    v_exp_f32 v29, v29
    ds_write_b128 v1, v[52:55] offset:33792
    v_exp_f32 v30, v30
    ds_write_b32 v3, v56 offset:4096
    v_mfma_f32_32x32x8_bf16 v[48:63], v[4:5], v[4:5], 0
    v_exp_f32 v31, v31
    v_exp_f32 v32, v32
    v_exp_f32 v33, v33
    v_smfmac_f32_32x32x32_bf16 v[48:63], v[128:131], v[16:23], v2
    v_exp_f32 v34, v34
    v_exp_f32 v35, v35
    v_exp_f32 v36, v36
    v_smfmac_f32_32x32x32_bf16 v[48:63], v[132:135], v[24:31], v2
    v_exp_f32 v37, v37
    v_exp_f32 v38, v38
    v_exp_f32 v39, v39
    v_mfma_f32_32x32x16_bf16 v[16:31], v[72:75], v[8:11], 0
    v_exp_f32 v40, v40
    v_exp_f32 v41, v41
    v_exp_f32 v42, v42
    v_exp_f32 v43, v43
    v_smfmac_f32_32x32x32_bf16 v[48:63], v[136:139], v[32:39], v2
    v_exp_f32 v44, v44
    v_exp_f32 v45, v45
    v_exp_f32 v46, v46
    v_exp_f32 v47, v47
    s_nop 2
    v_exp_f32 v16, v16
    v_exp_f32 v17, v17
    v_smfmac_f32_32x32x32_bf16 v[48:63], v[140:143], v[40:47], v2
    v_exp_f32 v18, v18
    v_exp_f32 v19, v19
    v_exp_f32 v20, v20
    v_mfma_f32_32x32x16_bf16 v[32:47], v[76:79], v[8:11], 0
    v_exp_f32 v21, v21
    v_exp_f32 v22, v22
    v_exp_f32 v23, v23
    v_exp_f32 v24, v24
    v_exp_f32 v25, v25
    v_exp_f32 v26, v26
    v_exp_f32 v27, v27
    v_exp_f32 v28, v28
    v_exp_f32 v29, v29
    v_exp_f32 v30, v30
    v_smfmac_f32_32x32x32_bf16 v[48:63], v[144:147], v[16:23], v2
    v_exp_f32 v31, v31
    v_exp_f32 v32, v32
    v_exp_f32 v33, v33
    v_smfmac_f32_32x32x32_bf16 v[48:63], v[148:151], v[24:31], v2
    v_exp_f32 v34, v34
    v_exp_f32 v35, v35
    v_exp_f32 v36, v36
    v_mfma_f32_32x32x16_bf16 v[16:31], v[80:83], v[8:11], 0
    v_exp_f32 v37, v37
    v_exp_f32 v38, v38
    v_exp_f32 v39, v39
    v_exp_f32 v40, v40
    v_exp_f32 v41, v41
    v_exp_f32 v42, v42
    v_exp_f32 v43, v43
    v_exp_f32 v44, v44
    v_exp_f32 v45, v45
    v_exp_f32 v46, v46
    v_smfmac_f32_32x32x32_bf16 v[48:63], v[152:155], v[32:39], v2
    v_exp_f32 v47, v47
    v_exp_f32 v16, v16
    v_exp_f32 v17, v17
    v_smfmac_f32_32x32x32_bf16 v[48:63], v[156:159], v[40:47], v2
    v_exp_f32 v18, v18
    v_exp_f32 v19, v19
    v_exp_f32 v20, v20
    v_mfma_f32_32x32x16_bf16 v[32:47], v[84:87], v[8:11], 0
    v_exp_f32 v21, v21
    v_exp_f32 v22, v22
    v_exp_f32 v23, v23
    v_exp_f32 v24, v24
    v_exp_f32 v25, v25
    v_exp_f32 v26, v26
    v_exp_f32 v27, v27
    v_exp_f32 v28, v28
    v_exp_f32 v29, v29
    v_exp_f32 v30, v30
    v_smfmac_f32_32x32x32_bf16 v[48:63], v[160:163], v[16:23], v2
    v_exp_f32 v31, v31
    v_exp_f32 v32, v32
    v_exp_f32 v33, v33
    v_smfmac_f32_32x32x32_bf16 v[48:63], v[164:167], v[24:31], v2
    v_exp_f32 v34, v34
    v_exp_f32 v35, v35
    v_exp_f32 v36, v36
    v_mfma_f32_32x32x16_bf16 v[16:31], v[88:91], v[8:11], 0
    v_exp_f32 v37, v37
    v_exp_f32 v38, v38
    v_exp_f32 v39, v39
    v_exp_f32 v40, v40
    v_exp_f32 v41, v41
    v_exp_f32 v42, v42
    v_exp_f32 v43, v43
    v_exp_f32 v44, v44
    v_exp_f32 v45, v45
    v_exp_f32 v46, v46
    v_smfmac_f32_32x32x32_bf16 v[48:63], v[168:171], v[32:39], v2
    v_exp_f32 v47, v47
    v_exp_f32 v16, v16
    v_exp_f32 v17, v17
    v_smfmac_f32_32x32x32_bf16 v[48:63], v[172:175], v[40:47], v2
    v_exp_f32 v18, v18
    v_exp_f32 v19, v19
    v_exp_f32 v20, v20
    v_mfma_f32_32x32x16_bf16 v[32:47], v[92:95], v[8:11], 0
    v_exp_f32 v21, v21
    v_exp_f32 v22, v22
    v_exp_f32 v23, v23
    v_exp_f32 v24, v24
    v_exp_f32 v25, v25
    v_exp_f32 v26, v26
    v_exp_f32 v27, v27
    v_exp_f32 v28, v28
    v_exp_f32 v29, v29
    v_exp_f32 v30, v30
    v_smfmac_f32_32x32x32_bf16 v[48:63], v[176:179], v[16:23], v2
    v_exp_f32 v31, v31
    v_exp_f32 v32, v32
    v_exp_f32 v33, v33
    v_smfmac_f32_32x32x32_bf16 v[48:63], v[180:183], v[24:31], v2
    v_exp_f32 v34, v34
    v_exp_f32 v35, v35
    v_exp_f32 v36, v36
    v_mfma_f32_32x32x16_bf16 v[16:31], v[96:99], v[8:11], 0
    v_exp_f32 v37, v37
    v_exp_f32 v38, v38
    v_exp_f32 v39, v39
    v_exp_f32 v40, v40
    v_exp_f32 v41, v41
    v_exp_f32 v42, v42
    v_exp_f32 v43, v43
    v_exp_f32 v44, v44
    v_exp_f32 v45, v45
    v_exp_f32 v46, v46
    v_smfmac_f32_32x32x32_bf16 v[48:63], v[184:187], v[32:39], v2
    v_exp_f32 v47, v47
    v_exp_f32 v16, v16
    v_exp_f32 v17, v17
    v_smfmac_f32_32x32x32_bf16 v[48:63], v[188:191], v[40:47], v2
    v_exp_f32 v18, v18
    v_exp_f32 v19, v19
    v_exp_f32 v20, v20
    v_mfma_f32_32x32x16_bf16 v[32:47], v[100:103], v[8:11], 0
    v_exp_f32 v21, v21
    v_exp_f32 v22, v22
    v_exp_f32 v23, v23
    v_exp_f32 v24, v24
    v_exp_f32 v25, v25
    v_exp_f32 v26, v26
    v_exp_f32 v27, v27
    v_exp_f32 v28, v28
    v_exp_f32 v29, v29
    v_exp_f32 v30, v30
    v_smfmac_f32_32x32x32_bf16 v[48:63], v[192:195], v[16:23], v2
    v_exp_f32 v31, v31
    v_exp_f32 v32, v32
    v_exp_f32 v33, v33
    v_smfmac_f32_32x32x32_bf16 v[48:63], v[196:199], v[24:31], v2
    v_exp_f32 v34, v34
    v_exp_f32 v35, v35
    v_exp_f32 v36, v36
    v_mfma_f32_32x32x16_bf16 v[16:31], v[104:107], v[8:11], 0
    v_exp_f32 v37, v37
    v_exp_f32 v38, v38
    v_exp_f32 v39, v39
    v_exp_f32 v40, v40
    v_exp_f32 v41, v41
    v_exp_f32 v42, v42
    v_exp_f32 v43, v43
    v_exp_f32 v44, v44
    v_exp_f32 v45, v45
    v_exp_f32 v46, v46
    v_smfmac_f32_32x32x32_bf16 v[48:63], v[200:203], v[32:39], v2
    v_exp_f32 v47, v47
    v_exp_f32 v16, v16
    v_exp_f32 v17, v17
    v_smfmac_f32_32x32x32_bf16 v[48:63], v[204:207], v[40:47], v2
    v_exp_f32 v18, v18
    v_exp_f32 v19, v19
    v_exp_f32 v20, v20
    v_mfma_f32_32x32x16_bf16 v[32:47], v[108:111], v[8:11], 0
    v_exp_f32 v21, v21
    v_exp_f32 v22, v22
    v_exp_f32 v23, v23
    v_exp_f32 v24, v24
    v_exp_f32 v25, v25
    v_exp_f32 v26, v26
    v_exp_f32 v27, v27
    v_exp_f32 v28, v28
    v_exp_f32 v29, v29
    v_exp_f32 v30, v30
    v_smfmac_f32_32x32x32_bf16 v[48:63], v[208:211], v[16:23], v2
    v_exp_f32 v31, v31
    v_exp_f32 v32, v32
    v_exp_f32 v33, v33
    v_smfmac_f32_32x32x32_bf16 v[48:63], v[212:215], v[24:31], v2
    v_exp_f32 v34, v34
    v_exp_f32 v35, v35
    v_exp_f32 v36, v36
    v_mfma_f32_32x32x16_bf16 v[16:31], v[112:115], v[8:11], 0
    v_exp_f32 v37, v37
    v_exp_f32 v38, v38
    v_exp_f32 v39, v39
    v_exp_f32 v40, v40
    v_exp_f32 v41, v41
    v_exp_f32 v42, v42
    v_exp_f32 v43, v43
    v_exp_f32 v44, v44
    v_exp_f32 v45, v45
    v_exp_f32 v46, v46
    v_smfmac_f32_32x32x32_bf16 v[48:63], v[216:219], v[32:39], v2
    v_exp_f32 v47, v47
    v_exp_f32 v16, v16
    v_exp_f32 v17, v17
    v_smfmac_f32_32x32x32_bf16 v[48:63], v[220:223], v[40:47], v2
    v_exp_f32 v18, v18
    v_exp_f32 v19, v19
    v_exp_f32 v20, v20
    v_mfma_f32_32x32x16_bf16 v[32:47], v[116:119], v[8:11], 0
    v_exp_f32 v21, v21
    v_exp_f32 v22, v22
    v_exp_f32 v23, v23
    v_exp_f32 v24, v24
    v_exp_f32 v25, v25
    v_exp_f32 v26, v26
    v_exp_f32 v27, v27
    v_exp_f32 v28, v28
    v_exp_f32 v29, v29
    v_exp_f32 v30, v30
    v_smfmac_f32_32x32x32_bf16 v[48:63], v[224:227], v[16:23], v2
    v_exp_f32 v31, v31
    v_exp_f32 v32, v32
    v_exp_f32 v33, v33
    v_smfmac_f32_32x32x32_bf16 v[48:63], v[228:231], v[24:31], v2
    v_exp_f32 v34, v34
    v_exp_f32 v35, v35
    v_exp_f32 v36, v36
    v_mfma_f32_32x32x16_bf16 v[16:31], v[120:123], v[8:11], 0
    v_exp_f32 v37, v37
    v_exp_f32 v38, v38
    v_exp_f32 v39, v39
    v_exp_f32 v40, v40
    v_exp_f32 v41, v41
    v_exp_f32 v42, v42
    v_exp_f32 v43, v43
    v_exp_f32 v44, v44
    v_exp_f32 v45, v45
    v_exp_f32 v46, v46
    v_smfmac_f32_32x32x32_bf16 v[48:63], v[232:235], v[32:39], v2
    v_exp_f32 v47, v47
    v_exp_f32 v16, v16
    v_exp_f32 v17, v17
    v_smfmac_f32_32x32x32_bf16 v[48:63], v[236:239], v[40:47], v2
    v_exp_f32 v18, v18
    v_exp_f32 v19, v19
    v_exp_f32 v20, v20
    v_mfma_f32_32x32x16_bf16 v[32:47], v[124:127], v[8:11], 0
    v_exp_f32 v21, v21
    ds_read_b128 v[8:11], v15 offset:6144
    v_exp_f32 v22, v22
    v_exp_f32 v23, v23
    v_exp_f32 v24, v24
    v_exp_f32 v25, v25
    v_exp_f32 v26, v26
    v_exp_f32 v27, v27
    v_exp_f32 v28, v28
    v_exp_f32 v29, v29
    v_exp_f32 v30, v30
    v_smfmac_f32_32x32x32_bf16 v[48:63], v[240:243], v[16:23], v2
    v_exp_f32 v31, v31
    v_exp_f32 v32, v32
    v_exp_f32 v33, v33
    v_smfmac_f32_32x32x32_bf16 v[48:63], v[244:247], v[24:31], v2
    v_exp_f32 v34, v34
    v_exp_f32 v35, v35
    v_exp_f32 v36, v36
    s_waitcnt lgkmcnt(0)
    v_mfma_f32_32x32x16_bf16 v[16:31], v[64:67], v[8:11], 0
    v_exp_f32 v37, v37
    v_exp_f32 v38, v38
    v_exp_f32 v39, v39
    v_exp_f32 v40, v40
    v_exp_f32 v41, v41
    v_exp_f32 v42, v42
    v_exp_f32 v43, v43
    v_exp_f32 v44, v44
    v_exp_f32 v45, v45
    v_exp_f32 v46, v46
    v_smfmac_f32_32x32x32_bf16 v[48:63], v[248:251], v[32:39], v2
    v_exp_f32 v47, v47
    v_exp_f32 v16, v16
    v_exp_f32 v17, v17
    v_smfmac_f32_32x32x32_bf16 v[48:63], v[252:255], v[40:47], v2
    v_exp_f32 v18, v18
    v_exp_f32 v19, v19
    v_exp_f32 v20, v20
    v_mfma_f32_32x32x16_bf16 v[32:47], v[68:71], v[8:11], 0
    v_exp_f32 v21, v21
    v_exp_f32 v22, v22
    v_exp_f32 v23, v23
    v_exp_f32 v24, v24
    v_exp_f32 v25, v25
    v_exp_f32 v26, v26
    v_exp_f32 v27, v27
    v_exp_f32 v28, v28
    ds_write_b128 v1, v[48:51] offset:40960
    v_exp_f32 v29, v29
    ds_write_b128 v1, v[52:55] offset:41984
    v_exp_f32 v30, v30
    ds_write_b32 v3, v56 offset:5120
    v_mfma_f32_32x32x8_bf16 v[48:63], v[4:5], v[4:5], 0
    v_exp_f32 v31, v31
    v_exp_f32 v32, v32
    v_exp_f32 v33, v33
    v_smfmac_f32_32x32x32_bf16 v[48:63], v[128:131], v[16:23], v2
    v_exp_f32 v34, v34
    v_exp_f32 v35, v35
    v_exp_f32 v36, v36
    v_smfmac_f32_32x32x32_bf16 v[48:63], v[132:135], v[24:31], v2
    v_exp_f32 v37, v37
    v_exp_f32 v38, v38
    v_exp_f32 v39, v39
    v_mfma_f32_32x32x16_bf16 v[16:31], v[72:75], v[8:11], 0
    v_exp_f32 v40, v40
    v_exp_f32 v41, v41
    v_exp_f32 v42, v42
    v_exp_f32 v43, v43
    v_smfmac_f32_32x32x32_bf16 v[48:63], v[136:139], v[32:39], v2
    v_exp_f32 v44, v44
    v_exp_f32 v45, v45
    v_exp_f32 v46, v46
    v_exp_f32 v47, v47
    s_nop 2
    v_exp_f32 v16, v16
    v_exp_f32 v17, v17
    v_smfmac_f32_32x32x32_bf16 v[48:63], v[140:143], v[40:47], v2
    v_exp_f32 v18, v18
    v_exp_f32 v19, v19
    v_exp_f32 v20, v20
    v_mfma_f32_32x32x16_bf16 v[32:47], v[76:79], v[8:11], 0
    v_exp_f32 v21, v21
    v_exp_f32 v22, v22
    v_exp_f32 v23, v23
    v_exp_f32 v24, v24
    v_exp_f32 v25, v25
    v_exp_f32 v26, v26
    v_exp_f32 v27, v27
    v_exp_f32 v28, v28
    v_exp_f32 v29, v29
    v_exp_f32 v30, v30
    v_smfmac_f32_32x32x32_bf16 v[48:63], v[144:147], v[16:23], v2
    v_exp_f32 v31, v31
    v_exp_f32 v32, v32
    v_exp_f32 v33, v33
    v_smfmac_f32_32x32x32_bf16 v[48:63], v[148:151], v[24:31], v2
    v_exp_f32 v34, v34
    v_exp_f32 v35, v35
    v_exp_f32 v36, v36
    v_mfma_f32_32x32x16_bf16 v[16:31], v[80:83], v[8:11], 0
    v_exp_f32 v37, v37
    v_exp_f32 v38, v38
    v_exp_f32 v39, v39
    v_exp_f32 v40, v40
    v_exp_f32 v41, v41
    v_exp_f32 v42, v42
    v_exp_f32 v43, v43
    v_exp_f32 v44, v44
    v_exp_f32 v45, v45
    v_exp_f32 v46, v46
    v_smfmac_f32_32x32x32_bf16 v[48:63], v[152:155], v[32:39], v2
    v_exp_f32 v47, v47
    v_exp_f32 v16, v16
    v_exp_f32 v17, v17
    v_smfmac_f32_32x32x32_bf16 v[48:63], v[156:159], v[40:47], v2
    v_exp_f32 v18, v18
    v_exp_f32 v19, v19
    v_exp_f32 v20, v20
    v_mfma_f32_32x32x16_bf16 v[32:47], v[84:87], v[8:11], 0
    v_exp_f32 v21, v21
    v_exp_f32 v22, v22
    v_exp_f32 v23, v23
    v_exp_f32 v24, v24
    v_exp_f32 v25, v25
    v_exp_f32 v26, v26
    v_exp_f32 v27, v27
    v_exp_f32 v28, v28
    v_exp_f32 v29, v29
    v_exp_f32 v30, v30
    v_smfmac_f32_32x32x32_bf16 v[48:63], v[160:163], v[16:23], v2
    v_exp_f32 v31, v31
    v_exp_f32 v32, v32
    v_exp_f32 v33, v33
    v_smfmac_f32_32x32x32_bf16 v[48:63], v[164:167], v[24:31], v2
    v_exp_f32 v34, v34
    v_exp_f32 v35, v35
    v_exp_f32 v36, v36
    v_mfma_f32_32x32x16_bf16 v[16:31], v[88:91], v[8:11], 0
    v_exp_f32 v37, v37
    v_exp_f32 v38, v38
    v_exp_f32 v39, v39
    v_exp_f32 v40, v40
    v_exp_f32 v41, v41
    v_exp_f32 v42, v42
    v_exp_f32 v43, v43
    v_exp_f32 v44, v44
    v_exp_f32 v45, v45
    v_exp_f32 v46, v46
    v_smfmac_f32_32x32x32_bf16 v[48:63], v[168:171], v[32:39], v2
    v_exp_f32 v47, v47
    v_exp_f32 v16, v16
    v_exp_f32 v17, v17
    v_smfmac_f32_32x32x32_bf16 v[48:63], v[172:175], v[40:47], v2
    v_exp_f32 v18, v18
    v_exp_f32 v19, v19
    v_exp_f32 v20, v20
    v_mfma_f32_32x32x16_bf16 v[32:47], v[92:95], v[8:11], 0
    v_exp_f32 v21, v21
    v_exp_f32 v22, v22
    v_exp_f32 v23, v23
    v_exp_f32 v24, v24
    v_exp_f32 v25, v25
    v_exp_f32 v26, v26
    v_exp_f32 v27, v27
    v_exp_f32 v28, v28
    v_exp_f32 v29, v29
    v_exp_f32 v30, v30
    v_smfmac_f32_32x32x32_bf16 v[48:63], v[176:179], v[16:23], v2
    v_exp_f32 v31, v31
    v_exp_f32 v32, v32
    v_exp_f32 v33, v33
    v_smfmac_f32_32x32x32_bf16 v[48:63], v[180:183], v[24:31], v2
    v_exp_f32 v34, v34
    v_exp_f32 v35, v35
    v_exp_f32 v36, v36
    v_mfma_f32_32x32x16_bf16 v[16:31], v[96:99], v[8:11], 0
    v_exp_f32 v37, v37
    v_exp_f32 v38, v38
    v_exp_f32 v39, v39
    v_exp_f32 v40, v40
    v_exp_f32 v41, v41
    v_exp_f32 v42, v42
    v_exp_f32 v43, v43
    v_exp_f32 v44, v44
    v_exp_f32 v45, v45
    v_exp_f32 v46, v46
    v_smfmac_f32_32x32x32_bf16 v[48:63], v[184:187], v[32:39], v2
    v_exp_f32 v47, v47
    v_exp_f32 v16, v16
    v_exp_f32 v17, v17
    v_smfmac_f32_32x32x32_bf16 v[48:63], v[188:191], v[40:47], v2
    v_exp_f32 v18, v18
    v_exp_f32 v19, v19
    v_exp_f32 v20, v20
    v_mfma_f32_32x32x16_bf16 v[32:47], v[100:103], v[8:11], 0
    v_exp_f32 v21, v21
    v_exp_f32 v22, v22
    v_exp_f32 v23, v23
    v_exp_f32 v24, v24
    v_exp_f32 v25, v25
    v_exp_f32 v26, v26
    v_exp_f32 v27, v27
    v_exp_f32 v28, v28
    v_exp_f32 v29, v29
    v_exp_f32 v30, v30
    v_smfmac_f32_32x32x32_bf16 v[48:63], v[192:195], v[16:23], v2
    v_exp_f32 v31, v31
    v_exp_f32 v32, v32
    v_exp_f32 v33, v33
    v_smfmac_f32_32x32x32_bf16 v[48:63], v[196:199], v[24:31], v2
    v_exp_f32 v34, v34
    v_exp_f32 v35, v35
    v_exp_f32 v36, v36
    v_mfma_f32_32x32x16_bf16 v[16:31], v[104:107], v[8:11], 0
    v_exp_f32 v37, v37
    v_exp_f32 v38, v38
    v_exp_f32 v39, v39
    v_exp_f32 v40, v40
    v_exp_f32 v41, v41
    v_exp_f32 v42, v42
    v_exp_f32 v43, v43
    v_exp_f32 v44, v44
    v_exp_f32 v45, v45
    v_exp_f32 v46, v46
    v_smfmac_f32_32x32x32_bf16 v[48:63], v[200:203], v[32:39], v2
    v_exp_f32 v47, v47
    v_exp_f32 v16, v16
    v_exp_f32 v17, v17
    v_smfmac_f32_32x32x32_bf16 v[48:63], v[204:207], v[40:47], v2
    v_exp_f32 v18, v18
    v_exp_f32 v19, v19
    v_exp_f32 v20, v20
    v_mfma_f32_32x32x16_bf16 v[32:47], v[108:111], v[8:11], 0
    v_exp_f32 v21, v21
    v_exp_f32 v22, v22
    v_exp_f32 v23, v23
    v_exp_f32 v24, v24
    v_exp_f32 v25, v25
    v_exp_f32 v26, v26
    v_exp_f32 v27, v27
    v_exp_f32 v28, v28
    v_exp_f32 v29, v29
    v_exp_f32 v30, v30
    v_smfmac_f32_32x32x32_bf16 v[48:63], v[208:211], v[16:23], v2
    v_exp_f32 v31, v31
    v_exp_f32 v32, v32
    v_exp_f32 v33, v33
    v_smfmac_f32_32x32x32_bf16 v[48:63], v[212:215], v[24:31], v2
    v_exp_f32 v34, v34
    v_exp_f32 v35, v35
    v_exp_f32 v36, v36
    v_mfma_f32_32x32x16_bf16 v[16:31], v[112:115], v[8:11], 0
    v_exp_f32 v37, v37
    v_exp_f32 v38, v38
    v_exp_f32 v39, v39
    v_exp_f32 v40, v40
    v_exp_f32 v41, v41
    v_exp_f32 v42, v42
    v_exp_f32 v43, v43
    v_exp_f32 v44, v44
    v_exp_f32 v45, v45
    v_exp_f32 v46, v46
    v_smfmac_f32_32x32x32_bf16 v[48:63], v[216:219], v[32:39], v2
    v_exp_f32 v47, v47
    v_exp_f32 v16, v16
    v_exp_f32 v17, v17
    v_smfmac_f32_32x32x32_bf16 v[48:63], v[220:223], v[40:47], v2
    v_exp_f32 v18, v18
    v_exp_f32 v19, v19
    v_exp_f32 v20, v20
    v_mfma_f32_32x32x16_bf16 v[32:47], v[116:119], v[8:11], 0
    v_exp_f32 v21, v21
    v_exp_f32 v22, v22
    v_exp_f32 v23, v23
    v_exp_f32 v24, v24
    v_exp_f32 v25, v25
    v_exp_f32 v26, v26
    v_exp_f32 v27, v27
    v_exp_f32 v28, v28
    v_exp_f32 v29, v29
    v_exp_f32 v30, v30
    v_smfmac_f32_32x32x32_bf16 v[48:63], v[224:227], v[16:23], v2
    v_exp_f32 v31, v31
    v_exp_f32 v32, v32
    v_exp_f32 v33, v33
    v_smfmac_f32_32x32x32_bf16 v[48:63], v[228:231], v[24:31], v2
    v_exp_f32 v34, v34
    v_exp_f32 v35, v35
    v_exp_f32 v36, v36
    v_mfma_f32_32x32x16_bf16 v[16:31], v[120:123], v[8:11], 0
    v_exp_f32 v37, v37
    v_exp_f32 v38, v38
    v_exp_f32 v39, v39
    v_exp_f32 v40, v40
    v_exp_f32 v41, v41
    v_exp_f32 v42, v42
    v_exp_f32 v43, v43
    v_exp_f32 v44, v44
    v_exp_f32 v45, v45
    v_exp_f32 v46, v46
    v_smfmac_f32_32x32x32_bf16 v[48:63], v[232:235], v[32:39], v2
    v_exp_f32 v47, v47
    v_exp_f32 v16, v16
    v_exp_f32 v17, v17
    v_smfmac_f32_32x32x32_bf16 v[48:63], v[236:239], v[40:47], v2
    v_exp_f32 v18, v18
    v_exp_f32 v19, v19
    v_exp_f32 v20, v20
    v_mfma_f32_32x32x16_bf16 v[32:47], v[124:127], v[8:11], 0
    v_exp_f32 v21, v21
    ds_read_b128 v[8:11], v15 offset:7168
    v_exp_f32 v22, v22
    v_exp_f32 v23, v23
    v_exp_f32 v24, v24
    v_exp_f32 v25, v25
    v_exp_f32 v26, v26
    v_exp_f32 v27, v27
    v_exp_f32 v28, v28
    v_exp_f32 v29, v29
    v_exp_f32 v30, v30
    v_smfmac_f32_32x32x32_bf16 v[48:63], v[240:243], v[16:23], v2
    v_exp_f32 v31, v31
    v_exp_f32 v32, v32
    v_exp_f32 v33, v33
    v_smfmac_f32_32x32x32_bf16 v[48:63], v[244:247], v[24:31], v2
    v_exp_f32 v34, v34
    v_exp_f32 v35, v35
    v_exp_f32 v36, v36
    s_waitcnt lgkmcnt(0)
    v_mfma_f32_32x32x16_bf16 v[16:31], v[64:67], v[8:11], 0
    v_exp_f32 v37, v37
    v_exp_f32 v38, v38
    v_exp_f32 v39, v39
    v_exp_f32 v40, v40
    v_exp_f32 v41, v41
    v_exp_f32 v42, v42
    v_exp_f32 v43, v43
    v_exp_f32 v44, v44
    v_exp_f32 v45, v45
    v_exp_f32 v46, v46
    v_smfmac_f32_32x32x32_bf16 v[48:63], v[248:251], v[32:39], v2
    v_exp_f32 v47, v47
    v_exp_f32 v16, v16
    v_exp_f32 v17, v17
    v_smfmac_f32_32x32x32_bf16 v[48:63], v[252:255], v[40:47], v2
    v_exp_f32 v18, v18
    v_exp_f32 v19, v19
    v_exp_f32 v20, v20
    v_mfma_f32_32x32x16_bf16 v[32:47], v[68:71], v[8:11], 0
    v_exp_f32 v21, v21
    v_exp_f32 v22, v22
    v_exp_f32 v23, v23
    v_exp_f32 v24, v24
    v_exp_f32 v25, v25
    v_exp_f32 v26, v26
    v_exp_f32 v27, v27
    v_exp_f32 v28, v28
    ds_write_b128 v1, v[48:51] offset:49152
    v_exp_f32 v29, v29
    ds_write_b128 v1, v[52:55] offset:50176
    v_exp_f32 v30, v30
    ds_write_b32 v3, v56 offset:6144
    v_mfma_f32_32x32x8_bf16 v[48:63], v[4:5], v[4:5], 0
    v_exp_f32 v31, v31
    v_exp_f32 v32, v32
    v_exp_f32 v33, v33
    v_smfmac_f32_32x32x32_bf16 v[48:63], v[128:131], v[16:23], v2
    v_exp_f32 v34, v34
    v_exp_f32 v35, v35
    v_exp_f32 v36, v36
    v_smfmac_f32_32x32x32_bf16 v[48:63], v[132:135], v[24:31], v2
    v_exp_f32 v37, v37
    v_exp_f32 v38, v38
    v_exp_f32 v39, v39
    v_mfma_f32_32x32x16_bf16 v[16:31], v[72:75], v[8:11], 0
    v_exp_f32 v40, v40
    v_exp_f32 v41, v41
    v_exp_f32 v42, v42
    v_exp_f32 v43, v43
    v_smfmac_f32_32x32x32_bf16 v[48:63], v[136:139], v[32:39], v2
    v_exp_f32 v44, v44
    v_exp_f32 v45, v45
    v_exp_f32 v46, v46
    v_exp_f32 v47, v47
    s_nop 2
    v_exp_f32 v16, v16
    v_exp_f32 v17, v17
    v_smfmac_f32_32x32x32_bf16 v[48:63], v[140:143], v[40:47], v2
    v_exp_f32 v18, v18
    v_exp_f32 v19, v19
    v_exp_f32 v20, v20
    v_mfma_f32_32x32x16_bf16 v[32:47], v[76:79], v[8:11], 0
    v_exp_f32 v21, v21
    v_exp_f32 v22, v22
    v_exp_f32 v23, v23
    v_exp_f32 v24, v24
    v_exp_f32 v25, v25
    v_exp_f32 v26, v26
    v_exp_f32 v27, v27
    v_exp_f32 v28, v28
    v_exp_f32 v29, v29
    v_exp_f32 v30, v30
    v_smfmac_f32_32x32x32_bf16 v[48:63], v[144:147], v[16:23], v2
    v_exp_f32 v31, v31
    v_exp_f32 v32, v32
    v_exp_f32 v33, v33
    v_smfmac_f32_32x32x32_bf16 v[48:63], v[148:151], v[24:31], v2
    v_exp_f32 v34, v34
    v_exp_f32 v35, v35
    v_exp_f32 v36, v36
    v_mfma_f32_32x32x16_bf16 v[16:31], v[80:83], v[8:11], 0
    v_exp_f32 v37, v37
    v_exp_f32 v38, v38
    v_exp_f32 v39, v39
    v_exp_f32 v40, v40
    v_exp_f32 v41, v41
    v_exp_f32 v42, v42
    v_exp_f32 v43, v43
    v_exp_f32 v44, v44
    v_exp_f32 v45, v45
    v_exp_f32 v46, v46
    v_smfmac_f32_32x32x32_bf16 v[48:63], v[152:155], v[32:39], v2
    v_exp_f32 v47, v47
    v_exp_f32 v16, v16
    v_exp_f32 v17, v17
    v_smfmac_f32_32x32x32_bf16 v[48:63], v[156:159], v[40:47], v2
    v_exp_f32 v18, v18
    v_exp_f32 v19, v19
    v_exp_f32 v20, v20
    v_mfma_f32_32x32x16_bf16 v[32:47], v[84:87], v[8:11], 0
    v_exp_f32 v21, v21
    v_exp_f32 v22, v22
    v_exp_f32 v23, v23
    v_exp_f32 v24, v24
    v_exp_f32 v25, v25
    v_exp_f32 v26, v26
    v_exp_f32 v27, v27
    v_exp_f32 v28, v28
    v_exp_f32 v29, v29
    v_exp_f32 v30, v30
    v_smfmac_f32_32x32x32_bf16 v[48:63], v[160:163], v[16:23], v2
    v_exp_f32 v31, v31
    v_exp_f32 v32, v32
    v_exp_f32 v33, v33
    v_smfmac_f32_32x32x32_bf16 v[48:63], v[164:167], v[24:31], v2
    v_exp_f32 v34, v34
    v_exp_f32 v35, v35
    v_exp_f32 v36, v36
    v_mfma_f32_32x32x16_bf16 v[16:31], v[88:91], v[8:11], 0
    v_exp_f32 v37, v37
    v_exp_f32 v38, v38
    v_exp_f32 v39, v39
    v_exp_f32 v40, v40
    v_exp_f32 v41, v41
    v_exp_f32 v42, v42
    v_exp_f32 v43, v43
    v_exp_f32 v44, v44
    v_exp_f32 v45, v45
    v_exp_f32 v46, v46
    v_smfmac_f32_32x32x32_bf16 v[48:63], v[168:171], v[32:39], v2
    v_exp_f32 v47, v47
    v_exp_f32 v16, v16
    v_exp_f32 v17, v17
    v_smfmac_f32_32x32x32_bf16 v[48:63], v[172:175], v[40:47], v2
    v_exp_f32 v18, v18
    v_exp_f32 v19, v19
    v_exp_f32 v20, v20
    v_mfma_f32_32x32x16_bf16 v[32:47], v[92:95], v[8:11], 0
    v_exp_f32 v21, v21
    v_exp_f32 v22, v22
    v_exp_f32 v23, v23
    v_exp_f32 v24, v24
    v_exp_f32 v25, v25
    v_exp_f32 v26, v26
    v_exp_f32 v27, v27
    v_exp_f32 v28, v28
    v_exp_f32 v29, v29
    v_exp_f32 v30, v30
    v_smfmac_f32_32x32x32_bf16 v[48:63], v[176:179], v[16:23], v2
    v_exp_f32 v31, v31
    v_exp_f32 v32, v32
    v_exp_f32 v33, v33
    v_smfmac_f32_32x32x32_bf16 v[48:63], v[180:183], v[24:31], v2
    v_exp_f32 v34, v34
    v_exp_f32 v35, v35
    v_exp_f32 v36, v36
    v_mfma_f32_32x32x16_bf16 v[16:31], v[96:99], v[8:11], 0
    v_exp_f32 v37, v37
    v_exp_f32 v38, v38
    v_exp_f32 v39, v39
    v_exp_f32 v40, v40
    v_exp_f32 v41, v41
    v_exp_f32 v42, v42
    v_exp_f32 v43, v43
    v_exp_f32 v44, v44
    v_exp_f32 v45, v45
    v_exp_f32 v46, v46
    v_smfmac_f32_32x32x32_bf16 v[48:63], v[184:187], v[32:39], v2
    v_exp_f32 v47, v47
    v_exp_f32 v16, v16
    v_exp_f32 v17, v17
    v_smfmac_f32_32x32x32_bf16 v[48:63], v[188:191], v[40:47], v2
    v_exp_f32 v18, v18
    v_exp_f32 v19, v19
    v_exp_f32 v20, v20
    v_mfma_f32_32x32x16_bf16 v[32:47], v[100:103], v[8:11], 0
    v_exp_f32 v21, v21
    v_exp_f32 v22, v22
    v_exp_f32 v23, v23
    v_exp_f32 v24, v24
    v_exp_f32 v25, v25
    v_exp_f32 v26, v26
    v_exp_f32 v27, v27
    v_exp_f32 v28, v28
    v_exp_f32 v29, v29
    v_exp_f32 v30, v30
    v_smfmac_f32_32x32x32_bf16 v[48:63], v[192:195], v[16:23], v2
    v_exp_f32 v31, v31
    v_exp_f32 v32, v32
    v_exp_f32 v33, v33
    v_smfmac_f32_32x32x32_bf16 v[48:63], v[196:199], v[24:31], v2
    v_exp_f32 v34, v34
    v_exp_f32 v35, v35
    v_exp_f32 v36, v36
    v_mfma_f32_32x32x16_bf16 v[16:31], v[104:107], v[8:11], 0
    v_exp_f32 v37, v37
    v_exp_f32 v38, v38
    v_exp_f32 v39, v39
    v_exp_f32 v40, v40
    v_exp_f32 v41, v41
    v_exp_f32 v42, v42
    v_exp_f32 v43, v43
    v_exp_f32 v44, v44
    v_exp_f32 v45, v45
    v_exp_f32 v46, v46
    v_smfmac_f32_32x32x32_bf16 v[48:63], v[200:203], v[32:39], v2
    v_exp_f32 v47, v47
    v_exp_f32 v16, v16
    v_exp_f32 v17, v17
    v_smfmac_f32_32x32x32_bf16 v[48:63], v[204:207], v[40:47], v2
    v_exp_f32 v18, v18
    v_exp_f32 v19, v19
    v_exp_f32 v20, v20
    v_mfma_f32_32x32x16_bf16 v[32:47], v[108:111], v[8:11], 0
    v_exp_f32 v21, v21
    v_exp_f32 v22, v22
    v_exp_f32 v23, v23
    v_exp_f32 v24, v24
    v_exp_f32 v25, v25
    v_exp_f32 v26, v26
    v_exp_f32 v27, v27
    v_exp_f32 v28, v28
    v_exp_f32 v29, v29
    v_exp_f32 v30, v30
    v_smfmac_f32_32x32x32_bf16 v[48:63], v[208:211], v[16:23], v2
    v_exp_f32 v31, v31
    v_exp_f32 v32, v32
    v_exp_f32 v33, v33
    v_smfmac_f32_32x32x32_bf16 v[48:63], v[212:215], v[24:31], v2
    v_exp_f32 v34, v34
    v_exp_f32 v35, v35
    v_exp_f32 v36, v36
    v_mfma_f32_32x32x16_bf16 v[16:31], v[112:115], v[8:11], 0
    v_exp_f32 v37, v37
    v_exp_f32 v38, v38
    v_exp_f32 v39, v39
    v_exp_f32 v40, v40
    v_exp_f32 v41, v41
    v_exp_f32 v42, v42
    v_exp_f32 v43, v43
    v_exp_f32 v44, v44
    v_exp_f32 v45, v45
    v_exp_f32 v46, v46
    v_smfmac_f32_32x32x32_bf16 v[48:63], v[216:219], v[32:39], v2
    v_exp_f32 v47, v47
    v_exp_f32 v16, v16
    v_exp_f32 v17, v17
    v_smfmac_f32_32x32x32_bf16 v[48:63], v[220:223], v[40:47], v2
    v_exp_f32 v18, v18
    v_exp_f32 v19, v19
    v_exp_f32 v20, v20
    v_mfma_f32_32x32x16_bf16 v[32:47], v[116:119], v[8:11], 0
    v_exp_f32 v21, v21
    v_exp_f32 v22, v22
    v_exp_f32 v23, v23
    v_exp_f32 v24, v24
    v_exp_f32 v25, v25
    v_exp_f32 v26, v26
    v_exp_f32 v27, v27
    v_exp_f32 v28, v28
    v_exp_f32 v29, v29
    v_exp_f32 v30, v30
    v_smfmac_f32_32x32x32_bf16 v[48:63], v[224:227], v[16:23], v2
    v_exp_f32 v31, v31
    v_exp_f32 v32, v32
    v_exp_f32 v33, v33
    v_smfmac_f32_32x32x32_bf16 v[48:63], v[228:231], v[24:31], v2
    v_exp_f32 v34, v34
    v_exp_f32 v35, v35
    v_exp_f32 v36, v36
    v_mfma_f32_32x32x16_bf16 v[16:31], v[120:123], v[8:11], 0
    v_exp_f32 v37, v37
    v_exp_f32 v38, v38
    v_exp_f32 v39, v39
    v_exp_f32 v40, v40
    v_exp_f32 v41, v41
    v_exp_f32 v42, v42
    v_exp_f32 v43, v43
    v_exp_f32 v44, v44
    v_exp_f32 v45, v45
    v_exp_f32 v46, v46
    v_smfmac_f32_32x32x32_bf16 v[48:63], v[232:235], v[32:39], v2
    v_exp_f32 v47, v47
    v_exp_f32 v16, v16
    v_exp_f32 v17, v17
    v_smfmac_f32_32x32x32_bf16 v[48:63], v[236:239], v[40:47], v2
    v_exp_f32 v18, v18
    v_exp_f32 v19, v19
    v_exp_f32 v20, v20
    v_mfma_f32_32x32x16_bf16 v[32:47], v[124:127], v[8:11], 0
    v_exp_f32 v21, v21
    v_exp_f32 v22, v22
    v_exp_f32 v23, v23
    v_exp_f32 v24, v24
    v_exp_f32 v25, v25
    v_exp_f32 v26, v26
    v_exp_f32 v27, v27
    v_exp_f32 v28, v28
    v_exp_f32 v29, v29
    v_exp_f32 v30, v30
    v_smfmac_f32_32x32x32_bf16 v[48:63], v[240:243], v[16:23], v2
    v_exp_f32 v31, v31
    v_exp_f32 v32, v32
    v_exp_f32 v33, v33
    v_smfmac_f32_32x32x32_bf16 v[48:63], v[244:247], v[24:31], v2
    v_exp_f32 v34, v34
    v_exp_f32 v35, v35
    v_exp_f32 v36, v36
    v_exp_f32 v37, v37
    v_exp_f32 v38, v38
    v_exp_f32 v39, v39
    v_exp_f32 v40, v40
    v_exp_f32 v41, v41
    v_exp_f32 v42, v42
    v_exp_f32 v43, v43
    v_exp_f32 v44, v44
    v_exp_f32 v45, v45
    v_exp_f32 v46, v46
    v_smfmac_f32_32x32x32_bf16 v[48:63], v[248:251], v[32:39], v2
    v_exp_f32 v47, v47
    s_nop 1
    v_smfmac_f32_32x32x32_bf16 v[48:63], v[252:255], v[40:47], v2
    s_nop 7
    s_nop 3
    ds_write_b128 v1, v[48:51] offset:57344
    ds_write_b128 v1, v[52:55] offset:58368
    ds_write_b32 v3, v56 offset:7168
    s_waitcnt lgkmcnt(0)
    s_barrier
    s_barrier
    v_mov_b32 v12, 148480
    ds_read_b32 v8, v12
    s_waitcnt lgkmcnt(0)
    v_readfirstlane_b32 s48, v8
    s_cmp_eq_u32 s48, 0
    s_cbranch_scc1 K_END
    s_load_dwordx2 s[64:65], s[0:1], 0
    s_load_dwordx4 s[8:11], s[0:1], 16
    s_mov_b32 s63, 0
    s_waitcnt lgkmcnt(0)
FBK_A:
    s_lshr_b32 s60, s63, 3
    s_and_b32 s61, s63, 7
    v_lshrrev_b32 v16, 4, v6
    v_and_b32 v17, 15, v6
    v_xor_b32 v18, v17, v16
    s_lshl_b32 s28, s60, 16
    s_and_b32 s29, s61, 6
    s_lshl_b32 s29, s29, 13
    s_add_u32 s28, s28, s29
    s_lshl_b32 s29, s3, 8
    s_add_u32 s28, s28, s29
    v_lshl_add_u32 v20, v16, 10, s28
    s_mul_i32 s31, s3, 36864
    v_lshl_add_u32 v17, v17, 8, s31
    v_xor_b32 v19, 0, v18
    v_lshl_add_u32 v24, v19, 4, v20
    v_lshl_add_u32 v28, v19, 4, v17
    v_xor_b32 v19, 4, v18
    v_lshl_add_u32 v25, v19, 4, v20
    v_lshl_add_u32 v29, v19, 4, v17
    v_add_u32 v25, 3072, v25
    v_xor_b32 v19, 8, v18
    v_lshl_add_u32 v26, v19, 4, v20
    v_lshl_add_u32 v30, v19, 4, v17
    v_add_u32 v26, 6144, v26
    v_xor_b32 v19, 12, v18
    v_lshl_add_u32 v27, v19, 4, v20
    v_lshl_add_u32 v31, v19, 4, v17
    v_add_u32 v27, 9216, v27
    v_bfe_u32 v17, v6, 2, 2
    v_lshl_add_u32 v17, v16, 3, v17
    v_lshl_add_u32 v17, v17, 5, s31
    v_and_b32 v19, 3, v6
    v_lshl_add_u32 v20, v19, 3, v17
    s_lshl_b32 s28, s3, 10
    s_cmp_eq_u32 s3, 3
    s_cselect_b32 s28, 0, s28
    s_add_u32 s28, s28, 156928
    v_add_u32 v22, s28, v0
    s_and_b32 s28, s61, 4
    s_lshl_b32 s28, s28, 8
    s_and_b32 s29, s61, 2
    s_lshl_b32 s29, s29, 7
    s_add_u32 s28, s28, s29
    s_and_b32 s29, s61, 6
    s_lshl_b32 s29, s29, 8
    s_add_u32 s29, s29, 65536
    s_bitcmp0_b32 s61, 0
    s_cselect_b32 s28, s28, s29
    s_cselect_b32 s29, 9, 7
    s_cselect_b32 s100, -1, 0xffff
    s_cselect_b32 s101, 0, 0xffff
    s_lshl_b32 s30, s60, 11
    s_add_u32 s28, s28, s30
    s_add_u32 s28, s28, 2097152
    v_lshrrev_b32 v16, 4, v6
    v_and_b32 v21, 15, v6
    v_lshlrev_b32 v16, s29, v16
    v_lshl_add_u32 v21, v21, 4, s28
    v_add_u32 v21, v21, v16
    s_mov_b32 s66, 2097152
    s_mov_b32 s67, 0x20000
    s_mov_b32 m0, s31
    s_bitcmp0_b32 s61, 0
    s_cselect_b32 s96, s8, s10
    s_cselect_b32 s97, s9, s11
    s_mov_b32 s98, 16384
    s_mov_b32 s99, 0x20000
    buffer_load_dwordx4 v24, s[64:67], 0 offen offset:0 lds
    buffer_load_dwordx4 v25, s[64:67], 0 offen offset:1024 lds
    buffer_load_dwordx4 v26, s[64:67], 0 offen offset:2048 lds
    buffer_load_dwordx4 v27, s[64:67], 0 offen offset:3072 lds
    s_add_u32 m0, s31, 32768
    s_lshl_b32 s28, s3, 12
    buffer_load_dwordx4 v0, s[96:99], s28 offen offset:0 lds
    buffer_load_dwordx4 v0, s[96:99], s28 offen offset:1024 lds
    buffer_load_dwordx4 v0, s[96:99], s28 offen offset:2048 lds
    buffer_load_dwordx4 v0, s[96:99], s28 offen offset:3072 lds
    s_lshl_b32 s28, s2, 17
    s_add_u32 s28, s28, 6291456
    v_add_u32 v21, s28, v21
    s_and_b32 s28, s3, 1
    s_lshr_b32 s29, s3, 1
    v_lshrrev_b32 v16, 5, v6
    v_bfe_u32 v17, v6, 2, 2
    v_lshl_add_u32 v18, v16, 6, v17
    v_lshlrev_b32 v18, 7, v18
    v_lshrrev_b32 v19, 1, v17
    v_xor_b32 v19, s28, v19
    v_lshl_add_u32 v18, v19, 6, v18
    v_bfe_u32 v19, v6, 4, 1
    v_lshl_add_u32 v18, v19, 5, v18
    v_and_b32 v19, 3, v6
    v_lshl_add_u32 v8, v19, 3, v18
    v_add_u32 v9, 73728, v8
    v_and_b32 v17, 31, v6
    s_lshl_b32 s28, s29, 13
    v_lshlrev_b32 v18, 8, v17
    v_add_u32 v18, s28, v18
    v_and_b32 v17, 15, v6
    v_lshlrev_b32 v19, 3, v16
    v_xor_b32 v17, v17, v19
    v_xor_b32 v19, 0, v17
    v_lshl_add_u32 v96, v19, 4, v18
    v_add_u32 v104, 73728, v96
    v_xor_b32 v19, 1, v17
    v_lshl_add_u32 v97, v19, 4, v18
    v_add_u32 v105, 73728, v97
    v_xor_b32 v19, 2, v17
    v_lshl_add_u32 v98, v19, 4, v18
    v_add_u32 v106, 73728, v98
    v_xor_b32 v19, 3, v17
    v_lshl_add_u32 v99, v19, 4, v18
    v_add_u32 v107, 73728, v99
    v_xor_b32 v19, 4, v17
    v_lshl_add_u32 v100, v19, 4, v18
    v_add_u32 v108, 73728, v100
    v_xor_b32 v19, 5, v17
    v_lshl_add_u32 v101, v19, 4, v18
    v_add_u32 v109, 73728, v101
    v_xor_b32 v19, 6, v17
    v_lshl_add_u32 v102, v19, 4, v18
    v_add_u32 v110, 73728, v102
    v_xor_b32 v19, 7, v17
    v_lshl_add_u32 v103, v19, 4, v18
    v_add_u32 v111, 73728, v103
    s_lshl_b32 s29, s29, 2
    s_and_b32 s30, s61, 6
    s_add_u32 s29, s29, s30
    s_lshl_b32 s28, s60, 16
    s_add_u32 s28, s28, 41943040
    s_and_b32 s30, s3, 1
    s_lshl_b32 s30, s30, 8
    v_bfe_u32 v17, v6, 3, 2
    v_add_u32 v17, s29, v17
    v_and_b32 v17, 7, v17
    v_sub_u32 v18, s61, v17
    v_and_b32 v18, 7, v18
    v_lshlrev_b32 v17, 13, v17
    v_lshl_add_u32 v17, v18, 10, v17
    v_lshl_add_u32 v18, v16, 9, s30
    v_and_b32 v19, 7, v6
    v_lshl_add_u32 v18, v19, 4, v18
    v_add3_u32 v10, v17, v18, s28
    s_waitcnt vmcnt(0)
    ds_read_b64_tr_b16 v[32:33], v20 offset:32768
    ds_read_b64_tr_b16 v[34:35], v20 offset:32896
    ds_read_b128 v[36:39], v28
    ds_read_b64_tr_b16 v[40:41], v20 offset:33792
    ds_read_b64_tr_b16 v[42:43], v20 offset:33920
    ds_read_b128 v[44:47], v29
    ds_read_b64_tr_b16 v[48:49], v20 offset:34816
    ds_read_b64_tr_b16 v[50:51], v20 offset:34944
    ds_read_b128 v[52:55], v30
    ds_read_b64_tr_b16 v[56:57], v20 offset:35840
    ds_read_b64_tr_b16 v[58:59], v20 offset:35968
    ds_read_b128 v[60:63], v31
    s_bitcmp0_b32 s61, 0
    s_cbranch_scc0 FCV
FCK:
    s_waitcnt lgkmcnt(9)
    v_mfma_f32_16x16x32_bf16 v[24:27], v[32:35], v[36:39], 0
    s_waitcnt lgkmcnt(6)
    v_mfma_f32_16x16x32_bf16 v[24:27], v[40:43], v[44:47], v[24:27]
    s_waitcnt lgkmcnt(3)
    v_mfma_f32_16x16x32_bf16 v[24:27], v[48:51], v[52:55], v[24:27]
    s_waitcnt lgkmcnt(0)
    v_mfma_f32_16x16x32_bf16 v[24:27], v[56:59], v[60:63], v[24:27]
    s_branch FCM
FCV:
    s_waitcnt lgkmcnt(9)
    v_mfma_f32_16x16x32_bf16 v[24:27], v[36:39], v[32:35], 0
    s_waitcnt lgkmcnt(6)
    v_mfma_f32_16x16x32_bf16 v[24:27], v[44:47], v[40:43], v[24:27]
    s_waitcnt lgkmcnt(3)
    v_mfma_f32_16x16x32_bf16 v[24:27], v[52:55], v[48:51], v[24:27]
    s_waitcnt lgkmcnt(0)
    v_mfma_f32_16x16x32_bf16 v[24:27], v[60:63], v[56:59], v[24:27]
FCM:
    s_cmp_eq_u32 s3, 3
    s_cbranch_scc1 FCR
    s_nop 5
    ds_write_b128 v22, v[24:27]
    s_waitcnt lgkmcnt(0)
    s_barrier
    s_branch FCD
FCR:
    s_waitcnt lgkmcnt(0)
    s_barrier
    ds_read_b128 v[32:35], v22 offset:0
    ds_read_b128 v[36:39], v22 offset:1024
    ds_read_b128 v[40:43], v22 offset:2048
    s_waitcnt lgkmcnt(0)
    v_pk_add_f32 v[32:33], v[32:33], v[36:37]
    v_pk_add_f32 v[34:35], v[34:35], v[38:39]
    v_pk_add_f32 v[24:25], v[24:25], v[40:41]
    v_pk_add_f32 v[26:27], v[26:27], v[42:43]
    v_pk_add_f32 v[24:25], v[24:25], v[32:33]
    v_pk_add_f32 v[26:27], v[26:27], v[34:35]
    s_bitcmp0_b32 s61, 0
    v_cvt_pk_bf16_f32 v44, v24, v25
    v_cvt_pk_bf16_f32 v45, v26, v27
    v_cvt_pk_bf16_f32 v46, v24, v25
    v_cvt_pk_bf16_f32 v47, v26, v27
    s_cbranch_scc0 FCSV
    s_nop 0
    v_permlane32_swap_b32 v44, v46
    v_permlane32_swap_b32 v45, v47
    s_branch FCST
FCSV:
    s_nop 0
    v_permlane16_swap_b32 v44, v46
    v_permlane16_swap_b32 v45, v47
FCST:
    s_mov_b64 exec, s[100:101]
    buffer_store_dwordx4 v[44:47], v21, s[16:19], 0 offen sc1
    s_mov_b64 exec, -1
FCD:
    s_barrier
    ds_read_b64_tr_b16 v[32:33], v8 offset:16384
    ds_read_b64_tr_b16 v[34:35], v8 offset:16896
    ds_read_b128 v[36:39], v96 offset:0
    ds_read_b64_tr_b16 v[40:41], v8 offset:17408
    ds_read_b64_tr_b16 v[42:43], v8 offset:17920
    ds_read_b128 v[44:47], v97 offset:0
    ds_read_b64_tr_b16 v[48:49], v8 offset:18432
    ds_read_b64_tr_b16 v[50:51], v8 offset:18944
    ds_read_b128 v[52:55], v98 offset:0
    ds_read_b64_tr_b16 v[56:57], v8 offset:19456
    ds_read_b64_tr_b16 v[58:59], v8 offset:19968
    ds_read_b128 v[60:63], v99 offset:0
    ds_read_b64_tr_b16 v[112:113], v8 offset:20480
    ds_read_b64_tr_b16 v[114:115], v8 offset:20992
    ds_read_b128 v[116:119], v100 offset:0
    s_waitcnt lgkmcnt(12)
    v_mfma_f32_32x32x16_bf16 v[16:31], v[32:35], v[36:39], 0
    ds_read_b64_tr_b16 v[120:121], v8 offset:21504
    ds_read_b64_tr_b16 v[122:123], v8 offset:22016
    ds_read_b128 v[124:127], v101 offset:0
    s_waitcnt lgkmcnt(12)
    v_mfma_f32_32x32x16_bf16 v[16:31], v[40:43], v[44:47], v[16:31]
    ds_read_b64_tr_b16 v[32:33], v8 offset:22528
    ds_read_b64_tr_b16 v[34:35], v8 offset:23040
    ds_read_b128 v[36:39], v102 offset:0
    s_waitcnt lgkmcnt(12)
    v_mfma_f32_32x32x16_bf16 v[16:31], v[48:51], v[52:55], v[16:31]
    ds_read_b64_tr_b16 v[40:41], v8 offset:23552
    ds_read_b64_tr_b16 v[42:43], v8 offset:24064
    ds_read_b128 v[44:47], v103 offset:0
    s_waitcnt lgkmcnt(12)
    v_mfma_f32_32x32x16_bf16 v[16:31], v[56:59], v[60:63], v[16:31]
    s_waitcnt lgkmcnt(9)
    v_mfma_f32_32x32x16_bf16 v[16:31], v[112:115], v[116:119], v[16:31]
    s_barrier
    ds_read_b64_tr_b16 v[48:49], v8 offset:53248
    ds_read_b64_tr_b16 v[50:51], v8 offset:53760
    ds_read_b128 v[52:55], v96 offset:36864
    ds_read_b64_tr_b16 v[56:57], v8 offset:54272
    ds_read_b64_tr_b16 v[58:59], v8 offset:54784
    ds_read_b128 v[60:63], v97 offset:36864
    s_waitcnt lgkmcnt(12)
    v_mfma_f32_32x32x16_bf16 v[16:31], v[120:123], v[124:127], v[16:31]
    ds_read_b64_tr_b16 v[112:113], v8 offset:55296
    ds_read_b64_tr_b16 v[114:115], v8 offset:55808
    ds_read_b128 v[116:119], v98 offset:36864
    s_waitcnt lgkmcnt(12)
    v_mfma_f32_32x32x16_bf16 v[16:31], v[32:35], v[36:39], v[16:31]
    ds_read_b64_tr_b16 v[120:121], v8 offset:56320
    ds_read_b64_tr_b16 v[122:123], v8 offset:56832
    ds_read_b128 v[124:127], v99 offset:36864
    s_waitcnt lgkmcnt(12)
    v_mfma_f32_32x32x16_bf16 v[16:31], v[40:43], v[44:47], v[16:31]
    ds_read_b64_tr_b16 v[32:33], v8 offset:57344
    ds_read_b64_tr_b16 v[34:35], v8 offset:57856
    ds_read_b128 v[36:39], v100 offset:36864
    s_waitcnt lgkmcnt(12)
    v_mfma_f32_32x32x16_bf16 v[16:31], v[48:51], v[52:55], v[16:31]
    ds_read_b64_tr_b16 v[40:41], v8 offset:58368
    ds_read_b64_tr_b16 v[42:43], v8 offset:58880
    ds_read_b128 v[44:47], v101 offset:36864
    s_waitcnt lgkmcnt(12)
    v_mfma_f32_32x32x16_bf16 v[16:31], v[56:59], v[60:63], v[16:31]
    ds_read_b64_tr_b16 v[48:49], v8 offset:59392
    ds_read_b64_tr_b16 v[50:51], v8 offset:59904
    ds_read_b128 v[52:55], v102 offset:36864
    s_waitcnt lgkmcnt(12)
    v_mfma_f32_32x32x16_bf16 v[16:31], v[112:115], v[116:119], v[16:31]
    ds_read_b64_tr_b16 v[56:57], v8 offset:60416
    ds_read_b64_tr_b16 v[58:59], v8 offset:60928
    ds_read_b128 v[60:63], v103 offset:36864
    s_waitcnt lgkmcnt(12)
    v_mfma_f32_32x32x16_bf16 v[16:31], v[120:123], v[124:127], v[16:31]
    s_waitcnt lgkmcnt(9)
    v_mfma_f32_32x32x16_bf16 v[16:31], v[32:35], v[36:39], v[16:31]
    s_barrier
    ds_read_b64_tr_b16 v[112:113], v9 offset:16384
    ds_read_b64_tr_b16 v[114:115], v9 offset:16896
    ds_read_b128 v[116:119], v104 offset:0
    ds_read_b64_tr_b16 v[120:121], v9 offset:17408
    ds_read_b64_tr_b16 v[122:123], v9 offset:17920
    ds_read_b128 v[124:127], v105 offset:0
    s_waitcnt lgkmcnt(12)
    v_mfma_f32_32x32x16_bf16 v[16:31], v[40:43], v[44:47], v[16:31]
    ds_read_b64_tr_b16 v[32:33], v9 offset:18432
    ds_read_b64_tr_b16 v[34:35], v9 offset:18944
    ds_read_b128 v[36:39], v106 offset:0
    s_waitcnt lgkmcnt(12)
    v_mfma_f32_32x32x16_bf16 v[16:31], v[48:51], v[52:55], v[16:31]
    ds_read_b64_tr_b16 v[40:41], v9 offset:19456
    ds_read_b64_tr_b16 v[42:43], v9 offset:19968
    ds_read_b128 v[44:47], v107 offset:0
    s_waitcnt lgkmcnt(12)
    v_mfma_f32_32x32x16_bf16 v[16:31], v[56:59], v[60:63], v[16:31]
    ds_read_b64_tr_b16 v[48:49], v9 offset:20480
    ds_read_b64_tr_b16 v[50:51], v9 offset:20992
    ds_read_b128 v[52:55], v108 offset:0
    s_waitcnt lgkmcnt(12)
    v_mfma_f32_32x32x16_bf16 v[16:31], v[112:115], v[116:119], v[16:31]
    ds_read_b64_tr_b16 v[56:57], v9 offset:21504
    ds_read_b64_tr_b16 v[58:59], v9 offset:22016
    ds_read_b128 v[60:63], v109 offset:0
    s_waitcnt lgkmcnt(12)
    v_mfma_f32_32x32x16_bf16 v[16:31], v[120:123], v[124:127], v[16:31]
    ds_read_b64_tr_b16 v[112:113], v9 offset:22528
    ds_read_b64_tr_b16 v[114:115], v9 offset:23040
    ds_read_b128 v[116:119], v110 offset:0
    s_waitcnt lgkmcnt(12)
    v_mfma_f32_32x32x16_bf16 v[16:31], v[32:35], v[36:39], v[16:31]
    ds_read_b64_tr_b16 v[120:121], v9 offset:23552
    ds_read_b64_tr_b16 v[122:123], v9 offset:24064
    ds_read_b128 v[124:127], v111 offset:0
    s_waitcnt lgkmcnt(12)
    v_mfma_f32_32x32x16_bf16 v[16:31], v[40:43], v[44:47], v[16:31]
    s_waitcnt lgkmcnt(9)
    v_mfma_f32_32x32x16_bf16 v[16:31], v[48:51], v[52:55], v[16:31]
    s_barrier
    ds_read_b64_tr_b16 v[32:33], v9 offset:53248
    ds_read_b64_tr_b16 v[34:35], v9 offset:53760
    ds_read_b128 v[36:39], v104 offset:36864
    ds_read_b64_tr_b16 v[40:41], v9 offset:54272
    ds_read_b64_tr_b16 v[42:43], v9 offset:54784
    ds_read_b128 v[44:47], v105 offset:36864
    s_waitcnt lgkmcnt(12)
    v_mfma_f32_32x32x16_bf16 v[16:31], v[56:59], v[60:63], v[16:31]
    ds_read_b64_tr_b16 v[48:49], v9 offset:55296
    ds_read_b64_tr_b16 v[50:51], v9 offset:55808
    ds_read_b128 v[52:55], v106 offset:36864
    s_waitcnt lgkmcnt(12)
    v_mfma_f32_32x32x16_bf16 v[16:31], v[112:115], v[116:119], v[16:31]
    ds_read_b64_tr_b16 v[56:57], v9 offset:56320
    ds_read_b64_tr_b16 v[58:59], v9 offset:56832
    ds_read_b128 v[60:63], v107 offset:36864
    s_waitcnt lgkmcnt(12)
    v_mfma_f32_32x32x16_bf16 v[16:31], v[120:123], v[124:127], v[16:31]
    ds_read_b64_tr_b16 v[112:113], v9 offset:57344
    ds_read_b64_tr_b16 v[114:115], v9 offset:57856
    ds_read_b128 v[116:119], v108 offset:36864
    s_waitcnt lgkmcnt(12)
    v_mfma_f32_32x32x16_bf16 v[16:31], v[32:35], v[36:39], v[16:31]
    ds_read_b64_tr_b16 v[120:121], v9 offset:58368
    ds_read_b64_tr_b16 v[122:123], v9 offset:58880
    ds_read_b128 v[124:127], v109 offset:36864
    s_waitcnt lgkmcnt(12)
    v_mfma_f32_32x32x16_bf16 v[16:31], v[40:43], v[44:47], v[16:31]
    ds_read_b64_tr_b16 v[32:33], v9 offset:59392
    ds_read_b64_tr_b16 v[34:35], v9 offset:59904
    ds_read_b128 v[36:39], v110 offset:36864
    s_waitcnt lgkmcnt(12)
    v_mfma_f32_32x32x16_bf16 v[16:31], v[48:51], v[52:55], v[16:31]
    ds_read_b64_tr_b16 v[40:41], v9 offset:60416
    ds_read_b64_tr_b16 v[42:43], v9 offset:60928
    ds_read_b128 v[44:47], v111 offset:36864
    s_waitcnt lgkmcnt(12)
    v_mfma_f32_32x32x16_bf16 v[16:31], v[56:59], v[60:63], v[16:31]
    s_waitcnt lgkmcnt(9)
    v_mfma_f32_32x32x16_bf16 v[16:31], v[112:115], v[116:119], v[16:31]
    s_waitcnt lgkmcnt(6)
    v_mfma_f32_32x32x16_bf16 v[16:31], v[120:123], v[124:127], v[16:31]
    s_waitcnt lgkmcnt(3)
    v_mfma_f32_32x32x16_bf16 v[16:31], v[32:35], v[36:39], v[16:31]
    s_waitcnt lgkmcnt(0)
    v_mfma_f32_32x32x16_bf16 v[16:31], v[40:43], v[44:47], v[16:31]
    s_mov_b32 s28, 0x3eb8aa3b
    s_mov_b32 s29, 0x3eb8aa3b
    s_nop 7
    s_nop 2
    v_pk_mul_f32 v[16:17], v[16:17], s[28:29]
    v_pk_mul_f32 v[18:19], v[18:19], s[28:29]
    v_pk_mul_f32 v[20:21], v[20:21], s[28:29]
    v_pk_mul_f32 v[22:23], v[22:23], s[28:29]
    v_cvt_pk_bf16_f32 v32, v16, v17
    v_cvt_pk_bf16_f32 v33, v18, v19
    v_cvt_pk_bf16_f32 v34, v20, v21
    v_cvt_pk_bf16_f32 v35, v22, v23
    buffer_store_dwordx4 v[32:35], v10, s[16:19], 0 offen offset:0 sc1
    v_pk_mul_f32 v[24:25], v[24:25], s[28:29]
    v_pk_mul_f32 v[26:27], v[26:27], s[28:29]
    v_pk_mul_f32 v[28:29], v[28:29], s[28:29]
    v_pk_mul_f32 v[30:31], v[30:31], s[28:29]
    v_cvt_pk_bf16_f32 v36, v24, v25
    v_cvt_pk_bf16_f32 v37, v26, v27
    v_cvt_pk_bf16_f32 v38, v28, v29
    v_cvt_pk_bf16_f32 v39, v30, v31
    buffer_store_dwordx4 v[36:39], v10, s[16:19], 0 offen offset:128 sc1
    s_barrier
    s_add_u32 s63, s63, 1
    s_cmp_lt_u32 s63, 256
    s_cbranch_scc1 FBK_A
    s_waitcnt vmcnt(0)
    s_barrier
    s_lshl_b32 s28, s2, 17
    s_add_u32 s28, s28, 6291456
    s_add_u32 s36, s36, s28
    buffer_load_dwordx4 v[64:67], v0, s[16:19], s36 offen offset:0 sc1
    buffer_load_dwordx4 v[68:71], v0, s[16:19], s36 offen offset:1024 sc1
    s_mov_b64 exec, s[44:45]
    buffer_load_dwordx4 v[128:131], v7, s[16:19], s36 offen offset:0 sc1
    buffer_load_dwordx4 v[132:135], v7, s[16:19], s36 offen offset:512 sc1
    buffer_load_dwordx4 v[136:139], v7, s[16:19], s36 offen offset:1024 sc1
    buffer_load_dwordx4 v[140:143], v7, s[16:19], s36 offen offset:1536 sc1
    s_mov_b64 exec, -1
    s_add_u32 s37, s37, s28
    buffer_load_dwordx4 v[72:75], v0, s[16:19], s37 offen offset:0 sc1
    buffer_load_dwordx4 v[76:79], v0, s[16:19], s37 offen offset:1024 sc1
    s_mov_b64 exec, s[44:45]
    buffer_load_dwordx4 v[144:147], v7, s[16:19], s37 offen offset:0 sc1
    buffer_load_dwordx4 v[148:151], v7, s[16:19], s37 offen offset:512 sc1
    buffer_load_dwordx4 v[152:155], v7, s[16:19], s37 offen offset:1024 sc1
    buffer_load_dwordx4 v[156:159], v7, s[16:19], s37 offen offset:1536 sc1
    s_mov_b64 exec, -1
    s_add_u32 s38, s38, s28
    buffer_load_dwordx4 v[80:83], v0, s[16:19], s38 offen offset:0 sc1
    buffer_load_dwordx4 v[84:87], v0, s[16:19], s38 offen offset:1024 sc1
    s_mov_b64 exec, s[44:45]
    buffer_load_dwordx4 v[160:163], v7, s[16:19], s38 offen offset:0 sc1
    buffer_load_dwordx4 v[164:167], v7, s[16:19], s38 offen offset:512 sc1
    buffer_load_dwordx4 v[168:171], v7, s[16:19], s38 offen offset:1024 sc1
    buffer_load_dwordx4 v[172:175], v7, s[16:19], s38 offen offset:1536 sc1
    s_mov_b64 exec, -1
    s_add_u32 s39, s39, s28
    buffer_load_dwordx4 v[88:91], v0, s[16:19], s39 offen offset:0 sc1
    buffer_load_dwordx4 v[92:95], v0, s[16:19], s39 offen offset:1024 sc1
    s_mov_b64 exec, s[44:45]
    buffer_load_dwordx4 v[176:179], v7, s[16:19], s39 offen offset:0 sc1
    buffer_load_dwordx4 v[180:183], v7, s[16:19], s39 offen offset:512 sc1
    buffer_load_dwordx4 v[184:187], v7, s[16:19], s39 offen offset:1024 sc1
    buffer_load_dwordx4 v[188:191], v7, s[16:19], s39 offen offset:1536 sc1
    s_mov_b64 exec, -1
    s_add_u32 s40, s40, s28
    buffer_load_dwordx4 v[96:99], v0, s[16:19], s40 offen offset:0 sc1
    buffer_load_dwordx4 v[100:103], v0, s[16:19], s40 offen offset:1024 sc1
    s_mov_b64 exec, s[44:45]
    buffer_load_dwordx4 v[192:195], v7, s[16:19], s40 offen offset:0 sc1
    buffer_load_dwordx4 v[196:199], v7, s[16:19], s40 offen offset:512 sc1
    buffer_load_dwordx4 v[200:203], v7, s[16:19], s40 offen offset:1024 sc1
    buffer_load_dwordx4 v[204:207], v7, s[16:19], s40 offen offset:1536 sc1
    s_mov_b64 exec, -1
    s_add_u32 s41, s41, s28
    buffer_load_dwordx4 v[104:107], v0, s[16:19], s41 offen offset:0 sc1
    buffer_load_dwordx4 v[108:111], v0, s[16:19], s41 offen offset:1024 sc1
    s_mov_b64 exec, s[44:45]
    buffer_load_dwordx4 v[208:211], v7, s[16:19], s41 offen offset:0 sc1
    buffer_load_dwordx4 v[212:215], v7, s[16:19], s41 offen offset:512 sc1
    buffer_load_dwordx4 v[216:219], v7, s[16:19], s41 offen offset:1024 sc1
    buffer_load_dwordx4 v[220:223], v7, s[16:19], s41 offen offset:1536 sc1
    s_mov_b64 exec, -1
    s_add_u32 s42, s42, s28
    buffer_load_dwordx4 v[112:115], v0, s[16:19], s42 offen offset:0 sc1
    buffer_load_dwordx4 v[116:119], v0, s[16:19], s42 offen offset:1024 sc1
    s_mov_b64 exec, s[44:45]
    buffer_load_dwordx4 v[224:227], v7, s[16:19], s42 offen offset:0 sc1
    buffer_load_dwordx4 v[228:231], v7, s[16:19], s42 offen offset:512 sc1
    buffer_load_dwordx4 v[232:235], v7, s[16:19], s42 offen offset:1024 sc1
    buffer_load_dwordx4 v[236:239], v7, s[16:19], s42 offen offset:1536 sc1
    s_mov_b64 exec, -1
    s_add_u32 s43, s43, s28
    buffer_load_dwordx4 v[120:123], v0, s[16:19], s43 offen offset:0 sc1
    buffer_load_dwordx4 v[124:127], v0, s[16:19], s43 offen offset:1024 sc1
    s_mov_b64 exec, s[44:45]
    buffer_load_dwordx4 v[240:243], v7, s[16:19], s43 offen offset:0 sc1
    buffer_load_dwordx4 v[244:247], v7, s[16:19], s43 offen offset:512 sc1
    buffer_load_dwordx4 v[248:251], v7, s[16:19], s43 offen offset:1024 sc1
    buffer_load_dwordx4 v[252:255], v7, s[16:19], s43 offen offset:1536 sc1
    s_mov_b64 exec, -1
    s_lshl_b32 s34, s32, 13
    s_add_u32 s34, s34, 41943040
    v_mov_b64 v[4:5], 0
    s_lshl_b32 s49, s3, 8
    v_lshlrev_b32 v14, 2, v6
    v_add_u32 v14, s49, v14
    v_add_u32 v14, 8192, v14
    v_and_b32 v12, 31, v6
    v_lshlrev_b32 v12, 2, v12
    v_add_u32 v12, 8192, v12
    s_mov_b32 s50, 0
FB_STEP:
    buffer_load_dwordx4 v[8:11], v0, s[16:19], s34 offen sc1
    v_mov_b32 v13, 0xff800000
    s_waitcnt vmcnt(0)
    v_mfma_f32_32x32x16_bf16 v[16:31], v[64:67], v[8:11], 0
    s_nop 7
    s_nop 3
    v_max3_f32 v13, v16, v17, v13
    v_max3_f32 v13, v18, v19, v13
    v_max3_f32 v13, v20, v21, v13
    v_max3_f32 v13, v22, v23, v13
    v_max3_f32 v13, v24, v25, v13
    v_max3_f32 v13, v26, v27, v13
    v_max3_f32 v13, v28, v29, v13
    v_max3_f32 v13, v30, v31, v13
    v_mfma_f32_32x32x16_bf16 v[16:31], v[68:71], v[8:11], 0
    s_nop 7
    s_nop 3
    v_max3_f32 v13, v16, v17, v13
    v_max3_f32 v13, v18, v19, v13
    v_max3_f32 v13, v20, v21, v13
    v_max3_f32 v13, v22, v23, v13
    v_max3_f32 v13, v24, v25, v13
    v_max3_f32 v13, v26, v27, v13
    v_max3_f32 v13, v28, v29, v13
    v_max3_f32 v13, v30, v31, v13
    v_mfma_f32_32x32x16_bf16 v[16:31], v[72:75], v[8:11], 0
    s_nop 7
    s_nop 3
    v_max3_f32 v13, v16, v17, v13
    v_max3_f32 v13, v18, v19, v13
    v_max3_f32 v13, v20, v21, v13
    v_max3_f32 v13, v22, v23, v13
    v_max3_f32 v13, v24, v25, v13
    v_max3_f32 v13, v26, v27, v13
    v_max3_f32 v13, v28, v29, v13
    v_max3_f32 v13, v30, v31, v13
    v_mfma_f32_32x32x16_bf16 v[16:31], v[76:79], v[8:11], 0
    s_nop 7
    s_nop 3
    v_max3_f32 v13, v16, v17, v13
    v_max3_f32 v13, v18, v19, v13
    v_max3_f32 v13, v20, v21, v13
    v_max3_f32 v13, v22, v23, v13
    v_max3_f32 v13, v24, v25, v13
    v_max3_f32 v13, v26, v27, v13
    v_max3_f32 v13, v28, v29, v13
    v_max3_f32 v13, v30, v31, v13
    v_mfma_f32_32x32x16_bf16 v[16:31], v[80:83], v[8:11], 0
    s_nop 7
    s_nop 3
    v_max3_f32 v13, v16, v17, v13
    v_max3_f32 v13, v18, v19, v13
    v_max3_f32 v13, v20, v21, v13
    v_max3_f32 v13, v22, v23, v13
    v_max3_f32 v13, v24, v25, v13
    v_max3_f32 v13, v26, v27, v13
    v_max3_f32 v13, v28, v29, v13
    v_max3_f32 v13, v30, v31, v13
    v_mfma_f32_32x32x16_bf16 v[16:31], v[84:87], v[8:11], 0
    s_nop 7
    s_nop 3
    v_max3_f32 v13, v16, v17, v13
    v_max3_f32 v13, v18, v19, v13
    v_max3_f32 v13, v20, v21, v13
    v_max3_f32 v13, v22, v23, v13
    v_max3_f32 v13, v24, v25, v13
    v_max3_f32 v13, v26, v27, v13
    v_max3_f32 v13, v28, v29, v13
    v_max3_f32 v13, v30, v31, v13
    v_mfma_f32_32x32x16_bf16 v[16:31], v[88:91], v[8:11], 0
    s_nop 7
    s_nop 3
    v_max3_f32 v13, v16, v17, v13
    v_max3_f32 v13, v18, v19, v13
    v_max3_f32 v13, v20, v21, v13
    v_max3_f32 v13, v22, v23, v13
    v_max3_f32 v13, v24, v25, v13
    v_max3_f32 v13, v26, v27, v13
    v_max3_f32 v13, v28, v29, v13
    v_max3_f32 v13, v30, v31, v13
    v_mfma_f32_32x32x16_bf16 v[16:31], v[92:95], v[8:11], 0
    s_nop 7
    s_nop 3
    v_max3_f32 v13, v16, v17, v13
    v_max3_f32 v13, v18, v19, v13
    v_max3_f32 v13, v20, v21, v13
    v_max3_f32 v13, v22, v23, v13
    v_max3_f32 v13, v24, v25, v13
    v_max3_f32 v13, v26, v27, v13
    v_max3_f32 v13, v28, v29, v13
    v_max3_f32 v13, v30, v31, v13
    v_mfma_f32_32x32x16_bf16 v[16:31], v[96:99], v[8:11], 0
    s_nop 7
    s_nop 3
    v_max3_f32 v13, v16, v17, v13
    v_max3_f32 v13, v18, v19, v13
    v_max3_f32 v13, v20, v21, v13
    v_max3_f32 v13, v22, v23, v13
    v_max3_f32 v13, v24, v25, v13
    v_max3_f32 v13, v26, v27, v13
    v_max3_f32 v13, v28, v29, v13
    v_max3_f32 v13, v30, v31, v13
    v_mfma_f32_32x32x16_bf16 v[16:31], v[100:103], v[8:11], 0
    s_nop 7
    s_nop 3
    v_max3_f32 v13, v16, v17, v13
    v_max3_f32 v13, v18, v19, v13
    v_max3_f32 v13, v20, v21, v13
    v_max3_f32 v13, v22, v23, v13
    v_max3_f32 v13, v24, v25, v13
    v_max3_f32 v13, v26, v27, v13
    v_max3_f32 v13, v28, v29, v13
    v_max3_f32 v13, v30, v31, v13
    v_mfma_f32_32x32x16_bf16 v[16:31], v[104:107], v[8:11], 0
    s_nop 7
    s_nop 3
    v_max3_f32 v13, v16, v17, v13
    v_max3_f32 v13, v18, v19, v13
    v_max3_f32 v13, v20, v21, v13
    v_max3_f32 v13, v22, v23, v13
    v_max3_f32 v13, v24, v25, v13
    v_max3_f32 v13, v26, v27, v13
    v_max3_f32 v13, v28, v29, v13
    v_max3_f32 v13, v30, v31, v13
    v_mfma_f32_32x32x16_bf16 v[16:31], v[108:111], v[8:11], 0
    s_nop 7
    s_nop 3
    v_max3_f32 v13, v16, v17, v13
    v_max3_f32 v13, v18, v19, v13
    v_max3_f32 v13, v20, v21, v13
    v_max3_f32 v13, v22, v23, v13
    v_max3_f32 v13, v24, v25, v13
    v_max3_f32 v13, v26, v27, v13
    v_max3_f32 v13, v28, v29, v13
    v_max3_f32 v13, v30, v31, v13
    v_mfma_f32_32x32x16_bf16 v[16:31], v[112:115], v[8:11], 0
    s_nop 7
    s_nop 3
    v_max3_f32 v13, v16, v17, v13
    v_max3_f32 v13, v18, v19, v13
    v_max3_f32 v13, v20, v21, v13
    v_max3_f32 v13, v22, v23, v13
    v_max3_f32 v13, v24, v25, v13
    v_max3_f32 v13, v26, v27, v13
    v_max3_f32 v13, v28, v29, v13
    v_max3_f32 v13, v30, v31, v13
    v_mfma_f32_32x32x16_bf16 v[16:31], v[116:119], v[8:11], 0
    s_nop 7
    s_nop 3
    v_max3_f32 v13, v16, v17, v13
    v_max3_f32 v13, v18, v19, v13
    v_max3_f32 v13, v20, v21, v13
    v_max3_f32 v13, v22, v23, v13
    v_max3_f32 v13, v24, v25, v13
    v_max3_f32 v13, v26, v27, v13
    v_max3_f32 v13, v28, v29, v13
    v_max3_f32 v13, v30, v31, v13
    v_mfma_f32_32x32x16_bf16 v[16:31], v[120:123], v[8:11], 0
    s_nop 7
    s_nop 3
    v_max3_f32 v13, v16, v17, v13
    v_max3_f32 v13, v18, v19, v13
    v_max3_f32 v13, v20, v21, v13
    v_max3_f32 v13, v22, v23, v13
    v_max3_f32 v13, v24, v25, v13
    v_max3_f32 v13, v26, v27, v13
    v_max3_f32 v13, v28, v29, v13
    v_max3_f32 v13, v30, v31, v13
    v_mfma_f32_32x32x16_bf16 v[16:31], v[124:127], v[8:11], 0
    s_nop 7
    s_nop 3
    v_max3_f32 v13, v16, v17, v13
    v_max3_f32 v13, v18, v19, v13
    v_max3_f32 v13, v20, v21, v13
    v_max3_f32 v13, v22, v23, v13
    v_max3_f32 v13, v24, v25, v13
    v_max3_f32 v13, v26, v27, v13
    v_max3_f32 v13, v28, v29, v13
    v_max3_f32 v13, v30, v31, v13
    ds_write_b32 v14, v13
    s_waitcnt lgkmcnt(0)
    s_barrier
    ds_read_b32 v16, v12 offset:0
    ds_read_b32 v17, v12 offset:128
    ds_read_b32 v18, v12 offset:256
    ds_read_b32 v19, v12 offset:384
    ds_read_b32 v20, v12 offset:512
    ds_read_b32 v21, v12 offset:640
    ds_read_b32 v22, v12 offset:768
    ds_read_b32 v23, v12 offset:896
    s_waitcnt lgkmcnt(0)
    v_max3_f32 v13, v16, v17, v13
    v_max3_f32 v13, v18, v19, v13
    v_max3_f32 v13, v20, v21, v13
    v_max3_f32 v13, v22, v23, v13
    v_sub_f32 v32, 0, v13
    v_sub_f32 v33, 0, v13
    v_sub_f32 v34, 0, v13
    v_sub_f32 v35, 0, v13
    v_sub_f32 v36, 0, v13
    v_sub_f32 v37, 0, v13
    v_sub_f32 v38, 0, v13
    v_sub_f32 v39, 0, v13
    v_sub_f32 v40, 0, v13
    v_sub_f32 v41, 0, v13
    v_sub_f32 v42, 0, v13
    v_sub_f32 v43, 0, v13
    v_sub_f32 v44, 0, v13
    v_sub_f32 v45, 0, v13
    v_sub_f32 v46, 0, v13
    v_sub_f32 v47, 0, v13
    s_nop 1
    v_mfma_f32_32x32x8_bf16 v[48:63], v[4:5], v[4:5], 0
    v_mfma_f32_32x32x16_bf16 v[16:31], v[64:67], v[8:11], v[32:47]
    s_nop 7
    s_nop 3
    v_exp_f32 v16, v16
    v_exp_f32 v17, v17
    v_exp_f32 v18, v18
    v_exp_f32 v19, v19
    v_exp_f32 v20, v20
    v_exp_f32 v21, v21
    v_exp_f32 v22, v22
    v_exp_f32 v23, v23
    v_exp_f32 v24, v24
    v_exp_f32 v25, v25
    v_exp_f32 v26, v26
    v_exp_f32 v27, v27
    v_exp_f32 v28, v28
    v_exp_f32 v29, v29
    v_exp_f32 v30, v30
    v_exp_f32 v31, v31
    s_nop 1
    v_smfmac_f32_32x32x32_bf16 v[48:63], v[128:131], v[16:23], v2
    v_smfmac_f32_32x32x32_bf16 v[48:63], v[132:135], v[24:31], v2
    v_mfma_f32_32x32x16_bf16 v[16:31], v[68:71], v[8:11], v[32:47]
    s_nop 7
    s_nop 3
    v_exp_f32 v16, v16
    v_exp_f32 v17, v17
    v_exp_f32 v18, v18
    v_exp_f32 v19, v19
    v_exp_f32 v20, v20
    v_exp_f32 v21, v21
    v_exp_f32 v22, v22
    v_exp_f32 v23, v23
    v_exp_f32 v24, v24
    v_exp_f32 v25, v25
    v_exp_f32 v26, v26
    v_exp_f32 v27, v27
    v_exp_f32 v28, v28
    v_exp_f32 v29, v29
    v_exp_f32 v30, v30
    v_exp_f32 v31, v31
    s_nop 1
    v_smfmac_f32_32x32x32_bf16 v[48:63], v[136:139], v[16:23], v2
    v_smfmac_f32_32x32x32_bf16 v[48:63], v[140:143], v[24:31], v2
    v_mfma_f32_32x32x16_bf16 v[16:31], v[72:75], v[8:11], v[32:47]
    s_nop 7
    s_nop 3
    v_exp_f32 v16, v16
    v_exp_f32 v17, v17
    v_exp_f32 v18, v18
    v_exp_f32 v19, v19
    v_exp_f32 v20, v20
    v_exp_f32 v21, v21
    v_exp_f32 v22, v22
    v_exp_f32 v23, v23
    v_exp_f32 v24, v24
    v_exp_f32 v25, v25
    v_exp_f32 v26, v26
    v_exp_f32 v27, v27
    v_exp_f32 v28, v28
    v_exp_f32 v29, v29
    v_exp_f32 v30, v30
    v_exp_f32 v31, v31
    s_nop 1
    v_smfmac_f32_32x32x32_bf16 v[48:63], v[144:147], v[16:23], v2
    v_smfmac_f32_32x32x32_bf16 v[48:63], v[148:151], v[24:31], v2
    v_mfma_f32_32x32x16_bf16 v[16:31], v[76:79], v[8:11], v[32:47]
    s_nop 7
    s_nop 3
    v_exp_f32 v16, v16
    v_exp_f32 v17, v17
    v_exp_f32 v18, v18
    v_exp_f32 v19, v19
    v_exp_f32 v20, v20
    v_exp_f32 v21, v21
    v_exp_f32 v22, v22
    v_exp_f32 v23, v23
    v_exp_f32 v24, v24
    v_exp_f32 v25, v25
    v_exp_f32 v26, v26
    v_exp_f32 v27, v27
    v_exp_f32 v28, v28
    v_exp_f32 v29, v29
    v_exp_f32 v30, v30
    v_exp_f32 v31, v31
    s_nop 1
    v_smfmac_f32_32x32x32_bf16 v[48:63], v[152:155], v[16:23], v2
    v_smfmac_f32_32x32x32_bf16 v[48:63], v[156:159], v[24:31], v2
    v_mfma_f32_32x32x16_bf16 v[16:31], v[80:83], v[8:11], v[32:47]
    s_nop 7
    s_nop 3
    v_exp_f32 v16, v16
    v_exp_f32 v17, v17
    v_exp_f32 v18, v18
    v_exp_f32 v19, v19
    v_exp_f32 v20, v20
    v_exp_f32 v21, v21
    v_exp_f32 v22, v22
    v_exp_f32 v23, v23
    v_exp_f32 v24, v24
    v_exp_f32 v25, v25
    v_exp_f32 v26, v26
    v_exp_f32 v27, v27
    v_exp_f32 v28, v28
    v_exp_f32 v29, v29
    v_exp_f32 v30, v30
    v_exp_f32 v31, v31
    s_nop 1
    v_smfmac_f32_32x32x32_bf16 v[48:63], v[160:163], v[16:23], v2
    v_smfmac_f32_32x32x32_bf16 v[48:63], v[164:167], v[24:31], v2
    v_mfma_f32_32x32x16_bf16 v[16:31], v[84:87], v[8:11], v[32:47]
    s_nop 7
    s_nop 3
    v_exp_f32 v16, v16
    v_exp_f32 v17, v17
    v_exp_f32 v18, v18
    v_exp_f32 v19, v19
    v_exp_f32 v20, v20
    v_exp_f32 v21, v21
    v_exp_f32 v22, v22
    v_exp_f32 v23, v23
    v_exp_f32 v24, v24
    v_exp_f32 v25, v25
    v_exp_f32 v26, v26
    v_exp_f32 v27, v27
    v_exp_f32 v28, v28
    v_exp_f32 v29, v29
    v_exp_f32 v30, v30
    v_exp_f32 v31, v31
    s_nop 1
    v_smfmac_f32_32x32x32_bf16 v[48:63], v[168:171], v[16:23], v2
    v_smfmac_f32_32x32x32_bf16 v[48:63], v[172:175], v[24:31], v2
    v_mfma_f32_32x32x16_bf16 v[16:31], v[88:91], v[8:11], v[32:47]
    s_nop 7
    s_nop 3
    v_exp_f32 v16, v16
    v_exp_f32 v17, v17
    v_exp_f32 v18, v18
    v_exp_f32 v19, v19
    v_exp_f32 v20, v20
    v_exp_f32 v21, v21
    v_exp_f32 v22, v22
    v_exp_f32 v23, v23
    v_exp_f32 v24, v24
    v_exp_f32 v25, v25
    v_exp_f32 v26, v26
    v_exp_f32 v27, v27
    v_exp_f32 v28, v28
    v_exp_f32 v29, v29
    v_exp_f32 v30, v30
    v_exp_f32 v31, v31
    s_nop 1
    v_smfmac_f32_32x32x32_bf16 v[48:63], v[176:179], v[16:23], v2
    v_smfmac_f32_32x32x32_bf16 v[48:63], v[180:183], v[24:31], v2
    v_mfma_f32_32x32x16_bf16 v[16:31], v[92:95], v[8:11], v[32:47]
    s_nop 7
    s_nop 3
    v_exp_f32 v16, v16
    v_exp_f32 v17, v17
    v_exp_f32 v18, v18
    v_exp_f32 v19, v19
    v_exp_f32 v20, v20
    v_exp_f32 v21, v21
    v_exp_f32 v22, v22
    v_exp_f32 v23, v23
    v_exp_f32 v24, v24
    v_exp_f32 v25, v25
    v_exp_f32 v26, v26
    v_exp_f32 v27, v27
    v_exp_f32 v28, v28
    v_exp_f32 v29, v29
    v_exp_f32 v30, v30
    v_exp_f32 v31, v31
    s_nop 1
    v_smfmac_f32_32x32x32_bf16 v[48:63], v[184:187], v[16:23], v2
    v_smfmac_f32_32x32x32_bf16 v[48:63], v[188:191], v[24:31], v2
    v_mfma_f32_32x32x16_bf16 v[16:31], v[96:99], v[8:11], v[32:47]
    s_nop 7
    s_nop 3
    v_exp_f32 v16, v16
    v_exp_f32 v17, v17
    v_exp_f32 v18, v18
    v_exp_f32 v19, v19
    v_exp_f32 v20, v20
    v_exp_f32 v21, v21
    v_exp_f32 v22, v22
    v_exp_f32 v23, v23
    v_exp_f32 v24, v24
    v_exp_f32 v25, v25
    v_exp_f32 v26, v26
    v_exp_f32 v27, v27
    v_exp_f32 v28, v28
    v_exp_f32 v29, v29
    v_exp_f32 v30, v30
    v_exp_f32 v31, v31
    s_nop 1
    v_smfmac_f32_32x32x32_bf16 v[48:63], v[192:195], v[16:23], v2
    v_smfmac_f32_32x32x32_bf16 v[48:63], v[196:199], v[24:31], v2
    v_mfma_f32_32x32x16_bf16 v[16:31], v[100:103], v[8:11], v[32:47]
    s_nop 7
    s_nop 3
    v_exp_f32 v16, v16
    v_exp_f32 v17, v17
    v_exp_f32 v18, v18
    v_exp_f32 v19, v19
    v_exp_f32 v20, v20
    v_exp_f32 v21, v21
    v_exp_f32 v22, v22
    v_exp_f32 v23, v23
    v_exp_f32 v24, v24
    v_exp_f32 v25, v25
    v_exp_f32 v26, v26
    v_exp_f32 v27, v27
    v_exp_f32 v28, v28
    v_exp_f32 v29, v29
    v_exp_f32 v30, v30
    v_exp_f32 v31, v31
    s_nop 1
    v_smfmac_f32_32x32x32_bf16 v[48:63], v[200:203], v[16:23], v2
    v_smfmac_f32_32x32x32_bf16 v[48:63], v[204:207], v[24:31], v2
    v_mfma_f32_32x32x16_bf16 v[16:31], v[104:107], v[8:11], v[32:47]
    s_nop 7
    s_nop 3
    v_exp_f32 v16, v16
    v_exp_f32 v17, v17
    v_exp_f32 v18, v18
    v_exp_f32 v19, v19
    v_exp_f32 v20, v20
    v_exp_f32 v21, v21
    v_exp_f32 v22, v22
    v_exp_f32 v23, v23
    v_exp_f32 v24, v24
    v_exp_f32 v25, v25
    v_exp_f32 v26, v26
    v_exp_f32 v27, v27
    v_exp_f32 v28, v28
    v_exp_f32 v29, v29
    v_exp_f32 v30, v30
    v_exp_f32 v31, v31
    s_nop 1
    v_smfmac_f32_32x32x32_bf16 v[48:63], v[208:211], v[16:23], v2
    v_smfmac_f32_32x32x32_bf16 v[48:63], v[212:215], v[24:31], v2
    v_mfma_f32_32x32x16_bf16 v[16:31], v[108:111], v[8:11], v[32:47]
    s_nop 7
    s_nop 3
    v_exp_f32 v16, v16
    v_exp_f32 v17, v17
    v_exp_f32 v18, v18
    v_exp_f32 v19, v19
    v_exp_f32 v20, v20
    v_exp_f32 v21, v21
    v_exp_f32 v22, v22
    v_exp_f32 v23, v23
    v_exp_f32 v24, v24
    v_exp_f32 v25, v25
    v_exp_f32 v26, v26
    v_exp_f32 v27, v27
    v_exp_f32 v28, v28
    v_exp_f32 v29, v29
    v_exp_f32 v30, v30
    v_exp_f32 v31, v31
    s_nop 1
    v_smfmac_f32_32x32x32_bf16 v[48:63], v[216:219], v[16:23], v2
    v_smfmac_f32_32x32x32_bf16 v[48:63], v[220:223], v[24:31], v2
    v_mfma_f32_32x32x16_bf16 v[16:31], v[112:115], v[8:11], v[32:47]
    s_nop 7
    s_nop 3
    v_exp_f32 v16, v16
    v_exp_f32 v17, v17
    v_exp_f32 v18, v18
    v_exp_f32 v19, v19
    v_exp_f32 v20, v20
    v_exp_f32 v21, v21
    v_exp_f32 v22, v22
    v_exp_f32 v23, v23
    v_exp_f32 v24, v24
    v_exp_f32 v25, v25
    v_exp_f32 v26, v26
    v_exp_f32 v27, v27
    v_exp_f32 v28, v28
    v_exp_f32 v29, v29
    v_exp_f32 v30, v30
    v_exp_f32 v31, v31
    s_nop 1
    v_smfmac_f32_32x32x32_bf16 v[48:63], v[224:227], v[16:23], v2
    v_smfmac_f32_32x32x32_bf16 v[48:63], v[228:231], v[24:31], v2
    v_mfma_f32_32x32x16_bf16 v[16:31], v[116:119], v[8:11], v[32:47]
    s_nop 7
    s_nop 3
    v_exp_f32 v16, v16
    v_exp_f32 v17, v17
    v_exp_f32 v18, v18
    v_exp_f32 v19, v19
    v_exp_f32 v20, v20
    v_exp_f32 v21, v21
    v_exp_f32 v22, v22
    v_exp_f32 v23, v23
    v_exp_f32 v24, v24
    v_exp_f32 v25, v25
    v_exp_f32 v26, v26
    v_exp_f32 v27, v27
    v_exp_f32 v28, v28
    v_exp_f32 v29, v29
    v_exp_f32 v30, v30
    v_exp_f32 v31, v31
    s_nop 1
    v_smfmac_f32_32x32x32_bf16 v[48:63], v[232:235], v[16:23], v2
    v_smfmac_f32_32x32x32_bf16 v[48:63], v[236:239], v[24:31], v2
    v_mfma_f32_32x32x16_bf16 v[16:31], v[120:123], v[8:11], v[32:47]
    s_nop 7
    s_nop 3
    v_exp_f32 v16, v16
    v_exp_f32 v17, v17
    v_exp_f32 v18, v18
    v_exp_f32 v19, v19
    v_exp_f32 v20, v20
    v_exp_f32 v21, v21
    v_exp_f32 v22, v22
    v_exp_f32 v23, v23
    v_exp_f32 v24, v24
    v_exp_f32 v25, v25
    v_exp_f32 v26, v26
    v_exp_f32 v27, v27
    v_exp_f32 v28, v28
    v_exp_f32 v29, v29
    v_exp_f32 v30, v30
    v_exp_f32 v31, v31
    s_nop 1
    v_smfmac_f32_32x32x32_bf16 v[48:63], v[240:243], v[16:23], v2
    v_smfmac_f32_32x32x32_bf16 v[48:63], v[244:247], v[24:31], v2
    v_mfma_f32_32x32x16_bf16 v[16:31], v[124:127], v[8:11], v[32:47]
    s_nop 7
    s_nop 3
    v_exp_f32 v16, v16
    v_exp_f32 v17, v17
    v_exp_f32 v18, v18
    v_exp_f32 v19, v19
    v_exp_f32 v20, v20
    v_exp_f32 v21, v21
    v_exp_f32 v22, v22
    v_exp_f32 v23, v23
    v_exp_f32 v24, v24
    v_exp_f32 v25, v25
    v_exp_f32 v26, v26
    v_exp_f32 v27, v27
    v_exp_f32 v28, v28
    v_exp_f32 v29, v29
    v_exp_f32 v30, v30
    v_exp_f32 v31, v31
    s_nop 1
    v_smfmac_f32_32x32x32_bf16 v[48:63], v[248:251], v[16:23], v2
    v_smfmac_f32_32x32x32_bf16 v[48:63], v[252:255], v[24:31], v2
    s_nop 7
    s_nop 3
    ds_write_b128 v1, v[48:51] offset:0
    ds_write_b128 v1, v[52:55] offset:1024
    ds_write_b32 v3, v56 offset:0
    s_add_u32 s34, s34, 1024
    v_add_u32 v1, 8192, v1
    v_add_u32 v3, 1024, v3
    v_add_u32 v14, 1024, v14
    v_add_u32 v12, 1024, v12
    s_add_u32 s50, s50, 1
    s_cmp_lt_u32 s50, 8
    s_cbranch_scc1 FB_STEP
    s_waitcnt lgkmcnt(0)
    s_barrier
    s_endpgm
ASLOW:
    s_sub_u32 s49, s49, 1
    s_cbranch_scc1 ABAD
    buffer_load_dword v13, v14, s[16:19], 0 offen sc1
    s_waitcnt vmcnt(0)
    v_cmp_eq_u32 vcc, v13, v12
    s_cbranch_vccnz ASLOW
    s_branch AOK
ABAD:
    v_mov_b64 v[4:5], -1
    s_mov_b32 s49, 0
    s_branch AOK
GR0:
    s_waitcnt lgkmcnt(0)
    s_sub_i32 s49, s49, 1
    s_cmp_lt_i32 s49, 0
    s_cbranch_scc1 GOK0
    buffer_load_dwordx4 v[64:67], v0, s[16:19], s36 offen offset:0 sc1
    buffer_load_dwordx4 v[68:71], v0, s[16:19], s36 offen offset:1024 sc1
    s_mov_b64 exec, s[44:45]
    buffer_load_dwordx4 v[128:131], v7, s[16:19], s36 offen offset:0 sc1
    buffer_load_dwordx4 v[132:135], v7, s[16:19], s36 offen offset:512 sc1
    buffer_load_dwordx4 v[136:139], v7, s[16:19], s36 offen offset:1024 sc1
    buffer_load_dwordx4 v[140:143], v7, s[16:19], s36 offen offset:1536 sc1
    s_mov_b64 exec, -1
    s_waitcnt vmcnt(0)
    v_max3_u32 v12, v64, v68, v128
    v_max3_u32 v13, v132, v136, v140
    v_max_u32 v12, v12, v13
    v_cmp_eq_u32 vcc, -1, v12
    s_cbranch_vccnz GR0
    s_branch GOK0
GR1:
    s_waitcnt lgkmcnt(0)
    s_sub_i32 s49, s49, 1
    s_cmp_lt_i32 s49, 0
    s_cbranch_scc1 GOK1
    buffer_load_dwordx4 v[72:75], v0, s[16:19], s37 offen offset:0 sc1
    buffer_load_dwordx4 v[76:79], v0, s[16:19], s37 offen offset:1024 sc1
    s_mov_b64 exec, s[44:45]
    buffer_load_dwordx4 v[144:147], v7, s[16:19], s37 offen offset:0 sc1
    buffer_load_dwordx4 v[148:151], v7, s[16:19], s37 offen offset:512 sc1
    buffer_load_dwordx4 v[152:155], v7, s[16:19], s37 offen offset:1024 sc1
    buffer_load_dwordx4 v[156:159], v7, s[16:19], s37 offen offset:1536 sc1
    s_mov_b64 exec, -1
    s_waitcnt vmcnt(0)
    v_max3_u32 v12, v72, v76, v144
    v_max3_u32 v13, v148, v152, v156
    v_max_u32 v12, v12, v13
    v_cmp_eq_u32 vcc, -1, v12
    s_cbranch_vccnz GR1
    s_branch GOK1
GR2:
    s_waitcnt lgkmcnt(0)
    s_sub_i32 s49, s49, 1
    s_cmp_lt_i32 s49, 0
    s_cbranch_scc1 GOK2
    buffer_load_dwordx4 v[80:83], v0, s[16:19], s38 offen offset:0 sc1
    buffer_load_dwordx4 v[84:87], v0, s[16:19], s38 offen offset:1024 sc1
    s_mov_b64 exec, s[44:45]
    buffer_load_dwordx4 v[160:163], v7, s[16:19], s38 offen offset:0 sc1
    buffer_load_dwordx4 v[164:167], v7, s[16:19], s38 offen offset:512 sc1
    buffer_load_dwordx4 v[168:171], v7, s[16:19], s38 offen offset:1024 sc1
    buffer_load_dwordx4 v[172:175], v7, s[16:19], s38 offen offset:1536 sc1
    s_mov_b64 exec, -1
    s_waitcnt vmcnt(0)
    v_max3_u32 v12, v80, v84, v160
    v_max3_u32 v13, v164, v168, v172
    v_max_u32 v12, v12, v13
    v_cmp_eq_u32 vcc, -1, v12
    s_cbranch_vccnz GR2
    s_branch GOK2
GR3:
    s_waitcnt lgkmcnt(0)
    s_sub_i32 s49, s49, 1
    s_cmp_lt_i32 s49, 0
    s_cbranch_scc1 GOK3
    buffer_load_dwordx4 v[88:91], v0, s[16:19], s39 offen offset:0 sc1
    buffer_load_dwordx4 v[92:95], v0, s[16:19], s39 offen offset:1024 sc1
    s_mov_b64 exec, s[44:45]
    buffer_load_dwordx4 v[176:179], v7, s[16:19], s39 offen offset:0 sc1
    buffer_load_dwordx4 v[180:183], v7, s[16:19], s39 offen offset:512 sc1
    buffer_load_dwordx4 v[184:187], v7, s[16:19], s39 offen offset:1024 sc1
    buffer_load_dwordx4 v[188:191], v7, s[16:19], s39 offen offset:1536 sc1
    s_mov_b64 exec, -1
    s_waitcnt vmcnt(0)
    v_max3_u32 v12, v88, v92, v176
    v_max3_u32 v13, v180, v184, v188
    v_max_u32 v12, v12, v13
    v_cmp_eq_u32 vcc, -1, v12
    s_cbranch_vccnz GR3
    s_branch GOK3
GR4:
    s_waitcnt lgkmcnt(0)
    s_sub_i32 s49, s49, 1
    s_cmp_lt_i32 s49, 0
    s_cbranch_scc1 GOK4
    buffer_load_dwordx4 v[96:99], v0, s[16:19], s40 offen offset:0 sc1
    buffer_load_dwordx4 v[100:103], v0, s[16:19], s40 offen offset:1024 sc1
    s_mov_b64 exec, s[44:45]
    buffer_load_dwordx4 v[192:195], v7, s[16:19], s40 offen offset:0 sc1
    buffer_load_dwordx4 v[196:199], v7, s[16:19], s40 offen offset:512 sc1
    buffer_load_dwordx4 v[200:203], v7, s[16:19], s40 offen offset:1024 sc1
    buffer_load_dwordx4 v[204:207], v7, s[16:19], s40 offen offset:1536 sc1
    s_mov_b64 exec, -1
    s_waitcnt vmcnt(0)
    v_max3_u32 v12, v96, v100, v192
    v_max3_u32 v13, v196, v200, v204
    v_max_u32 v12, v12, v13
    v_cmp_eq_u32 vcc, -1, v12
    s_cbranch_vccnz GR4
    s_branch GOK4
GR5:
    s_waitcnt lgkmcnt(0)
    s_sub_i32 s49, s49, 1
    s_cmp_lt_i32 s49, 0
    s_cbranch_scc1 GOK5
    buffer_load_dwordx4 v[104:107], v0, s[16:19], s41 offen offset:0 sc1
    buffer_load_dwordx4 v[108:111], v0, s[16:19], s41 offen offset:1024 sc1
    s_mov_b64 exec, s[44:45]
    buffer_load_dwordx4 v[208:211], v7, s[16:19], s41 offen offset:0 sc1
    buffer_load_dwordx4 v[212:215], v7, s[16:19], s41 offen offset:512 sc1
    buffer_load_dwordx4 v[216:219], v7, s[16:19], s41 offen offset:1024 sc1
    buffer_load_dwordx4 v[220:223], v7, s[16:19], s41 offen offset:1536 sc1
    s_mov_b64 exec, -1
    s_waitcnt vmcnt(0)
    v_max3_u32 v12, v104, v108, v208
    v_max3_u32 v13, v212, v216, v220
    v_max_u32 v12, v12, v13
    v_cmp_eq_u32 vcc, -1, v12
    s_cbranch_vccnz GR5
    s_branch GOK5
GR6:
    s_waitcnt lgkmcnt(0)
    s_sub_i32 s49, s49, 1
    s_cmp_lt_i32 s49, 0
    s_cbranch_scc1 GOK6
    buffer_load_dwordx4 v[112:115], v0, s[16:19], s42 offen offset:0 sc1
    buffer_load_dwordx4 v[116:119], v0, s[16:19], s42 offen offset:1024 sc1
    s_mov_b64 exec, s[44:45]
    buffer_load_dwordx4 v[224:227], v7, s[16:19], s42 offen offset:0 sc1
    buffer_load_dwordx4 v[228:231], v7, s[16:19], s42 offen offset:512 sc1
    buffer_load_dwordx4 v[232:235], v7, s[16:19], s42 offen offset:1024 sc1
    buffer_load_dwordx4 v[236:239], v7, s[16:19], s42 offen offset:1536 sc1
    s_mov_b64 exec, -1
    s_waitcnt vmcnt(0)
    v_max3_u32 v12, v112, v116, v224
    v_max3_u32 v13, v228, v232, v236
    v_max_u32 v12, v12, v13
    v_cmp_eq_u32 vcc, -1, v12
    s_cbranch_vccnz GR6
    s_branch GOK6
GR7:
    s_waitcnt lgkmcnt(0)
    s_sub_i32 s49, s49, 1
    s_cmp_lt_i32 s49, 0
    s_cbranch_scc1 GOK7
    buffer_load_dwordx4 v[120:123], v0, s[16:19], s43 offen offset:0 sc1
    buffer_load_dwordx4 v[124:127], v0, s[16:19], s43 offen offset:1024 sc1
    s_mov_b64 exec, s[44:45]
    buffer_load_dwordx4 v[240:243], v7, s[16:19], s43 offen offset:0 sc1
    buffer_load_dwordx4 v[244:247], v7, s[16:19], s43 offen offset:512 sc1
    buffer_load_dwordx4 v[248:251], v7, s[16:19], s43 offen offset:1024 sc1
    buffer_load_dwordx4 v[252:255], v7, s[16:19], s43 offen offset:1536 sc1
    s_mov_b64 exec, -1
    s_waitcnt vmcnt(0)
    v_max3_u32 v12, v120, v124, v240
    v_max3_u32 v13, v244, v248, v252
    v_max_u32 v12, v12, v13
    v_cmp_eq_u32 vcc, -1, v12
    s_cbranch_vccnz GR7
    s_branch GOK7
H_GO:
    s_setprio 2
    s_cmp_eq_u32 s3, 6
    s_cbranch_scc0 H_W2
    s_mov_b32 s44, 0x05040100
    s_mov_b32 s45, 0x07060302
    v_perm_b32 v148, v141, v140, s44
    v_perm_b32 v152, v141, v140, s45
    v_perm_b32 v149, v145, v144, s44
    v_perm_b32 v153, v145, v144, s45
    v_perm_b32 v150, v143, v142, s44
    v_perm_b32 v154, v143, v142, s45
    v_perm_b32 v151, v147, v146, s44
    v_perm_b32 v155, v147, v146, s45
    buffer_store_dwordx4 v[148:151], v137, s[16:19], 0 offen sc1
    buffer_store_dwordx4 v[152:155], v137, s[16:19], 0 offen offset:2048 sc1
H_W2:
    s_mul_i32 s57, s38, 4224
    s_lshl_b32 s44, s37, 11
    s_add_u32 s57, s57, s44
    s_add_u32 s57, s57, 2768896
    s_cmp_eq_u32 s37, 1
    s_cselect_b32 s44, 0, 2016
    s_cselect_b32 s45, 0, 32
    s_cselect_b32 s51, 32, 544
    s_add_u32 s43, s35, 8192
    s_add_u32 s45, s45, s43
    s_add_u32 s51, s51, s43
    v_and_b32 v7, 31, v6
    v_lshrrev_b32 v5, 5, v6
    v_and_b32 v8, 3, v7
    v_mul_u32_u24 v8, 4190, v8
    v_lshl_add_u32 v8, v7, 1, v8
    v_lshl_add_u32 v8, v5, 4, v8
    v_bfe_u32 v18, v6, 4, 1
    v_mad_u32_u24 v3, v18, s44, v8
    v_mul_u32_u24 v18, 2016, v18
    v_add_u32 v3, s45, v3
    v_add3_u32 v2, v18, s51, v8
    s_cmp_eq_u32 s37, 1
    s_cselect_b32 s45, 0, 1584
    s_cselect_b32 s51, 0, 768
    s_lshl_b32 s44, -48, s37
    s_add_u32 s45, s45, s35
    s_add_u32 s51, s51, s35
    s_add_u32 s45, s45, 2976
    s_add_u32 s51, s51, 6096
    v_lshl_add_u32 v4, v5, 4, s45
    v_lshl_add_u32 v12, v5, 4, s51
    v_mad_i32_i24 v4, v7, s44, v4
    v_mul_u32_u24 v7, 48, v7
    v_sub_u32 v12, v12, v7
    s_lshl_b32 s40, s40, 16
    s_lshl_b32 s44, s36, 4
    v_add_u32 v8, s42, v0
    s_lshr_b32 s41, s41, s44
    ds_write_b128 v8, v[60:63] offset:6144
    s_lshl_b32 s41, s41, 16
    s_cmp_eq_u32 s37, 1
    s_cbranch_scc0 HF1
    v_mov_b32 v188, s40
    s_mov_b32 exec_hi, 0
    v_add_f32 v188, s41, v188
    ds_write_b64 v3, v[60:61]
    v_cvt_pk_bf16_f32 v188, v188, v188
    s_mov_b64 exec, 1
    ds_write_b16 v3, v188 offset:62
    s_mov_b64 exec, 4
    ds_write_b16 v3, v188 offset:58
    s_mov_b64 exec, -1
HF1:
    s_xor_b32 s40, s37, 1
    s_lshl_b32 s40, s40, 11
    s_add_u32 s41, s35, s40
    s_lshl_b32 s45, s58, 2
    s_add_u32 s45, s45, s33
    s_lshl_b32 s45, s45, 16
    s_lshl_b32 s46, s59, 8
    s_add_u32 s45, s45, s46
    s_add_u32 s45, s45, 4931584
    v_lshrrev_b32 v10, 4, v6
    v_lshlrev_b32 v10, 13, v10
    v_and_b32 v5, 15, v6
    v_lshl_add_u32 v10, v5, 4, v10
    v_add_u32 v10, s45, v10
    s_mov_b32 s46, 16384
    s_mov_b32 s48, 32768
    s_mov_b32 s49, 36864
    s_and_b32 s50, s32, 7
    s_lshl_b32 s50, s50, 2
    s_add_u32 s50, s50, s33
    s_lshl_b32 s50, s50, 14
    s_add_u32 s12, s16, 2228224
    s_addc_u32 s13, s17, 0
    s_mov_b32 s14, 524288
    s_mov_b32 s15, 0x20000
    s_mov_b32 s26, 2097152
    s_mov_b32 s27, 0x20000
    s_mov_b32 s30, 4194304
    s_mov_b32 s31, 0x20000
    s_lshr_b32 s44, s59, 4
    s_lshl_b32 s44, s44, 1
    s_bfe_u32 s45, s59, 0x10002
    s_mul_i32 s45, s45, 3
    s_xor_b32 s44, s44, s45
    s_lshl_b32 s44, s44, 1
    s_and_b32 s45, s59, 1
    s_add_u32 s44, s44, s45
    s_lshl_b32 s44, s44, 2
    s_add_u32 s44, s44, s33
    s_lshl_b32 s44, s44, 3
    s_bfe_u32 s45, s59, 0x10003
    s_add_u32 s44, s44, s45
    s_lshl_b32 s44, s44, 1
    s_bfe_u32 s45, s59, 0x10001
    s_add_u32 s44, s44, s45
    s_lshl_b32 s44, s44, 12
    s_lshl_b32 s45, s58, 7
    v_and_b32 v5, 31, v6
    v_lshrrev_b32 v7, 5, v6
    v_lshl_add_u32 v16, v7, 15, s44
    v_lshl_add_u32 v11, v5, 2, s45
    v_lshl_add_u32 v17, v16, 1, v11
    s_add_u32 s44, s44, s45
    s_lshl_b32 s43, s33, 11
    s_add_u32 s43, s43, 141312
    s_cmp_eq_u32 s33, 3
    s_cselect_b32 s43, 156928, s43
    v_bfe_u32 v8, v6, 3, 2
    v_and_b32 v18, 7, v6
    v_lshl_add_u32 v27, v7, 14, s44
    v_lshl_add_u32 v16, v7, 10, s43
    v_lshl_add_u32 v27, v8, 10, v27
    v_lshl_add_u32 v16, v5, 2, v16
    v_lshl_add_u32 v27, v18, 4, v27
    s_lshl_b32 s44, s32, 13
    s_lshl_b32 s45, s33, 6
    s_add_u32 s44, s44, s45
    s_add_u32 s44, s44, 4931584
    v_lshlrev_b32 v11, 8, v5
    v_lshl_add_u32 v11, v7, 5, v11
    v_add_u32 v11, s44, v11
    v_and_b32 v5, 8, v6
    v_mov_b32 v13, 0x44444444
    v_mov_b32 v14, 0xeeeeeeee
    v_cmp_eq_u32 vcc, 0, v5
    v_mov_b32 v15, 0x7fc00000
    v_cndmask_b32 v13, v14, v13, vcc
    v_add_u32 v14, 75776, v0
    s_mov_b32 s53, 0
    s_lshl_b32 s54, s32, 13
    s_add_u32 s63, s54, 4096
    s_mov_b32 s55, 0x4e800000
    s_movk_i32 s60, 3000
    s_mov_b32 s61, s33
    v_mfma_f32_32x32x8_bf16 v[96:111], v[60:61], v[60:61], 0
    v_mfma_f32_32x32x8_bf16 v[112:127], v[60:61], v[60:61], 0
    s_branch POLL7
POLLW7:
    s_nop 15
    s_nop 15
    s_nop 15
    s_nop 15
POLL7:
    ds_read_b32 v18, v0 offset:7168
    s_sub_u32 s56, s56, 1
    s_cmp_lt_i32 s56, 0
    s_cbranch_scc1 POLLX7
    s_waitcnt lgkmcnt(0)
    v_cmp_eq_u32 vcc, s52, v18
    s_cbranch_vccnz POLLW7
POLLX7:
    s_mov_b32 s74, 2097152
    s_mov_b32 s75, 0x20000
    s_mov_b32 s78, 2097152
    s_mov_b32 s79, 0x20000
    s_cmp_eq_u32 s33, 0
    s_cbranch_scc0 GD1
    s_sub_u32 m0, s94, 1040
    s_mov_b32 exec_lo, 0
    s_mov_b32 exec_hi, 0xffffff00
    buffer_load_dwordx4 v247, s[72:75], 0 offen lds
    s_mov_b64 exec, -1
GD1:
    s_mov_b32 m0, s94
    s_movk_i32 s44, 7152
    buffer_load_dwordx4 v246, s[72:75], 0 offen lds
    buffer_load_dwordx4 v246, s[72:75], s44 offen offset:1040 lds
    s_add_u32 m0, s94, 8320
    s_nop 0
    buffer_load_dwordx4 v246, s[76:79], 0 offen lds
    buffer_load_dwordx4 v246, s[76:79], s44 offen offset:1040 lds
    s_cmp_eq_u32 s3, 6
    s_cbranch_scc0 H_W3
    s_waitcnt vmcnt(4)
    v_add_u32 v138, 1, v138
    s_mov_b64 exec, 1
    buffer_store_dword v138, off, s[16:19], s88 sc1
    s_mov_b64 exec, -1
H_W3:
    s_waitcnt vmcnt(0)
    ds_write_b32 v1, v252
TPOLL:
    ds_read_b32 v18, v251
    s_sub_u32 s56, s56, 1
    s_cmp_lt_i32 s56, 0
    s_cbranch_scc1 TPOLLX
    s_waitcnt lgkmcnt(0)
    v_cmp_eq_u32 vcc, 0, v18
    s_cbranch_vccnz TPOLL
TPOLLX:
    ds_read_b128 v[192:195], v253 offset:0
    ds_read_b128 v[196:199], v253 offset:128
    ds_read_b128 v[200:203], v254 offset:256
    ds_read_b128 v[204:207], v250 offset:400
    ds_read_b128 v[208:211], v250 offset:528
    ds_read_b128 v[212:215], v250 offset:656
    ds_read_b128 v[216:219], v250 offset:8720
    ds_read_b128 v[220:223], v250 offset:8976
    s_add_u32 s20, s4, s39
    s_addc_u32 s21, s5, 0
    s_mov_b32 s22, 4096
    s_mov_b32 s23, 0x20000
    s_add_u32 m0, s41, 20824
    s_nop 0
    buffer_load_dwordx4 v0, s[20:23], s40 offen offset:0 lds
    buffer_load_dwordx4 v0, s[20:23], s40 offen offset:1024 lds
    s_add_u32 m0, s41, 12444
    s_nop 0
    buffer_load_dwordx4 v0, s[20:23], s40 offen offset:0 lds
    buffer_load_dwordx4 v0, s[20:23], s40 offen offset:1024 lds
    s_waitcnt lgkmcnt(7)
    v_mfma_f32_16x16x32_bf16 v[64:67], v[224:227], v[192:195], 0
    s_waitcnt lgkmcnt(6)
    v_mfma_f32_16x16x32_bf16 v[68:71], v[224:227], v[196:199], 0
    s_waitcnt lgkmcnt(5)
    v_mfma_f32_16x16x32_bf16 v[72:75], v[224:227], v[200:203], 0
    v_mfma_f32_16x16x32_bf16 v[64:67], v[228:231], v[200:203], v[64:67]
    s_waitcnt lgkmcnt(4)
    v_mfma_f32_16x16x32_bf16 v[76:79], v[224:227], v[204:207], 0
    v_mfma_f32_16x16x32_bf16 v[68:71], v[228:231], v[204:207], v[68:71]
    s_waitcnt lgkmcnt(3)
    v_mfma_f32_16x16x32_bf16 v[72:75], v[228:231], v[208:211], v[72:75]
    s_waitcnt lgkmcnt(2)
    v_mfma_f32_16x16x32_bf16 v[76:79], v[228:231], v[212:215], v[76:79]
    s_waitcnt lgkmcnt(1)
    v_mfma_f32_16x16x32_bf16 v[80:83], v[232:235], v[216:219], 0
    v_mfma_f32_16x16x32_bf16 v[84:87], v[236:239], v[216:219], 0
    s_waitcnt lgkmcnt(0)
    v_mfma_f32_16x16x32_bf16 v[88:91], v[232:235], v[220:223], 0
    v_mfma_f32_16x16x32_bf16 v[92:95], v[236:239], v[220:223], 0
    s_nop 5
    v_pk_mul_f32 v[64:65], v[64:65], v[80:81]
    v_pk_mul_f32 v[68:69], v[68:69], v[84:85]
    v_pk_mul_f32 v[72:73], v[72:73], v[88:89]
    v_pk_mul_f32 v[76:77], v[76:77], v[92:93]
    v_cvt_pk_bf16_f32 v192, v76, v72
    v_cvt_pk_bf16_f32 v193, v68, v64
    buffer_store_dwordx2 v[192:193], v249, s[16:19], 0 offen sc1
    v_cvt_pk_bf16_f32 v194, v77, v73
    v_cvt_pk_bf16_f32 v195, v69, v65
    s_movk_i32 s44, 4224
    buffer_store_dwordx2 v[194:195], v249, s[16:19], s44 offen sc1
    v_pk_mul_f32 v[66:67], v[66:67], v[82:83]
    v_pk_mul_f32 v[70:71], v[70:71], v[86:87]
    v_pk_mul_f32 v[74:75], v[74:75], v[90:91]
    v_pk_mul_f32 v[78:79], v[78:79], v[94:95]
    v_cvt_pk_bf16_f32 v196, v78, v74
    v_cvt_pk_bf16_f32 v197, v70, v66
    s_movk_i32 s44, 8448
    buffer_store_dwordx2 v[196:197], v249, s[16:19], s44 offen sc1
    v_cvt_pk_bf16_f32 v198, v79, v75
    v_cvt_pk_bf16_f32 v199, v71, v67
    s_movk_i32 s44, 12672
    buffer_store_dwordx2 v[198:199], v249, s[16:19], s44 offen sc1
    s_add_u32 s44, s40, 2
    s_add_u32 m0, s41, 8256
    s_nop 0
    buffer_load_dwordx4 v0, s[20:23], s44 offen offset:0 lds
    buffer_load_dwordx4 v0, s[20:23], s44 offen offset:1024 lds
    s_add_u32 m0, s41, 16636
    s_nop 0
    buffer_load_dwordx4 v0, s[20:23], s44 offen offset:0 lds
    buffer_load_dwordx4 v0, s[20:23], s44 offen offset:1024 lds
    s_cmp_eq_u32 s61, 0
    s_cbranch_scc0 SND1
    s_branch POLL0
POLLW0:
    s_nop 15
    s_nop 15
    s_nop 15
    s_nop 15
POLL0:
    ds_read_b32 v18, v0 offset:0
    s_sub_u32 s56, s56, 1
    s_cmp_lt_i32 s56, 0
    s_cbranch_scc1 POLLX0
    s_waitcnt lgkmcnt(0)
    v_cmp_eq_u32 vcc, s52, v18
    s_cbranch_vccnz POLLW0
POLLX0:
    ds_read_b32 v5, v9 offset:0
    ds_read_b32 v7, v9 offset:256
    ds_read_b32 v8, v9 offset:512
    ds_read_b32 v18, v9 offset:768
    ds_read_b128 v[32:35], v14 offset:0
    ds_read_b128 v[36:39], v14 offset:1024
    ds_read_b128 v[40:43], v14 offset:2048
    ds_read_b128 v[44:47], v14 offset:3072
    ds_read_b128 v[48:51], v14 offset:4096
    ds_read_b128 v[52:55], v14 offset:5120
    ds_read_b128 v[56:59], v14 offset:6144
    ds_read_b128 v[60:63], v14 offset:7168
    s_waitcnt lgkmcnt(8)
    v_add_f32 v5, v5, v7
    v_add_f32 v8, v8, v18
    v_add_f32 v5, v5, v8
    v_rcp_f32 v8, v5
    s_waitcnt lgkmcnt(4)
    v_pk_add_f32 v[32:33], v[32:33], v[40:41]
    v_pk_add_f32 v[34:35], v[34:35], v[42:43]
    v_pk_add_f32 v[36:37], v[36:37], v[44:45]
    v_pk_add_f32 v[38:39], v[38:39], v[46:47]
    v_max_f32 v7, v5, v8
    v_cmp_ge_f32 vcc, s55, v7
    v_cndmask_b32 v8, v15, v8, vcc
    s_waitcnt lgkmcnt(0)
    v_pk_add_f32 v[48:49], v[48:49], v[56:57]
    v_pk_add_f32 v[50:51], v[50:51], v[58:59]
    v_pk_add_f32 v[52:53], v[52:53], v[60:61]
    v_pk_add_f32 v[54:55], v[54:55], v[62:63]
    v_pk_add_f32 v[32:33], v[32:33], v[48:49]
    v_pk_add_f32 v[34:35], v[34:35], v[50:51]
    v_pk_add_f32 v[36:37], v[36:37], v[52:53]
    v_pk_add_f32 v[38:39], v[38:39], v[54:55]
    v_pk_mul_f32 v[32:33], v[32:33], v[8:9] op_sel_hi:[1,0]
    v_pk_mul_f32 v[34:35], v[34:35], v[8:9] op_sel_hi:[1,0]
    v_pk_mul_f32 v[36:37], v[36:37], v[8:9] op_sel_hi:[1,0]
    v_pk_mul_f32 v[38:39], v[38:39], v[8:9] op_sel_hi:[1,0]
    v_cvt_pk_bf16_f32 v28, v32, v33
    v_cvt_pk_bf16_f32 v29, v34, v35
    v_cvt_pk_bf16_f32 v30, v36, v37
    v_cvt_pk_bf16_f32 v31, v38, v39
    s_add_u32 s44, s32, 1
    s_and_b32 s44, s44, 7
    s_and_b32 s45, s32, 0xf8
    s_add_u32 s44, s44, s45
    s_lshl_b32 s44, s44, 13
    s_add_u32 s44, s44, 0
    s_add_u32 s61, s61, 4
    buffer_store_dwordx4 v[28:31], v0, s[16:19], s44 offen sc1
SND1:
    s_waitcnt vmcnt(0)
    s_cmp_eq_u32 s37, 1
    s_cbranch_scc0 HF2
    s_mov_b64 exec, 2
    ds_write_b16 v3, v188 offset:60
    s_mov_b64 exec, 8
    ds_write_b16 v3, v188 offset:56
    s_mov_b64 exec, -1
HF2:
    buffer_load_dword v190, v191, s[16:19], 0 offen sc1
    buffer_load_dwordx4 v[80:83], v0, s[16:19], s57 offen offset:0 sc1
    buffer_load_dwordx4 v[84:87], v0, s[16:19], s57 offen offset:1024 sc1
    v_mov_b64 v[184:185], -1
    v_mov_b64 v[186:187], -1
    s_lshl_b32 s44, s32, 2
    s_add_u32 s44, s44, s33
    s_lshl_b32 s44, s44, 11
    s_add_u32 s44, s44, 4931584
    buffer_store_dwordx4 v[184:187], v0, s[16:19], s44 offen offset:0 sc1
    buffer_store_dwordx4 v[184:187], v0, s[16:19], s44 offen offset:1024 sc1
    s_waitcnt vmcnt(4)
    v_cmp_eq_u32 vcc, v189, v190
    s_cbranch_vccnz WSLOW
WOK:
    s_cmp_eq_u32 s61, 1
    s_cbranch_scc0 SND2
    s_branch POLL1
POLLW1:
    s_nop 15
    s_nop 15
    s_nop 15
    s_nop 15
POLL1:
    ds_read_b32 v18, v0 offset:1024
    s_sub_u32 s56, s56, 1
    s_cmp_lt_i32 s56, 0
    s_cbranch_scc1 POLLX1
    s_waitcnt lgkmcnt(0)
    v_cmp_eq_u32 vcc, s52, v18
    s_cbranch_vccnz POLLW1
POLLX1:
    ds_read_b32 v5, v9 offset:1024
    ds_read_b32 v7, v9 offset:1280
    ds_read_b32 v8, v9 offset:1536
    ds_read_b32 v18, v9 offset:1792
    ds_read_b128 v[32:35], v14 offset:8192
    ds_read_b128 v[36:39], v14 offset:9216
    ds_read_b128 v[40:43], v14 offset:10240
    ds_read_b128 v[44:47], v14 offset:11264
    ds_read_b128 v[48:51], v14 offset:12288
    ds_read_b128 v[52:55], v14 offset:13312
    ds_read_b128 v[56:59], v14 offset:14336
    ds_read_b128 v[60:63], v14 offset:15360
    s_waitcnt lgkmcnt(8)
    v_add_f32 v5, v5, v7
    v_add_f32 v8, v8, v18
    v_add_f32 v5, v5, v8
    v_rcp_f32 v8, v5
    s_waitcnt lgkmcnt(4)
    v_pk_add_f32 v[32:33], v[32:33], v[40:41]
    v_pk_add_f32 v[34:35], v[34:35], v[42:43]
    v_pk_add_f32 v[36:37], v[36:37], v[44:45]
    v_pk_add_f32 v[38:39], v[38:39], v[46:47]
    v_max_f32 v7, v5, v8
    v_cmp_ge_f32 vcc, s55, v7
    v_cndmask_b32 v8, v15, v8, vcc
    s_waitcnt lgkmcnt(0)
    v_pk_add_f32 v[48:49], v[48:49], v[56:57]
    v_pk_add_f32 v[50:51], v[50:51], v[58:59]
    v_pk_add_f32 v[52:53], v[52:53], v[60:61]
    v_pk_add_f32 v[54:55], v[54:55], v[62:63]
    v_pk_add_f32 v[32:33], v[32:33], v[48:49]
    v_pk_add_f32 v[34:35], v[34:35], v[50:51]
    v_pk_add_f32 v[36:37], v[36:37], v[52:53]
    v_pk_add_f32 v[38:39], v[38:39], v[54:55]
    v_pk_mul_f32 v[32:33], v[32:33], v[8:9] op_sel_hi:[1,0]
    v_pk_mul_f32 v[34:35], v[34:35], v[8:9] op_sel_hi:[1,0]
    v_pk_mul_f32 v[36:37], v[36:37], v[8:9] op_sel_hi:[1,0]
    v_pk_mul_f32 v[38:39], v[38:39], v[8:9] op_sel_hi:[1,0]
    v_cvt_pk_bf16_f32 v28, v32, v33
    v_cvt_pk_bf16_f32 v29, v34, v35
    v_cvt_pk_bf16_f32 v30, v36, v37
    v_cvt_pk_bf16_f32 v31, v38, v39
    s_add_u32 s44, s32, 2
    s_and_b32 s44, s44, 7
    s_and_b32 s45, s32, 0xf8
    s_add_u32 s44, s44, s45
    s_lshl_b32 s44, s44, 13
    s_add_u32 s44, s44, 1024
    s_add_u32 s61, s61, 4
    buffer_store_dwordx4 v[28:31], v0, s[16:19], s44 offen sc1
SND2:
    s_mul_i32 s44, s37, 3072
    s_add_u32 s44, s44, s35
    v_lshrrev_b32 v8, 1, v6
    v_lshl_add_u32 v8, v8, 4, v0
    v_add_u32 v8, s44, v8
    s_waitcnt vmcnt(2)
    v_max3_u32 v5, v80, v82, v84
    v_max_u32 v5, v5, v86
    v_cmp_eq_u32 vcc, -1, v5
    s_cbranch_vccnz USLOW
UOK:
    ds_write_b128 v8, v[80:83] offset:0
    ds_write_b128 v8, v[84:87] offset:1536
    v_mov_b32 v7, 2
    ds_write_b32 v1, v7
    v_xor_b32 v8, 256, v1
MPOLL:
    ds_read_b32 v18, v8
    s_sub_u32 s56, s56, 1
    s_cmp_lt_i32 s56, 0
    s_cbranch_scc1 MPOLLX
    s_waitcnt lgkmcnt(0)
    v_cmp_gt_u32 vcc, 2, v18
    s_cbranch_vccnz MPOLL
MPOLLX:
    v_mov_b64 v[32:33], 0
    v_mov_b64 v[34:35], 0
    s_mov_b32 exec_lo, 0xffff
    s_mov_b32 exec_hi, 0xffff
    ds_read_b64 v[32:33], v3 offset:2048
    ds_read_b64 v[34:35], v3 offset:2056
    s_mov_b64 exec, -1
    ds_read_b128 v[36:39], v4 offset:3072
    s_setprio 0
    ds_read2_b64 v[40:43], v2 offset0:0 offset1:1
    ds_read_b128 v[44:47], v12 offset:0
    ds_read2_b64 v[48:51], v3 offset0:0 offset1:1
    ds_read_b128 v[52:55], v4 offset:0
    s_waitcnt lgkmcnt(4)
    v_mfma_f32_32x32x16_bf16 v[64:79], v[32:35], v[36:39], 0
    s_mov_b32 m0, s43
    s_add_u32 s44, s43, 1024
    buffer_load_dwordx4 v27, s[24:27], 0 offen lds
    s_mov_b32 m0, s44
    s_nop 0
    buffer_load_dwordx4 v27, s[24:27], s48 offen lds
    ds_read2_b64 v[56:59], v3 offset0:4 offset1:5
    ds_read_b128 v[60:63], v4 offset:48
    s_waitcnt lgkmcnt(4)
    v_mfma_f32_32x32x16_bf16 v[80:95], v[40:43], v[44:47], 0
    s_add_u32 s51, s50, 458752
    s_and_b32 s51, s51, 0x7ffff
    buffer_load_dwordx4 v[128:131], v0, s[12:15], s51 offen offset:0 sc1
    ds_read2_b64 v[32:35], v3 offset0:8 offset1:9
    ds_read_b128 v[36:39], v4 offset:96
    s_waitcnt lgkmcnt(4)
    v_mfma_f32_32x32x16_bf16 v[64:79], v[48:51], v[52:55], v[64:79]
    buffer_load_dwordx4 v[132:135], v0, s[12:15], s51 offen offset:1024 sc1
    ds_read2_b64 v[40:43], v3 offset0:12 offset1:13
    ds_read_b128 v[44:47], v4 offset:144
    s_waitcnt lgkmcnt(4)
    v_mfma_f32_32x32x16_bf16 v[64:79], v[56:59], v[60:63], v[64:79]
    buffer_load_dwordx4 v[136:139], v0, s[12:15], s51 offen offset:2048 sc1
    ds_read2_b64 v[48:51], v2 offset0:4 offset1:5
    ds_read_b128 v[52:55], v12 offset:48
    s_waitcnt lgkmcnt(4)
    v_mfma_f32_32x32x16_bf16 v[64:79], v[32:35], v[36:39], v[64:79]
    buffer_load_dwordx4 v[140:143], v0, s[12:15], s51 offen offset:3072 sc1
    ds_read2_b64 v[56:59], v3 offset0:16 offset1:17
    ds_read_b128 v[60:63], v4 offset:192
    s_waitcnt lgkmcnt(4)
    v_mfma_f32_32x32x16_bf16 v[64:79], v[40:43], v[44:47], v[64:79]
    s_add_u32 s51, s50, 462848
    s_and_b32 s51, s51, 0x7ffff
    buffer_load_dwordx4 v[144:147], v0, s[12:15], s51 offen offset:0 sc1
    buffer_load_dwordx4 v[148:151], v0, s[12:15], s51 offen offset:1024 sc1
    ds_read2_b64 v[32:35], v3 offset0:20 offset1:21
    ds_read_b128 v[36:39], v4 offset:240
    s_waitcnt lgkmcnt(4)
    v_mfma_f32_32x32x16_bf16 v[80:95], v[48:51], v[52:55], v[80:95]
    buffer_load_dwordx4 v[152:155], v0, s[12:15], s51 offen offset:2048 sc1
    ds_read2_b64 v[40:43], v3 offset0:24 offset1:25
    ds_read_b128 v[44:47], v4 offset:288
    s_waitcnt lgkmcnt(4)
    v_mfma_f32_32x32x16_bf16 v[64:79], v[56:59], v[60:63], v[64:79]
    buffer_load_dwordx4 v[156:159], v0, s[12:15], s51 offen offset:3072 sc1
    ds_read2_b64 v[48:51], v3 offset0:28 offset1:29
    ds_read_b128 v[52:55], v4 offset:336
    s_waitcnt lgkmcnt(4)
    v_mfma_f32_32x32x16_bf16 v[64:79], v[32:35], v[36:39], v[64:79]
    s_add_u32 s51, s50, 466944
    s_and_b32 s51, s51, 0x7ffff
    buffer_load_dwordx4 v[160:163], v0, s[12:15], s51 offen offset:0 sc1
    ds_read2_b64 v[56:59], v2 offset0:8 offset1:9
    ds_read_b128 v[60:63], v12 offset:96
    s_waitcnt lgkmcnt(4)
    v_mfma_f32_32x32x16_bf16 v[64:79], v[40:43], v[44:47], v[64:79]
    buffer_load_dwordx4 v[164:167], v0, s[12:15], s51 offen offset:1024 sc1
    ds_read2_b64 v[32:35], v3 offset0:32 offset1:33
    ds_read_b128 v[36:39], v4 offset:384
    s_waitcnt lgkmcnt(4)
    v_mfma_f32_32x32x16_bf16 v[64:79], v[48:51], v[52:55], v[64:79]
    buffer_load_dwordx4 v[168:171], v0, s[12:15], s51 offen offset:2048 sc1
    ds_read2_b64 v[40:43], v3 offset0:36 offset1:37
    ds_read_b128 v[44:47], v4 offset:432
    s_waitcnt lgkmcnt(4)
    v_mfma_f32_32x32x16_bf16 v[80:95], v[56:59], v[60:63], v[80:95]
    buffer_load_dwordx4 v[172:175], v0, s[12:15], s51 offen offset:3072 sc1
    s_add_u32 s51, s50, 471040
    s_and_b32 s51, s51, 0x7ffff
    buffer_load_dwordx4 v[176:179], v0, s[12:15], s51 offen offset:0 sc1
    ds_read2_b64 v[48:51], v3 offset0:40 offset1:41
    ds_read_b128 v[52:55], v4 offset:480
    s_waitcnt lgkmcnt(4)
    v_mfma_f32_32x32x16_bf16 v[64:79], v[32:35], v[36:39], v[64:79]
    buffer_load_dwordx4 v[180:183], v0, s[12:15], s51 offen offset:1024 sc1
    ds_read2_b64 v[56:59], v3 offset0:44 offset1:45
    ds_read_b128 v[60:63], v4 offset:528
    s_waitcnt lgkmcnt(4)
    v_mfma_f32_32x32x16_bf16 v[64:79], v[40:43], v[44:47], v[64:79]
    buffer_load_dwordx4 v[184:187], v0, s[12:15], s51 offen offset:2048 sc1
    ds_read2_b64 v[32:35], v2 offset0:12 offset1:13
    ds_read_b128 v[36:39], v12 offset:144
    s_waitcnt lgkmcnt(4)
    v_mfma_f32_32x32x16_bf16 v[64:79], v[48:51], v[52:55], v[64:79]
    buffer_load_dwordx4 v[188:191], v0, s[12:15], s51 offen offset:3072 sc1
    ds_read2_b64 v[40:43], v3 offset0:48 offset1:49
    ds_read_b128 v[44:47], v4 offset:576
    s_waitcnt lgkmcnt(4)
    v_mfma_f32_32x32x16_bf16 v[64:79], v[56:59], v[60:63], v[64:79]
    buffer_load_dwordx4 v[20:23], v0, s[16:19], s54 offen offset:0 sc1
    ds_read2_b64 v[48:51], v3 offset0:52 offset1:53
    ds_read_b128 v[52:55], v4 offset:624
    s_waitcnt lgkmcnt(4)
    v_mfma_f32_32x32x16_bf16 v[80:95], v[32:35], v[36:39], v[80:95]
    buffer_load_dwordx4 v[24:27], v0, s[16:19], s54 offen offset:1024 sc1
    ds_read2_b64 v[56:59], v3 offset0:56 offset1:57
    ds_read_b128 v[60:63], v4 offset:672
    s_waitcnt lgkmcnt(4)
    v_mfma_f32_32x32x16_bf16 v[64:79], v[40:43], v[44:47], v[64:79]
    s_add_u32 s51, s50, 393216
    s_and_b32 s51, s51, 0x7ffff
    buffer_load_dwordx4 v[192:195], v0, s[12:15], s51 offen offset:0 sc1
    buffer_load_dwordx4 v[196:199], v0, s[12:15], s51 offen offset:1024 sc1
    ds_read2_b64 v[32:35], v3 offset0:60 offset1:61
    ds_read_b128 v[36:39], v4 offset:720
    s_waitcnt lgkmcnt(4)
    v_mfma_f32_32x32x16_bf16 v[64:79], v[48:51], v[52:55], v[64:79]
    buffer_load_dwordx4 v[200:203], v0, s[12:15], s51 offen offset:2048 sc1
    ds_read2_b64 v[40:43], v2 offset0:16 offset1:17
    ds_read_b128 v[44:47], v12 offset:192
    s_waitcnt lgkmcnt(4)
    v_mfma_f32_32x32x16_bf16 v[64:79], v[56:59], v[60:63], v[64:79]
    buffer_load_dwordx4 v[204:207], v0, s[12:15], s51 offen offset:3072 sc1
    ds_read2_b64 v[48:51], v3 offset0:64 offset1:65
    ds_read_b128 v[52:55], v4 offset:768
    s_waitcnt lgkmcnt(4)
    v_mfma_f32_32x32x16_bf16 v[64:79], v[32:35], v[36:39], v[64:79]
    s_add_u32 s51, s50, 397312
    s_and_b32 s51, s51, 0x7ffff
    buffer_load_dwordx4 v[208:211], v0, s[12:15], s51 offen offset:0 sc1
    ds_read2_b64 v[56:59], v3 offset0:68 offset1:69
    ds_read_b128 v[60:63], v4 offset:816
    s_waitcnt lgkmcnt(4)
    v_mfma_f32_32x32x16_bf16 v[80:95], v[40:43], v[44:47], v[80:95]
    buffer_load_dwordx4 v[212:215], v0, s[12:15], s51 offen offset:1024 sc1
    ds_read2_b64 v[32:35], v3 offset0:72 offset1:73
    ds_read_b128 v[36:39], v4 offset:864
    s_waitcnt lgkmcnt(4)
    v_mfma_f32_32x32x16_bf16 v[64:79], v[48:51], v[52:55], v[64:79]
    buffer_load_dwordx4 v[216:219], v0, s[12:15], s51 offen offset:2048 sc1
    ds_read2_b64 v[40:43], v3 offset0:76 offset1:77
    ds_read_b128 v[44:47], v4 offset:912
    s_waitcnt lgkmcnt(4)
    v_mfma_f32_32x32x16_bf16 v[64:79], v[56:59], v[60:63], v[64:79]
    buffer_load_dwordx4 v[220:223], v0, s[12:15], s51 offen offset:3072 sc1
    s_add_u32 s51, s50, 401408
    s_and_b32 s51, s51, 0x7ffff
    buffer_load_dwordx4 v[224:227], v0, s[12:15], s51 offen offset:0 sc1
    ds_read2_b64 v[48:51], v2 offset0:20 offset1:21
    ds_read_b128 v[52:55], v12 offset:240
    s_waitcnt lgkmcnt(4)
    v_mfma_f32_32x32x16_bf16 v[64:79], v[32:35], v[36:39], v[64:79]
    buffer_load_dwordx4 v[228:231], v0, s[12:15], s51 offen offset:1024 sc1
    ds_read2_b64 v[56:59], v3 offset0:80 offset1:81
    ds_read_b128 v[60:63], v4 offset:960
    s_waitcnt lgkmcnt(4)
    v_mfma_f32_32x32x16_bf16 v[64:79], v[40:43], v[44:47], v[64:79]
    buffer_load_dwordx4 v[232:235], v0, s[12:15], s51 offen offset:2048 sc1
    ds_read2_b64 v[32:35], v3 offset0:84 offset1:85
    ds_read_b128 v[36:39], v4 offset:1008
    s_waitcnt lgkmcnt(4)
    v_mfma_f32_32x32x16_bf16 v[80:95], v[48:51], v[52:55], v[80:95]
    buffer_load_dwordx4 v[236:239], v0, s[12:15], s51 offen offset:3072 sc1
    ds_read2_b64 v[40:43], v3 offset0:88 offset1:89
    ds_read_b128 v[44:47], v4 offset:1056
    s_waitcnt lgkmcnt(4)
    v_mfma_f32_32x32x16_bf16 v[64:79], v[56:59], v[60:63], v[64:79]
    s_add_u32 s51, s50, 405504
    s_and_b32 s51, s51, 0x7ffff
    buffer_load_dwordx4 v[240:243], v0, s[12:15], s51 offen offset:0 sc1
    s_waitcnt lgkmcnt(2)
    v_mfma_f32_32x32x16_bf16 v[64:79], v[32:35], v[36:39], v[64:79]
    buffer_load_dwordx4 v[244:247], v0, s[12:15], s51 offen offset:1024 sc1
    s_waitcnt lgkmcnt(0)
    v_mfma_f32_32x32x16_bf16 v[64:79], v[40:43], v[44:47], v[64:79]
    buffer_load_dwordx4 v[248:251], v0, s[12:15], s51 offen offset:2048 sc1
    buffer_load_dwordx4 v[252:255], v0, s[12:15], s51 offen offset:3072 sc1
    s_setprio 2
    s_cmp_eq_u32 s61, 2
    s_cbranch_scc0 SND3
    s_branch POLL2
POLLW2:
    s_nop 15
    s_nop 15
    s_nop 15
    s_nop 15
POLL2:
    ds_read_b32 v18, v0 offset:2048
    s_sub_u32 s56, s56, 1
    s_cmp_lt_i32 s56, 0
    s_cbranch_scc1 POLLX2
    s_waitcnt lgkmcnt(0)
    v_cmp_eq_u32 vcc, s52, v18
    s_cbranch_vccnz POLLW2
POLLX2:
    ds_read_b32 v5, v9 offset:2048
    ds_read_b32 v7, v9 offset:2304
    ds_read_b32 v8, v9 offset:2560
    ds_read_b32 v18, v9 offset:2816
    ds_read_b128 v[32:35], v14 offset:16384
    ds_read_b128 v[36:39], v14 offset:17408
    ds_read_b128 v[40:43], v14 offset:18432
    ds_read_b128 v[44:47], v14 offset:19456
    ds_read_b128 v[48:51], v14 offset:20480
    ds_read_b128 v[52:55], v14 offset:21504
    ds_read_b128 v[56:59], v14 offset:22528
    ds_read_b128 v[60:63], v14 offset:23552
    s_waitcnt lgkmcnt(8)
    v_add_f32 v5, v5, v7
    v_add_f32 v8, v8, v18
    v_add_f32 v5, v5, v8
    v_rcp_f32 v8, v5
    s_waitcnt lgkmcnt(4)
    v_pk_add_f32 v[32:33], v[32:33], v[40:41]
    v_pk_add_f32 v[34:35], v[34:35], v[42:43]
    v_pk_add_f32 v[36:37], v[36:37], v[44:45]
    v_pk_add_f32 v[38:39], v[38:39], v[46:47]
    v_max_f32 v7, v5, v8
    v_cmp_ge_f32 vcc, s55, v7
    v_cndmask_b32 v8, v15, v8, vcc
    s_waitcnt lgkmcnt(0)
    v_pk_add_f32 v[48:49], v[48:49], v[56:57]
    v_pk_add_f32 v[50:51], v[50:51], v[58:59]
    v_pk_add_f32 v[52:53], v[52:53], v[60:61]
    v_pk_add_f32 v[54:55], v[54:55], v[62:63]
    v_pk_add_f32 v[32:33], v[32:33], v[48:49]
    v_pk_add_f32 v[34:35], v[34:35], v[50:51]
    v_pk_add_f32 v[36:37], v[36:37], v[52:53]
    v_pk_add_f32 v[38:39], v[38:39], v[54:55]
    v_pk_mul_f32 v[32:33], v[32:33], v[8:9] op_sel_hi:[1,0]
    v_pk_mul_f32 v[34:35], v[34:35], v[8:9] op_sel_hi:[1,0]
    v_pk_mul_f32 v[36:37], v[36:37], v[8:9] op_sel_hi:[1,0]
    v_pk_mul_f32 v[38:39], v[38:39], v[8:9] op_sel_hi:[1,0]
    v_cvt_pk_bf16_f32 v28, v32, v33
    v_cvt_pk_bf16_f32 v29, v34, v35
    v_cvt_pk_bf16_f32 v30, v36, v37
    v_cvt_pk_bf16_f32 v31, v38, v39
    s_add_u32 s44, s32, 3
    s_and_b32 s44, s44, 7
    s_and_b32 s45, s32, 0xf8
    s_add_u32 s44, s44, s45
    s_lshl_b32 s44, s44, 13
    s_add_u32 s44, s44, 2048
    s_add_u32 s61, s61, 4
    buffer_store_dwordx4 v[28:31], v0, s[16:19], s44 offen sc1
SND3:
    s_waitcnt vmcnt(17)
    v_cmp_eq_u32 vcc, -1, v20
    s_cbranch_vccnz OSLOW0
OOK0:
    s_setprio 0
    v_smfmac_f32_16x16x64_bf16 v[96:99], v[20:23], v[128:135], v13
    v_smfmac_f32_16x16x64_bf16 v[100:103], v[20:23], v[136:143], v13
    v_smfmac_f32_16x16x64_bf16 v[104:107], v[20:23], v[144:151], v13
    v_smfmac_f32_16x16x64_bf16 v[108:111], v[20:23], v[152:159], v13
    v_smfmac_f32_16x16x64_bf16 v[112:115], v[20:23], v[160:167], v13
    v_smfmac_f32_16x16x64_bf16 v[116:119], v[20:23], v[168:175], v13
    v_smfmac_f32_16x16x64_bf16 v[120:123], v[20:23], v[176:183], v13
    v_smfmac_f32_16x16x64_bf16 v[124:127], v[20:23], v[184:191], v13
    s_setprio 2
    s_waitcnt vmcnt(16)
    v_cmp_eq_u32 vcc, -1, v24
    s_cbranch_vccnz OSLOW1
OOK1:
    s_waitcnt vmcnt(0)
    s_setprio 0
    v_smfmac_f32_16x16x64_bf16 v[96:99], v[24:27], v[192:199], v13
    v_smfmac_f32_16x16x64_bf16 v[100:103], v[24:27], v[200:207], v13
    v_smfmac_f32_16x16x64_bf16 v[104:107], v[24:27], v[208:215], v13
    v_smfmac_f32_16x16x64_bf16 v[108:111], v[24:27], v[216:223], v13
    v_smfmac_f32_16x16x64_bf16 v[112:115], v[24:27], v[224:231], v13
    v_smfmac_f32_16x16x64_bf16 v[116:119], v[24:27], v[232:239], v13
    v_smfmac_f32_16x16x64_bf16 v[120:123], v[24:27], v[240:247], v13
    v_smfmac_f32_16x16x64_bf16 v[124:127], v[24:27], v[248:255], v13
    s_setprio 2
    ds_read2_b64 v[48:51], v3 offset0:92 offset1:93
    ds_read_b128 v[52:55], v4 offset:1104
    s_setprio 0
    ds_read2_b64 v[56:59], v2 offset0:24 offset1:25
    ds_read_b128 v[60:63], v12 offset:288
    ds_read2_b64 v[32:35], v3 offset0:96 offset1:97
    ds_read_b128 v[36:39], v4 offset:1152
    s_waitcnt lgkmcnt(4)
    v_mfma_f32_32x32x16_bf16 v[64:79], v[48:51], v[52:55], v[64:79]
    s_nop 0
    ds_read2_b64 v[40:43], v3 offset0:100 offset1:101
    ds_read_b128 v[44:47], v4 offset:1200
    s_waitcnt lgkmcnt(4)
    v_mfma_f32_32x32x16_bf16 v[80:95], v[56:59], v[60:63], v[80:95]
    s_add_u32 s51, s50, 327680
    s_and_b32 s51, s51, 0x7ffff
    buffer_load_dwordx4 v[128:131], v0, s[12:15], s51 offen offset:0 sc1
    ds_read2_b64 v[48:51], v3 offset0:104 offset1:105
    ds_read_b128 v[52:55], v4 offset:1248
    s_waitcnt lgkmcnt(4)
    v_mfma_f32_32x32x16_bf16 v[64:79], v[32:35], v[36:39], v[64:79]
    buffer_load_dwordx4 v[132:135], v0, s[12:15], s51 offen offset:1024 sc1
    ds_read2_b64 v[56:59], v3 offset0:108 offset1:109
    ds_read_b128 v[60:63], v4 offset:1296
    s_waitcnt lgkmcnt(4)
    v_mfma_f32_32x32x16_bf16 v[64:79], v[40:43], v[44:47], v[64:79]
    buffer_load_dwordx4 v[136:139], v0, s[12:15], s51 offen offset:2048 sc1
    ds_read2_b64 v[32:35], v2 offset0:28 offset1:29
    ds_read_b128 v[36:39], v12 offset:336
    s_waitcnt lgkmcnt(4)
    v_mfma_f32_32x32x16_bf16 v[64:79], v[48:51], v[52:55], v[64:79]
    s_nop 0
    ds_read2_b64 v[40:43], v3 offset0:112 offset1:113
    ds_read_b128 v[44:47], v4 offset:1344
    s_waitcnt lgkmcnt(4)
    v_mfma_f32_32x32x16_bf16 v[64:79], v[56:59], v[60:63], v[64:79]
    buffer_load_dwordx4 v[140:143], v0, s[12:15], s51 offen offset:3072 sc1
    ds_read2_b64 v[48:51], v3 offset0:116 offset1:117
    ds_read_b128 v[52:55], v4 offset:1392
    s_waitcnt lgkmcnt(4)
    v_mfma_f32_32x32x16_bf16 v[80:95], v[32:35], v[36:39], v[80:95]
    s_add_u32 s51, s50, 331776
    s_and_b32 s51, s51, 0x7ffff
    buffer_load_dwordx4 v[144:147], v0, s[12:15], s51 offen offset:0 sc1
    ds_read2_b64 v[56:59], v3 offset0:120 offset1:121
    ds_read_b128 v[60:63], v4 offset:1440
    s_waitcnt lgkmcnt(4)
    v_mfma_f32_32x32x16_bf16 v[64:79], v[40:43], v[44:47], v[64:79]
    buffer_load_dwordx4 v[148:151], v0, s[12:15], s51 offen offset:1024 sc1
    ds_read2_b64 v[32:35], v3 offset0:124 offset1:125
    ds_read_b128 v[36:39], v4 offset:1488
    s_waitcnt lgkmcnt(4)
    v_mfma_f32_32x32x16_bf16 v[64:79], v[48:51], v[52:55], v[64:79]
    buffer_load_dwordx4 v[152:155], v0, s[12:15], s51 offen offset:2048 sc1
    ds_read2_b64 v[40:43], v2 offset0:32 offset1:33
    ds_read_b128 v[44:47], v12 offset:384
    s_waitcnt lgkmcnt(4)
    v_mfma_f32_32x32x16_bf16 v[64:79], v[56:59], v[60:63], v[64:79]
    s_nop 0
    ds_read2_b64 v[48:51], v3 offset0:128 offset1:129
    ds_read_b128 v[52:55], v4 offset:1536
    s_waitcnt lgkmcnt(4)
    v_mfma_f32_32x32x16_bf16 v[64:79], v[32:35], v[36:39], v[64:79]
    buffer_load_dwordx4 v[156:159], v0, s[12:15], s51 offen offset:3072 sc1
    ds_read2_b64 v[56:59], v3 offset0:132 offset1:133
    ds_read_b128 v[60:63], v4 offset:1584
    s_waitcnt lgkmcnt(4)
    v_mfma_f32_32x32x16_bf16 v[80:95], v[40:43], v[44:47], v[80:95]
    s_add_u32 s51, s50, 335872
    s_and_b32 s51, s51, 0x7ffff
    buffer_load_dwordx4 v[160:163], v0, s[12:15], s51 offen offset:0 sc1
    ds_read2_b64 v[32:35], v3 offset0:136 offset1:137
    ds_read_b128 v[36:39], v4 offset:1632
    s_waitcnt lgkmcnt(4)
    v_mfma_f32_32x32x16_bf16 v[64:79], v[48:51], v[52:55], v[64:79]
    buffer_load_dwordx4 v[164:167], v0, s[12:15], s51 offen offset:1024 sc1
    ds_read2_b64 v[40:43], v3 offset0:140 offset1:141
    ds_read_b128 v[44:47], v4 offset:1680
    s_waitcnt lgkmcnt(4)
    v_mfma_f32_32x32x16_bf16 v[64:79], v[56:59], v[60:63], v[64:79]
    buffer_load_dwordx4 v[168:171], v0, s[12:15], s51 offen offset:2048 sc1
    ds_read2_b64 v[48:51], v2 offset0:36 offset1:37
    ds_read_b128 v[52:55], v12 offset:432
    s_waitcnt lgkmcnt(4)
    v_mfma_f32_32x32x16_bf16 v[64:79], v[32:35], v[36:39], v[64:79]
    s_nop 0
    ds_read2_b64 v[56:59], v3 offset0:144 offset1:145
    ds_read_b128 v[60:63], v4 offset:1728
    s_waitcnt lgkmcnt(4)
    v_mfma_f32_32x32x16_bf16 v[64:79], v[40:43], v[44:47], v[64:79]
    buffer_load_dwordx4 v[172:175], v0, s[12:15], s51 offen offset:3072 sc1
    ds_read2_b64 v[32:35], v3 offset0:148 offset1:149
    ds_read_b128 v[36:39], v4 offset:1776
    s_waitcnt lgkmcnt(4)
    v_mfma_f32_32x32x16_bf16 v[80:95], v[48:51], v[52:55], v[80:95]
    s_add_u32 s51, s50, 339968
    s_and_b32 s51, s51, 0x7ffff
    buffer_load_dwordx4 v[176:179], v0, s[12:15], s51 offen offset:0 sc1
    ds_read2_b64 v[40:43], v3 offset0:152 offset1:153
    ds_read_b128 v[44:47], v4 offset:1824
    s_waitcnt lgkmcnt(4)
    v_mfma_f32_32x32x16_bf16 v[64:79], v[56:59], v[60:63], v[64:79]
    buffer_load_dwordx4 v[180:183], v0, s[12:15], s51 offen offset:1024 sc1
    ds_read2_b64 v[48:51], v3 offset0:156 offset1:157
    ds_read_b128 v[52:55], v4 offset:1872
    s_waitcnt lgkmcnt(4)
    v_mfma_f32_32x32x16_bf16 v[64:79], v[32:35], v[36:39], v[64:79]
    s_nop 0
    ds_read2_b64 v[56:59], v2 offset0:40 offset1:41
    ds_read_b128 v[60:63], v12 offset:480
    s_waitcnt lgkmcnt(4)
    v_mfma_f32_32x32x16_bf16 v[64:79], v[40:43], v[44:47], v[64:79]
    buffer_load_dwordx4 v[184:187], v0, s[12:15], s51 offen offset:2048 sc1
    ds_read2_b64 v[32:35], v3 offset0:160 offset1:161
    ds_read_b128 v[36:39], v4 offset:1920
    s_waitcnt lgkmcnt(4)
    v_mfma_f32_32x32x16_bf16 v[64:79], v[48:51], v[52:55], v[64:79]
    buffer_load_dwordx4 v[188:191], v0, s[12:15], s51 offen offset:3072 sc1
    ds_read2_b64 v[40:43], v3 offset0:164 offset1:165
    ds_read_b128 v[44:47], v4 offset:1968
    s_waitcnt lgkmcnt(4)
    v_mfma_f32_32x32x16_bf16 v[80:95], v[56:59], v[60:63], v[80:95]
    s_add_u32 s51, s50, 262144
    s_and_b32 s51, s51, 0x7ffff
    buffer_load_dwordx4 v[192:195], v0, s[12:15], s51 offen offset:0 sc1
    ds_read2_b64 v[48:51], v3 offset0:168 offset1:169
    ds_read_b128 v[52:55], v4 offset:2016
    s_waitcnt lgkmcnt(4)
    v_mfma_f32_32x32x16_bf16 v[64:79], v[32:35], v[36:39], v[64:79]
    buffer_load_dwordx4 v[196:199], v0, s[12:15], s51 offen offset:1024 sc1
    ds_read2_b64 v[56:59], v3 offset0:172 offset1:173
    ds_read_b128 v[60:63], v4 offset:2064
    s_waitcnt lgkmcnt(4)
    v_mfma_f32_32x32x16_bf16 v[64:79], v[40:43], v[44:47], v[64:79]
    s_nop 0
    ds_read2_b64 v[32:35], v2 offset0:44 offset1:45
    ds_read_b128 v[36:39], v12 offset:528
    s_waitcnt lgkmcnt(4)
    v_mfma_f32_32x32x16_bf16 v[64:79], v[48:51], v[52:55], v[64:79]
    buffer_load_dwordx4 v[200:203], v0, s[12:15], s51 offen offset:2048 sc1
    ds_read2_b64 v[40:43], v3 offset0:176 offset1:177
    ds_read_b128 v[44:47], v4 offset:2112
    s_waitcnt lgkmcnt(4)
    v_mfma_f32_32x32x16_bf16 v[64:79], v[56:59], v[60:63], v[64:79]
    buffer_load_dwordx4 v[204:207], v0, s[12:15], s51 offen offset:3072 sc1
    ds_read2_b64 v[48:51], v3 offset0:180 offset1:181
    ds_read_b128 v[52:55], v4 offset:2160
    s_waitcnt lgkmcnt(4)
    v_mfma_f32_32x32x16_bf16 v[80:95], v[32:35], v[36:39], v[80:95]
    s_add_u32 s51, s50, 266240
    s_and_b32 s51, s51, 0x7ffff
    buffer_load_dwordx4 v[208:211], v0, s[12:15], s51 offen offset:0 sc1
    ds_read2_b64 v[56:59], v3 offset0:184 offset1:185
    ds_read_b128 v[60:63], v4 offset:2208
    s_waitcnt lgkmcnt(4)
    v_mfma_f32_32x32x16_bf16 v[64:79], v[40:43], v[44:47], v[64:79]
    buffer_load_dwordx4 v[212:215], v0, s[12:15], s51 offen offset:1024 sc1
    ds_read2_b64 v[32:35], v3 offset0:188 offset1:189
    ds_read_b128 v[36:39], v4 offset:2256
    s_waitcnt lgkmcnt(4)
    v_mfma_f32_32x32x16_bf16 v[64:79], v[48:51], v[52:55], v[64:79]
    s_nop 0
    ds_read2_b64 v[40:43], v2 offset0:48 offset1:49
    ds_read_b128 v[44:47], v12 offset:576
    s_waitcnt lgkmcnt(4)
    v_mfma_f32_32x32x16_bf16 v[64:79], v[56:59], v[60:63], v[64:79]
    buffer_load_dwordx4 v[216:219], v0, s[12:15], s51 offen offset:2048 sc1
    ds_read2_b64 v[48:51], v3 offset0:192 offset1:193
    ds_read_b128 v[52:55], v4 offset:2304
    s_waitcnt lgkmcnt(4)
    v_mfma_f32_32x32x16_bf16 v[64:79], v[32:35], v[36:39], v[64:79]
    buffer_load_dwordx4 v[220:223], v0, s[12:15], s51 offen offset:3072 sc1
    ds_read2_b64 v[56:59], v3 offset0:196 offset1:197
    ds_read_b128 v[60:63], v4 offset:2352
    s_waitcnt lgkmcnt(4)
    v_mfma_f32_32x32x16_bf16 v[80:95], v[40:43], v[44:47], v[80:95]
    s_add_u32 s51, s50, 270336
    s_and_b32 s51, s51, 0x7ffff
    buffer_load_dwordx4 v[224:227], v0, s[12:15], s51 offen offset:0 sc1
    ds_read2_b64 v[32:35], v3 offset0:200 offset1:201
    ds_read_b128 v[36:39], v4 offset:2400
    s_waitcnt lgkmcnt(4)
    v_mfma_f32_32x32x16_bf16 v[64:79], v[48:51], v[52:55], v[64:79]
    s_nop 0
    ds_read2_b64 v[40:43], v3 offset0:204 offset1:205
    ds_read_b128 v[44:47], v4 offset:2448
    s_waitcnt lgkmcnt(4)
    v_mfma_f32_32x32x16_bf16 v[64:79], v[56:59], v[60:63], v[64:79]
    buffer_load_dwordx4 v[228:231], v0, s[12:15], s51 offen offset:1024 sc1
    ds_read2_b64 v[48:51], v2 offset0:52 offset1:53
    ds_read_b128 v[52:55], v12 offset:624
    s_waitcnt lgkmcnt(4)
    v_mfma_f32_32x32x16_bf16 v[64:79], v[32:35], v[36:39], v[64:79]
    buffer_load_dwordx4 v[232:235], v0, s[12:15], s51 offen offset:2048 sc1
    ds_read2_b64 v[56:59], v3 offset0:208 offset1:209
    ds_read_b128 v[60:63], v4 offset:2496
    s_waitcnt lgkmcnt(4)
    v_mfma_f32_32x32x16_bf16 v[64:79], v[40:43], v[44:47], v[64:79]
    buffer_load_dwordx4 v[236:239], v0, s[12:15], s51 offen offset:3072 sc1
    ds_read2_b64 v[32:35], v3 offset0:212 offset1:213
    ds_read_b128 v[36:39], v4 offset:2544
    s_waitcnt lgkmcnt(4)
    v_mfma_f32_32x32x16_bf16 v[80:95], v[48:51], v[52:55], v[80:95]
    s_add_u32 s51, s50, 274432
    s_and_b32 s51, s51, 0x7ffff
    buffer_load_dwordx4 v[240:243], v0, s[12:15], s51 offen offset:0 sc1
    ds_read2_b64 v[40:43], v3 offset0:216 offset1:217
    ds_read_b128 v[44:47], v4 offset:2592
    s_waitcnt lgkmcnt(4)
    v_mfma_f32_32x32x16_bf16 v[64:79], v[56:59], v[60:63], v[64:79]
    s_nop 0
    ds_read2_b64 v[48:51], v3 offset0:220 offset1:221
    ds_read_b128 v[52:55], v4 offset:2640
    s_waitcnt lgkmcnt(4)
    v_mfma_f32_32x32x16_bf16 v[64:79], v[32:35], v[36:39], v[64:79]
    buffer_load_dwordx4 v[244:247], v0, s[12:15], s51 offen offset:1024 sc1
    ds_read2_b64 v[56:59], v2 offset0:56 offset1:57
    ds_read_b128 v[60:63], v12 offset:672
    s_waitcnt lgkmcnt(4)
    v_mfma_f32_32x32x16_bf16 v[64:79], v[40:43], v[44:47], v[64:79]
    buffer_load_dwordx4 v[248:251], v0, s[12:15], s51 offen offset:2048 sc1
    s_waitcnt lgkmcnt(2)
    v_mfma_f32_32x32x16_bf16 v[64:79], v[48:51], v[52:55], v[64:79]
    buffer_load_dwordx4 v[252:255], v0, s[12:15], s51 offen offset:3072 sc1
    s_waitcnt lgkmcnt(0)
    v_mfma_f32_32x32x16_bf16 v[80:95], v[56:59], v[60:63], v[80:95]
    buffer_load_dwordx4 v[20:23], v0, s[16:19], s54 offen offset:2048 sc1
    s_setprio 2
    s_cmp_eq_u32 s61, 3
    s_cbranch_scc0 SND4
    s_branch POLL3
POLLW3:
    s_nop 15
    s_nop 15
    s_nop 15
    s_nop 15
POLL3:
    ds_read_b32 v18, v0 offset:3072
    s_sub_u32 s56, s56, 1
    s_cmp_lt_i32 s56, 0
    s_cbranch_scc1 POLLX3
    s_waitcnt lgkmcnt(0)
    v_cmp_eq_u32 vcc, s52, v18
    s_cbranch_vccnz POLLW3
POLLX3:
    ds_read_b32 v5, v9 offset:3072
    ds_read_b32 v7, v9 offset:3328
    ds_read_b32 v8, v9 offset:3584
    ds_read_b32 v18, v9 offset:3840
    ds_read_b128 v[32:35], v14 offset:24576
    ds_read_b128 v[36:39], v14 offset:25600
    ds_read_b128 v[40:43], v14 offset:26624
    ds_read_b128 v[44:47], v14 offset:27648
    ds_read_b128 v[48:51], v14 offset:28672
    ds_read_b128 v[52:55], v14 offset:29696
    ds_read_b128 v[56:59], v14 offset:30720
    ds_read_b128 v[60:63], v14 offset:31744
    s_waitcnt lgkmcnt(8)
    v_add_f32 v5, v5, v7
    v_add_f32 v8, v8, v18
    v_add_f32 v5, v5, v8
    v_rcp_f32 v8, v5
    s_waitcnt lgkmcnt(4)
    v_pk_add_f32 v[32:33], v[32:33], v[40:41]
    v_pk_add_f32 v[34:35], v[34:35], v[42:43]
    v_pk_add_f32 v[36:37], v[36:37], v[44:45]
    v_pk_add_f32 v[38:39], v[38:39], v[46:47]
    v_max_f32 v7, v5, v8
    v_cmp_ge_f32 vcc, s55, v7
    v_cndmask_b32 v8, v15, v8, vcc
    s_waitcnt lgkmcnt(0)
    v_pk_add_f32 v[48:49], v[48:49], v[56:57]
    v_pk_add_f32 v[50:51], v[50:51], v[58:59]
    v_pk_add_f32 v[52:53], v[52:53], v[60:61]
    v_pk_add_f32 v[54:55], v[54:55], v[62:63]
    v_pk_add_f32 v[32:33], v[32:33], v[48:49]
    v_pk_add_f32 v[34:35], v[34:35], v[50:51]
    v_pk_add_f32 v[36:37], v[36:37], v[52:53]
    v_pk_add_f32 v[38:39], v[38:39], v[54:55]
    v_pk_mul_f32 v[32:33], v[32:33], v[8:9] op_sel_hi:[1,0]
    v_pk_mul_f32 v[34:35], v[34:35], v[8:9] op_sel_hi:[1,0]
    v_pk_mul_f32 v[36:37], v[36:37], v[8:9] op_sel_hi:[1,0]
    v_pk_mul_f32 v[38:39], v[38:39], v[8:9] op_sel_hi:[1,0]
    v_cvt_pk_bf16_f32 v28, v32, v33
    v_cvt_pk_bf16_f32 v29, v34, v35
    v_cvt_pk_bf16_f32 v30, v36, v37
    v_cvt_pk_bf16_f32 v31, v38, v39
    s_add_u32 s44, s32, 4
    s_and_b32 s44, s44, 7
    s_and_b32 s45, s32, 0xf8
    s_add_u32 s44, s44, s45
    s_lshl_b32 s44, s44, 13
    s_add_u32 s44, s44, 3072
    s_add_u32 s61, s61, 4
    buffer_store_dwordx4 v[28:31], v0, s[16:19], s44 offen sc1
SND4:
    s_waitcnt vmcnt(0)
    v_cmp_eq_u32 vcc, -1, v20
    s_cbranch_vccnz OSLOW2
OOK2:
    s_setprio 0
    v_smfmac_f32_16x16x64_bf16 v[96:99], v[20:23], v[128:135], v13
    v_smfmac_f32_16x16x64_bf16 v[100:103], v[20:23], v[136:143], v13
    v_smfmac_f32_16x16x64_bf16 v[104:107], v[20:23], v[144:151], v13
    v_smfmac_f32_16x16x64_bf16 v[108:111], v[20:23], v[152:159], v13
    v_smfmac_f32_16x16x64_bf16 v[112:115], v[20:23], v[160:167], v13
    v_smfmac_f32_16x16x64_bf16 v[116:119], v[20:23], v[168:175], v13
    v_smfmac_f32_16x16x64_bf16 v[120:123], v[20:23], v[176:183], v13
    v_smfmac_f32_16x16x64_bf16 v[124:127], v[20:23], v[184:191], v13
    s_setprio 2
    ds_read2_b64 v[32:35], v3 offset0:224 offset1:225
    ds_read_b128 v[36:39], v4 offset:2688
    s_setprio 0
    ds_read2_b64 v[40:43], v3 offset0:228 offset1:229
    ds_read_b128 v[44:47], v4 offset:2736
    ds_read2_b64 v[48:51], v3 offset0:232 offset1:233
    ds_read_b128 v[52:55], v4 offset:2784
    s_waitcnt lgkmcnt(4)
    v_mfma_f32_32x32x16_bf16 v[64:79], v[32:35], v[36:39], v[64:79]
    s_add_u32 s51, s50, 196608
    s_and_b32 s51, s51, 0x7ffff
    buffer_load_dwordx4 v[128:131], v0, s[12:15], s51 offen offset:0 sc1
    ds_read2_b64 v[56:59], v3 offset0:236 offset1:237
    ds_read_b128 v[60:63], v4 offset:2832
    s_waitcnt lgkmcnt(4)
    v_mfma_f32_32x32x16_bf16 v[64:79], v[40:43], v[44:47], v[64:79]
    buffer_load_dwordx4 v[132:135], v0, s[12:15], s51 offen offset:1024 sc1
    buffer_load_dwordx4 v[136:139], v0, s[12:15], s51 offen offset:2048 sc1
    ds_read2_b64 v[32:35], v2 offset0:60 offset1:61
    ds_read_b128 v[36:39], v12 offset:720
    s_waitcnt lgkmcnt(4)
    v_mfma_f32_32x32x16_bf16 v[64:79], v[48:51], v[52:55], v[64:79]
    buffer_load_dwordx4 v[140:143], v0, s[12:15], s51 offen offset:3072 sc1
    s_add_u32 s51, s50, 200704
    s_and_b32 s51, s51, 0x7ffff
    buffer_load_dwordx4 v[144:147], v0, s[12:15], s51 offen offset:0 sc1
    ds_read2_b64 v[40:43], v3 offset0:240 offset1:241
    ds_read_b128 v[44:47], v4 offset:2880
    s_waitcnt lgkmcnt(4)
    v_mfma_f32_32x32x16_bf16 v[64:79], v[56:59], v[60:63], v[64:79]
    buffer_load_dwordx4 v[148:151], v0, s[12:15], s51 offen offset:1024 sc1
    buffer_load_dwordx4 v[152:155], v0, s[12:15], s51 offen offset:2048 sc1
    ds_read2_b64 v[48:51], v3 offset0:244 offset1:245
    ds_read_b128 v[52:55], v4 offset:2928
    s_waitcnt lgkmcnt(4)
    v_mfma_f32_32x32x16_bf16 v[80:95], v[32:35], v[36:39], v[80:95]
    buffer_load_dwordx4 v[156:159], v0, s[12:15], s51 offen offset:3072 sc1
    s_add_u32 s51, s50, 204800
    s_and_b32 s51, s51, 0x7ffff
    buffer_load_dwordx4 v[160:163], v0, s[12:15], s51 offen offset:0 sc1
    ds_read2_b64 v[56:59], v3 offset0:248 offset1:249
    ds_read_b128 v[60:63], v4 offset:2976
    s_waitcnt lgkmcnt(4)
    v_mfma_f32_32x32x16_bf16 v[64:79], v[40:43], v[44:47], v[64:79]
    buffer_load_dwordx4 v[164:167], v0, s[12:15], s51 offen offset:1024 sc1
    buffer_load_dwordx4 v[168:171], v0, s[12:15], s51 offen offset:2048 sc1
    ds_read2_b64 v[32:35], v3 offset0:252 offset1:253
    ds_read_b128 v[36:39], v4 offset:3024
    s_waitcnt lgkmcnt(4)
    v_mfma_f32_32x32x16_bf16 v[64:79], v[48:51], v[52:55], v[64:79]
    buffer_load_dwordx4 v[172:175], v0, s[12:15], s51 offen offset:3072 sc1
    s_add_u32 s51, s50, 208896
    s_and_b32 s51, s51, 0x7ffff
    buffer_load_dwordx4 v[176:179], v0, s[12:15], s51 offen offset:0 sc1
    s_waitcnt lgkmcnt(2)
    v_mfma_f32_32x32x16_bf16 v[64:79], v[56:59], v[60:63], v[64:79]
    buffer_load_dwordx4 v[180:183], v0, s[12:15], s51 offen offset:1024 sc1
    buffer_load_dwordx4 v[184:187], v0, s[12:15], s51 offen offset:2048 sc1
    s_waitcnt lgkmcnt(0)
    v_mfma_f32_32x32x16_bf16 v[64:79], v[32:35], v[36:39], v[64:79]
    buffer_load_dwordx4 v[188:191], v0, s[12:15], s51 offen offset:3072 sc1
    buffer_load_dwordx4 v[24:27], v0, s[16:19], s54 offen offset:3072 sc1
    s_setprio 2
    s_cmp_eq_u32 s61, 4
    s_cbranch_scc0 SND5
    ds_read_b32 v18, v0 offset:4096
    s_waitcnt lgkmcnt(0)
    v_cmp_eq_u32 vcc, s52, v18
    s_cbranch_vccnz SND5
    ds_read_b32 v5, v9 offset:4096
    ds_read_b32 v7, v9 offset:4352
    ds_read_b32 v8, v9 offset:4608
    ds_read_b32 v18, v9 offset:4864
    ds_read_b128 v[32:35], v14 offset:32768
    ds_read_b128 v[36:39], v14 offset:33792
    ds_read_b128 v[40:43], v14 offset:34816
    ds_read_b128 v[44:47], v14 offset:35840
    ds_read_b128 v[48:51], v14 offset:36864
    ds_read_b128 v[52:55], v14 offset:37888
    ds_read_b128 v[56:59], v14 offset:38912
    ds_read_b128 v[60:63], v14 offset:39936
    s_waitcnt lgkmcnt(8)
    v_add_f32 v5, v5, v7
    v_add_f32 v8, v8, v18
    v_add_f32 v5, v5, v8
    v_rcp_f32 v8, v5
    s_waitcnt lgkmcnt(4)
    v_pk_add_f32 v[32:33], v[32:33], v[40:41]
    v_pk_add_f32 v[34:35], v[34:35], v[42:43]
    v_pk_add_f32 v[36:37], v[36:37], v[44:45]
    v_pk_add_f32 v[38:39], v[38:39], v[46:47]
    v_max_f32 v7, v5, v8
    v_cmp_ge_f32 vcc, s55, v7
    v_cndmask_b32 v8, v15, v8, vcc
    s_waitcnt lgkmcnt(0)
    v_pk_add_f32 v[48:49], v[48:49], v[56:57]
    v_pk_add_f32 v[50:51], v[50:51], v[58:59]
    v_pk_add_f32 v[52:53], v[52:53], v[60:61]
    v_pk_add_f32 v[54:55], v[54:55], v[62:63]
    v_pk_add_f32 v[32:33], v[32:33], v[48:49]
    v_pk_add_f32 v[34:35], v[34:35], v[50:51]
    v_pk_add_f32 v[36:37], v[36:37], v[52:53]
    v_pk_add_f32 v[38:39], v[38:39], v[54:55]
    v_pk_mul_f32 v[32:33], v[32:33], v[8:9] op_sel_hi:[1,0]
    v_pk_mul_f32 v[34:35], v[34:35], v[8:9] op_sel_hi:[1,0]
    v_pk_mul_f32 v[36:37], v[36:37], v[8:9] op_sel_hi:[1,0]
    v_pk_mul_f32 v[38:39], v[38:39], v[8:9] op_sel_hi:[1,0]
    v_cvt_pk_bf16_f32 v28, v32, v33
    v_cvt_pk_bf16_f32 v29, v34, v35
    v_cvt_pk_bf16_f32 v30, v36, v37
    v_cvt_pk_bf16_f32 v31, v38, v39
    s_add_u32 s44, s32, 5
    s_and_b32 s44, s44, 7
    s_and_b32 s45, s32, 0xf8
    s_add_u32 s44, s44, s45
    s_lshl_b32 s44, s44, 13
    s_add_u32 s44, s44, 4096
    s_add_u32 s61, s61, 4
    buffer_store_dwordx4 v[28:31], v0, s[16:19], s44 offen sc1
SND5:
    s_lshl_b32 s44, s33, 13
    s_nop 7
    s_nop 2
    v_add_u32 v5, s44, v14
    ds_write_b128 v5, v[64:67] offset:0
    ds_write_b128 v5, v[68:71] offset:1024
    ds_write_b128 v5, v[72:75] offset:2048
    ds_write_b128 v5, v[76:79] offset:3072
    ds_write_b128 v5, v[80:83] offset:4096
    ds_write_b128 v5, v[84:87] offset:5120
    ds_write_b128 v5, v[88:91] offset:6144
    ds_write_b128 v5, v[92:95] offset:7168
    v_mov_b32 v7, 3
    ds_write_b32 v1, v7
    v_and_b32 v8, 3, v6
    v_lshlrev_b32 v8, 8, v8
    v_add_u32 v8, 147456, v8
    s_lshl_b32 s44, s33, 10
    s_xor_b32 s45, s44, 2048
    v_add_u32 v19, s44, v14
    v_add_u32 v5, s45, v14
    s_lshl_b32 s44, s37, 10
    s_lshl_b32 s45, s36, 8
    s_sub_u32 s44, s44, s45
    s_add_u32 s44, s44, 84224
    v_and_b32 v2, 1, v6
    v_and_b32 v3, 30, v6
    v_and_b32 v4, 32, v6
    v_lshl_add_u32 v7, v2, 11, s44
    v_lshl_add_u32 v7, v3, 3, v7
    v_lshl_add_u32 v7, v4, 4, v7
XPOLL:
    ds_read_b32 v18, v8
    s_sub_u32 s56, s56, 1
    s_cmp_lt_i32 s56, 0
    s_cbranch_scc1 XPOLLX
    s_waitcnt lgkmcnt(0)
    v_cmp_gt_u32 vcc, 3, v18
    s_cbranch_vccnz XPOLL
XPOLLX:
    ds_read_b128 v[32:35], v19 offset:4096
    ds_read_b128 v[40:43], v19 offset:12288
    ds_read_b128 v[36:39], v5 offset:0
    ds_read_b128 v[44:47], v7 offset:0
    ds_read_b128 v[48:51], v19 offset:20480
    ds_read_b128 v[56:59], v19 offset:28672
    ds_read_b128 v[52:55], v5 offset:16384
    ds_read_b128 v[60:63], v7 offset:16384
    s_cmp_eq_u32 s36, 1
    s_waitcnt lgkmcnt(6)
    v_pk_add_f32 v[32:33], v[32:33], v[40:41]
    v_pk_add_f32 v[34:35], v[34:35], v[42:43]
    s_waitcnt lgkmcnt(2)
    v_pk_add_f32 v[48:49], v[48:49], v[56:57]
    v_pk_add_f32 v[50:51], v[50:51], v[58:59]
    s_waitcnt lgkmcnt(0)
    s_cbranch_scc1 XTA
    v_pk_add_f32 v[36:37], v[36:37], v[44:45]
    v_pk_add_f32 v[38:39], v[38:39], v[46:47]
    v_pk_add_f32 v[52:53], v[52:53], v[60:61]
    v_pk_add_f32 v[54:55], v[54:55], v[62:63]
    s_branch XTB
XTA:
    v_pk_add_f32 v[32:33], v[32:33], v[44:45]
    v_pk_add_f32 v[34:35], v[34:35], v[46:47]
    v_pk_add_f32 v[48:49], v[48:49], v[60:61]
    v_pk_add_f32 v[50:51], v[50:51], v[62:63]
XTB:
    v_cvt_pk_bf16_f32 v64, v32, v48
    v_cvt_pk_bf16_f32 v65, v33, v49
    v_cvt_pk_bf16_f32 v66, v34, v50
    v_cvt_pk_bf16_f32 v67, v35, v51
    buffer_store_dwordx4 v[64:67], v10, s[16:19], 0 offen sc1
    v_cvt_pk_bf16_f32 v68, v36, v52
    v_cvt_pk_bf16_f32 v69, v37, v53
    v_cvt_pk_bf16_f32 v70, v38, v54
    v_cvt_pk_bf16_f32 v71, v39, v55
    buffer_store_dwordx4 v[68:71], v10, s[16:19], s48 offen sc1
    s_cmp_eq_u32 s61, 4
    s_cbranch_scc0 SND6
    s_branch POLL4
POLLW4:
    s_nop 15
    s_nop 15
    s_nop 15
    s_nop 15
POLL4:
    ds_read_b32 v18, v0 offset:4096
    s_sub_u32 s56, s56, 1
    s_cmp_lt_i32 s56, 0
    s_cbranch_scc1 POLLX4
    s_waitcnt lgkmcnt(0)
    v_cmp_eq_u32 vcc, s52, v18
    s_cbranch_vccnz POLLW4
POLLX4:
    ds_read_b32 v5, v9 offset:4096
    ds_read_b32 v7, v9 offset:4352
    ds_read_b32 v8, v9 offset:4608
    ds_read_b32 v18, v9 offset:4864
    ds_read_b128 v[32:35], v14 offset:32768
    ds_read_b128 v[36:39], v14 offset:33792
    ds_read_b128 v[40:43], v14 offset:34816
    ds_read_b128 v[44:47], v14 offset:35840
    ds_read_b128 v[48:51], v14 offset:36864
    ds_read_b128 v[52:55], v14 offset:37888
    ds_read_b128 v[56:59], v14 offset:38912
    ds_read_b128 v[60:63], v14 offset:39936
    s_waitcnt lgkmcnt(8)
    v_add_f32 v5, v5, v7
    v_add_f32 v8, v8, v18
    v_add_f32 v5, v5, v8
    v_rcp_f32 v8, v5
    s_waitcnt lgkmcnt(4)
    v_pk_add_f32 v[32:33], v[32:33], v[40:41]
    v_pk_add_f32 v[34:35], v[34:35], v[42:43]
    v_pk_add_f32 v[36:37], v[36:37], v[44:45]
    v_pk_add_f32 v[38:39], v[38:39], v[46:47]
    v_max_f32 v7, v5, v8
    v_cmp_ge_f32 vcc, s55, v7
    v_cndmask_b32 v8, v15, v8, vcc
    s_waitcnt lgkmcnt(0)
    v_pk_add_f32 v[48:49], v[48:49], v[56:57]
    v_pk_add_f32 v[50:51], v[50:51], v[58:59]
    v_pk_add_f32 v[52:53], v[52:53], v[60:61]
    v_pk_add_f32 v[54:55], v[54:55], v[62:63]
    v_pk_add_f32 v[32:33], v[32:33], v[48:49]
    v_pk_add_f32 v[34:35], v[34:35], v[50:51]
    v_pk_add_f32 v[36:37], v[36:37], v[52:53]
    v_pk_add_f32 v[38:39], v[38:39], v[54:55]
    v_pk_mul_f32 v[32:33], v[32:33], v[8:9] op_sel_hi:[1,0]
    v_pk_mul_f32 v[34:35], v[34:35], v[8:9] op_sel_hi:[1,0]
    v_pk_mul_f32 v[36:37], v[36:37], v[8:9] op_sel_hi:[1,0]
    v_pk_mul_f32 v[38:39], v[38:39], v[8:9] op_sel_hi:[1,0]
    v_cvt_pk_bf16_f32 v28, v32, v33
    v_cvt_pk_bf16_f32 v29, v34, v35
    v_cvt_pk_bf16_f32 v30, v36, v37
    v_cvt_pk_bf16_f32 v31, v38, v39
    s_add_u32 s44, s32, 5
    s_and_b32 s44, s44, 7
    s_and_b32 s45, s32, 0xf8
    s_add_u32 s44, s44, s45
    s_lshl_b32 s44, s44, 13
    s_add_u32 s44, s44, 4096
    s_add_u32 s61, s61, 4
    buffer_store_dwordx4 v[28:31], v0, s[16:19], s44 offen sc1
SND6:
    buffer_load_dwordx4 v[20:23], v0, s[16:19], s63 offen offset:0 sc1
    s_waitcnt vmcnt(3)
    v_cmp_eq_u32 vcc, -1, v24
    s_cbranch_vccnz OSLOW3
OOK3:
    s_setprio 0
    v_smfmac_f32_16x16x64_bf16 v[96:99], v[24:27], v[192:199], v13
    s_add_u32 s51, s50, 131072
    s_and_b32 s51, s51, 0x7ffff
    buffer_load_dwordx4 v[192:195], v0, s[12:15], s51 offen offset:0 sc1
    buffer_load_dwordx4 v[196:199], v0, s[12:15], s51 offen offset:1024 sc1
    v_smfmac_f32_16x16x64_bf16 v[100:103], v[24:27], v[200:207], v13
    buffer_load_dwordx4 v[200:203], v0, s[12:15], s51 offen offset:2048 sc1
    buffer_load_dwordx4 v[204:207], v0, s[12:15], s51 offen offset:3072 sc1
    v_smfmac_f32_16x16x64_bf16 v[104:107], v[24:27], v[208:215], v13
    s_add_u32 s51, s50, 135168
    s_and_b32 s51, s51, 0x7ffff
    buffer_load_dwordx4 v[208:211], v0, s[12:15], s51 offen offset:0 sc1
    buffer_load_dwordx4 v[212:215], v0, s[12:15], s51 offen offset:1024 sc1
    v_smfmac_f32_16x16x64_bf16 v[108:111], v[24:27], v[216:223], v13
    buffer_load_dwordx4 v[216:219], v0, s[12:15], s51 offen offset:2048 sc1
    buffer_load_dwordx4 v[220:223], v0, s[12:15], s51 offen offset:3072 sc1
    v_smfmac_f32_16x16x64_bf16 v[112:115], v[24:27], v[224:231], v13
    s_add_u32 s51, s50, 139264
    s_and_b32 s51, s51, 0x7ffff
    buffer_load_dwordx4 v[224:227], v0, s[12:15], s51 offen offset:0 sc1
    buffer_load_dwordx4 v[228:231], v0, s[12:15], s51 offen offset:1024 sc1
    v_smfmac_f32_16x16x64_bf16 v[116:119], v[24:27], v[232:239], v13
    buffer_load_dwordx4 v[232:235], v0, s[12:15], s51 offen offset:2048 sc1
    buffer_load_dwordx4 v[236:239], v0, s[12:15], s51 offen offset:3072 sc1
    v_smfmac_f32_16x16x64_bf16 v[120:123], v[24:27], v[240:247], v13
    s_add_u32 s51, s50, 143360
    s_and_b32 s51, s51, 0x7ffff
    buffer_load_dwordx4 v[240:243], v0, s[12:15], s51 offen offset:0 sc1
    buffer_load_dwordx4 v[244:247], v0, s[12:15], s51 offen offset:1024 sc1
    v_smfmac_f32_16x16x64_bf16 v[124:127], v[24:27], v[248:255], v13
    buffer_load_dwordx4 v[248:251], v0, s[12:15], s51 offen offset:2048 sc1
    buffer_load_dwordx4 v[252:255], v0, s[12:15], s51 offen offset:3072 sc1
    s_setprio 2
    s_cmp_eq_u32 s61, 5
    s_cbranch_scc0 SND7
    ds_read_b32 v18, v0 offset:5120
    s_waitcnt lgkmcnt(0)
    v_cmp_eq_u32 vcc, s52, v18
    s_cbranch_vccnz SND7
    ds_read_b32 v5, v9 offset:5120
    ds_read_b32 v7, v9 offset:5376
    ds_read_b32 v8, v9 offset:5632
    ds_read_b32 v18, v9 offset:5888
    ds_read_b128 v[32:35], v14 offset:40960
    ds_read_b128 v[36:39], v14 offset:41984
    ds_read_b128 v[40:43], v14 offset:43008
    ds_read_b128 v[44:47], v14 offset:44032
    ds_read_b128 v[48:51], v14 offset:45056
    ds_read_b128 v[52:55], v14 offset:46080
    ds_read_b128 v[56:59], v14 offset:47104
    ds_read_b128 v[60:63], v14 offset:48128
    s_waitcnt lgkmcnt(8)
    v_add_f32 v5, v5, v7
    v_add_f32 v8, v8, v18
    v_add_f32 v5, v5, v8
    v_rcp_f32 v8, v5
    s_waitcnt lgkmcnt(4)
    v_pk_add_f32 v[32:33], v[32:33], v[40:41]
    v_pk_add_f32 v[34:35], v[34:35], v[42:43]
    v_pk_add_f32 v[36:37], v[36:37], v[44:45]
    v_pk_add_f32 v[38:39], v[38:39], v[46:47]
    v_max_f32 v7, v5, v8
    v_cmp_ge_f32 vcc, s55, v7
    v_cndmask_b32 v8, v15, v8, vcc
    s_waitcnt lgkmcnt(0)
    v_pk_add_f32 v[48:49], v[48:49], v[56:57]
    v_pk_add_f32 v[50:51], v[50:51], v[58:59]
    v_pk_add_f32 v[52:53], v[52:53], v[60:61]
    v_pk_add_f32 v[54:55], v[54:55], v[62:63]
    v_pk_add_f32 v[32:33], v[32:33], v[48:49]
    v_pk_add_f32 v[34:35], v[34:35], v[50:51]
    v_pk_add_f32 v[36:37], v[36:37], v[52:53]
    v_pk_add_f32 v[38:39], v[38:39], v[54:55]
    v_pk_mul_f32 v[32:33], v[32:33], v[8:9] op_sel_hi:[1,0]
    v_pk_mul_f32 v[34:35], v[34:35], v[8:9] op_sel_hi:[1,0]
    v_pk_mul_f32 v[36:37], v[36:37], v[8:9] op_sel_hi:[1,0]
    v_pk_mul_f32 v[38:39], v[38:39], v[8:9] op_sel_hi:[1,0]
    v_cvt_pk_bf16_f32 v28, v32, v33
    v_cvt_pk_bf16_f32 v29, v34, v35
    v_cvt_pk_bf16_f32 v30, v36, v37
    v_cvt_pk_bf16_f32 v31, v38, v39
    s_add_u32 s44, s32, 6
    s_and_b32 s44, s44, 7
    s_and_b32 s45, s32, 0xf8
    s_add_u32 s44, s44, s45
    s_lshl_b32 s44, s44, 13
    s_add_u32 s44, s44, 5120
    s_add_u32 s61, s61, 4
    buffer_store_dwordx4 v[28:31], v0, s[16:19], s44 offen sc1
SND7:
    s_waitcnt vmcnt(16)
    v_cmp_eq_u32 vcc, -1, v20
    s_cbranch_vccnz OSLOW4
OOK4:
    s_setprio 0
    v_smfmac_f32_16x16x64_bf16 v[96:99], v[20:23], v[128:135], v13
    s_add_u32 s51, s50, 65536
    s_and_b32 s51, s51, 0x7ffff
    buffer_load_dwordx4 v[128:131], v0, s[12:15], s51 offen offset:0 sc1
    buffer_load_dwordx4 v[132:135], v0, s[12:15], s51 offen offset:1024 sc1
    v_smfmac_f32_16x16x64_bf16 v[100:103], v[20:23], v[136:143], v13
    buffer_load_dwordx4 v[136:139], v0, s[12:15], s51 offen offset:2048 sc1
    buffer_load_dwordx4 v[140:143], v0, s[12:15], s51 offen offset:3072 sc1
    v_smfmac_f32_16x16x64_bf16 v[104:107], v[20:23], v[144:151], v13
    s_add_u32 s51, s50, 69632
    s_and_b32 s51, s51, 0x7ffff
    buffer_load_dwordx4 v[144:147], v0, s[12:15], s51 offen offset:0 sc1
    buffer_load_dwordx4 v[148:151], v0, s[12:15], s51 offen offset:1024 sc1
    v_smfmac_f32_16x16x64_bf16 v[108:111], v[20:23], v[152:159], v13
    buffer_load_dwordx4 v[152:155], v0, s[12:15], s51 offen offset:2048 sc1
    buffer_load_dwordx4 v[156:159], v0, s[12:15], s51 offen offset:3072 sc1
    v_smfmac_f32_16x16x64_bf16 v[112:115], v[20:23], v[160:167], v13
    s_add_u32 s51, s50, 73728
    s_and_b32 s51, s51, 0x7ffff
    buffer_load_dwordx4 v[160:163], v0, s[12:15], s51 offen offset:0 sc1
    buffer_load_dwordx4 v[164:167], v0, s[12:15], s51 offen offset:1024 sc1
    v_smfmac_f32_16x16x64_bf16 v[116:119], v[20:23], v[168:175], v13
    buffer_load_dwordx4 v[168:171], v0, s[12:15], s51 offen offset:2048 sc1
    buffer_load_dwordx4 v[172:175], v0, s[12:15], s51 offen offset:3072 sc1
    v_smfmac_f32_16x16x64_bf16 v[120:123], v[20:23], v[176:183], v13
    s_add_u32 s51, s50, 77824
    s_and_b32 s51, s51, 0x7ffff
    buffer_load_dwordx4 v[176:179], v0, s[12:15], s51 offen offset:0 sc1
    buffer_load_dwordx4 v[180:183], v0, s[12:15], s51 offen offset:1024 sc1
    v_smfmac_f32_16x16x64_bf16 v[124:127], v[20:23], v[184:191], v13
    buffer_load_dwordx4 v[184:187], v0, s[12:15], s51 offen offset:2048 sc1
    buffer_load_dwordx4 v[188:191], v0, s[12:15], s51 offen offset:3072 sc1
    s_setprio 2
    s_cmp_eq_u32 s61, 5
    s_cbranch_scc0 SND8
    s_branch POLL5
POLLW5:
    s_nop 15
    s_nop 15
    s_nop 15
    s_nop 15
POLL5:
    ds_read_b32 v18, v0 offset:5120
    s_sub_u32 s56, s56, 1
    s_cmp_lt_i32 s56, 0
    s_cbranch_scc1 POLLX5
    s_waitcnt lgkmcnt(0)
    v_cmp_eq_u32 vcc, s52, v18
    s_cbranch_vccnz POLLW5
POLLX5:
    ds_read_b32 v5, v9 offset:5120
    ds_read_b32 v7, v9 offset:5376
    ds_read_b32 v8, v9 offset:5632
    ds_read_b32 v18, v9 offset:5888
    ds_read_b128 v[32:35], v14 offset:40960
    ds_read_b128 v[36:39], v14 offset:41984
    ds_read_b128 v[40:43], v14 offset:43008
    ds_read_b128 v[44:47], v14 offset:44032
    ds_read_b128 v[48:51], v14 offset:45056
    ds_read_b128 v[52:55], v14 offset:46080
    ds_read_b128 v[56:59], v14 offset:47104
    ds_read_b128 v[60:63], v14 offset:48128
    s_waitcnt lgkmcnt(8)
    v_add_f32 v5, v5, v7
    v_add_f32 v8, v8, v18
    v_add_f32 v5, v5, v8
    v_rcp_f32 v8, v5
    s_waitcnt lgkmcnt(4)
    v_pk_add_f32 v[32:33], v[32:33], v[40:41]
    v_pk_add_f32 v[34:35], v[34:35], v[42:43]
    v_pk_add_f32 v[36:37], v[36:37], v[44:45]
    v_pk_add_f32 v[38:39], v[38:39], v[46:47]
    v_max_f32 v7, v5, v8
    v_cmp_ge_f32 vcc, s55, v7
    v_cndmask_b32 v8, v15, v8, vcc
    s_waitcnt lgkmcnt(0)
    v_pk_add_f32 v[48:49], v[48:49], v[56:57]
    v_pk_add_f32 v[50:51], v[50:51], v[58:59]
    v_pk_add_f32 v[52:53], v[52:53], v[60:61]
    v_pk_add_f32 v[54:55], v[54:55], v[62:63]
    v_pk_add_f32 v[32:33], v[32:33], v[48:49]
    v_pk_add_f32 v[34:35], v[34:35], v[50:51]
    v_pk_add_f32 v[36:37], v[36:37], v[52:53]
    v_pk_add_f32 v[38:39], v[38:39], v[54:55]
    v_pk_mul_f32 v[32:33], v[32:33], v[8:9] op_sel_hi:[1,0]
    v_pk_mul_f32 v[34:35], v[34:35], v[8:9] op_sel_hi:[1,0]
    v_pk_mul_f32 v[36:37], v[36:37], v[8:9] op_sel_hi:[1,0]
    v_pk_mul_f32 v[38:39], v[38:39], v[8:9] op_sel_hi:[1,0]
    v_cvt_pk_bf16_f32 v28, v32, v33
    v_cvt_pk_bf16_f32 v29, v34, v35
    v_cvt_pk_bf16_f32 v30, v36, v37
    v_cvt_pk_bf16_f32 v31, v38, v39
    s_add_u32 s44, s32, 6
    s_and_b32 s44, s44, 7
    s_and_b32 s45, s32, 0xf8
    s_add_u32 s44, s44, s45
    s_lshl_b32 s44, s44, 13
    s_add_u32 s44, s44, 5120
    s_add_u32 s61, s61, 4
    buffer_store_dwordx4 v[28:31], v0, s[16:19], s44 offen sc1
SND8:
    buffer_load_dwordx4 v[80:83], v11, s[16:19], 0 offen offset:0 sc1
    buffer_load_dwordx4 v[84:87], v11, s[16:19], 0 offen offset:16 sc1
    s_cmp_eq_u32 s61, 6
    s_cbranch_scc0 SND9
    ds_read_b32 v18, v0 offset:6144
    s_waitcnt lgkmcnt(0)
    v_cmp_eq_u32 vcc, s52, v18
    s_cbranch_vccnz SND9
    ds_read_b32 v5, v9 offset:6144
    ds_read_b32 v7, v9 offset:6400
    ds_read_b32 v8, v9 offset:6656
    ds_read_b32 v18, v9 offset:6912
    ds_read_b128 v[32:35], v14 offset:49152
    ds_read_b128 v[36:39], v14 offset:50176
    ds_read_b128 v[40:43], v14 offset:51200
    ds_read_b128 v[44:47], v14 offset:52224
    ds_read_b128 v[48:51], v14 offset:53248
    ds_read_b128 v[52:55], v14 offset:54272
    ds_read_b128 v[56:59], v14 offset:55296
    ds_read_b128 v[60:63], v14 offset:56320
    s_waitcnt lgkmcnt(8)
    v_add_f32 v5, v5, v7
    v_add_f32 v8, v8, v18
    v_add_f32 v5, v5, v8
    v_rcp_f32 v8, v5
    s_waitcnt lgkmcnt(4)
    v_pk_add_f32 v[32:33], v[32:33], v[40:41]
    v_pk_add_f32 v[34:35], v[34:35], v[42:43]
    v_pk_add_f32 v[36:37], v[36:37], v[44:45]
    v_pk_add_f32 v[38:39], v[38:39], v[46:47]
    v_max_f32 v7, v5, v8
    v_cmp_ge_f32 vcc, s55, v7
    v_cndmask_b32 v8, v15, v8, vcc
    s_waitcnt lgkmcnt(0)
    v_pk_add_f32 v[48:49], v[48:49], v[56:57]
    v_pk_add_f32 v[50:51], v[50:51], v[58:59]
    v_pk_add_f32 v[52:53], v[52:53], v[60:61]
    v_pk_add_f32 v[54:55], v[54:55], v[62:63]
    v_pk_add_f32 v[32:33], v[32:33], v[48:49]
    v_pk_add_f32 v[34:35], v[34:35], v[50:51]
    v_pk_add_f32 v[36:37], v[36:37], v[52:53]
    v_pk_add_f32 v[38:39], v[38:39], v[54:55]
    v_pk_mul_f32 v[32:33], v[32:33], v[8:9] op_sel_hi:[1,0]
    v_pk_mul_f32 v[34:35], v[34:35], v[8:9] op_sel_hi:[1,0]
    v_pk_mul_f32 v[36:37], v[36:37], v[8:9] op_sel_hi:[1,0]
    v_pk_mul_f32 v[38:39], v[38:39], v[8:9] op_sel_hi:[1,0]
    v_cvt_pk_bf16_f32 v28, v32, v33
    v_cvt_pk_bf16_f32 v29, v34, v35
    v_cvt_pk_bf16_f32 v30, v36, v37
    v_cvt_pk_bf16_f32 v31, v38, v39
    s_add_u32 s44, s32, 7
    s_and_b32 s44, s44, 7
    s_and_b32 s45, s32, 0xf8
    s_add_u32 s44, s44, s45
    s_lshl_b32 s44, s44, 13
    s_add_u32 s44, s44, 6144
    s_add_u32 s61, s61, 4
    buffer_store_dwordx4 v[28:31], v0, s[16:19], s44 offen sc1
SND9:
    s_waitcnt vmcnt(0)
    v_max_u32 v5, v80, v84
    v_cmp_eq_u32 vcc, -1, v5
    s_cbranch_vccnz YSLOW
YOK:
    buffer_load_dwordx4 v[24:27], v0, s[16:19], s63 offen offset:1024 sc1
    s_cmp_eq_u32 s61, 6
    s_cbranch_scc0 SND10
    ds_read_b32 v18, v0 offset:6144
    s_waitcnt lgkmcnt(0)
    v_cmp_eq_u32 vcc, s52, v18
    s_cbranch_vccnz SND10
    ds_read_b32 v5, v9 offset:6144
    ds_read_b32 v7, v9 offset:6400
    ds_read_b32 v8, v9 offset:6656
    ds_read_b32 v18, v9 offset:6912
    ds_read_b128 v[32:35], v14 offset:49152
    ds_read_b128 v[36:39], v14 offset:50176
    ds_read_b128 v[40:43], v14 offset:51200
    ds_read_b128 v[44:47], v14 offset:52224
    ds_read_b128 v[48:51], v14 offset:53248
    ds_read_b128 v[52:55], v14 offset:54272
    ds_read_b128 v[56:59], v14 offset:55296
    ds_read_b128 v[60:63], v14 offset:56320
    s_waitcnt lgkmcnt(8)
    v_add_f32 v5, v5, v7
    v_add_f32 v8, v8, v18
    v_add_f32 v5, v5, v8
    v_rcp_f32 v8, v5
    s_waitcnt lgkmcnt(4)
    v_pk_add_f32 v[32:33], v[32:33], v[40:41]
    v_pk_add_f32 v[34:35], v[34:35], v[42:43]
    v_pk_add_f32 v[36:37], v[36:37], v[44:45]
    v_pk_add_f32 v[38:39], v[38:39], v[46:47]
    v_max_f32 v7, v5, v8
    v_cmp_ge_f32 vcc, s55, v7
    v_cndmask_b32 v8, v15, v8, vcc
    s_waitcnt lgkmcnt(0)
    v_pk_add_f32 v[48:49], v[48:49], v[56:57]
    v_pk_add_f32 v[50:51], v[50:51], v[58:59]
    v_pk_add_f32 v[52:53], v[52:53], v[60:61]
    v_pk_add_f32 v[54:55], v[54:55], v[62:63]
    v_pk_add_f32 v[32:33], v[32:33], v[48:49]
    v_pk_add_f32 v[34:35], v[34:35], v[50:51]
    v_pk_add_f32 v[36:37], v[36:37], v[52:53]
    v_pk_add_f32 v[38:39], v[38:39], v[54:55]
    v_pk_mul_f32 v[32:33], v[32:33], v[8:9] op_sel_hi:[1,0]
    v_pk_mul_f32 v[34:35], v[34:35], v[8:9] op_sel_hi:[1,0]
    v_pk_mul_f32 v[36:37], v[36:37], v[8:9] op_sel_hi:[1,0]
    v_pk_mul_f32 v[38:39], v[38:39], v[8:9] op_sel_hi:[1,0]
    v_cvt_pk_bf16_f32 v28, v32, v33
    v_cvt_pk_bf16_f32 v29, v34, v35
    v_cvt_pk_bf16_f32 v30, v36, v37
    v_cvt_pk_bf16_f32 v31, v38, v39
    s_add_u32 s44, s32, 7
    s_and_b32 s44, s44, 7
    s_and_b32 s45, s32, 0xf8
    s_add_u32 s44, s44, s45
    s_lshl_b32 s44, s44, 13
    s_add_u32 s44, s44, 6144
    s_add_u32 s61, s61, 4
    buffer_store_dwordx4 v[28:31], v0, s[16:19], s44 offen sc1
SND10:
    ds_read_b32 v72, v16 offset:0
    ds_read_b32 v73, v16 offset:128
    ds_read_b32 v74, v16 offset:256
    ds_read_b32 v75, v16 offset:384
    ds_read_b32 v76, v16 offset:512
    ds_read_b32 v77, v16 offset:640
    ds_read_b32 v78, v16 offset:768
    ds_read_b32 v79, v16 offset:896
    s_waitcnt lgkmcnt(0)
    v_lshlrev_b32 v32, 16, v80
    v_and_b32 v33, s62, v80
    v_lshlrev_b32 v34, 16, v72
    v_and_b32 v35, s62, v72
    v_pk_mul_f32 v[32:33], v[32:33], v[34:35]
    v_cvt_pk_bf16_f32 v88, v32, v33
    buffer_store_dword v88, v17, s[28:31], 0 offen offset:1024 nt sc0 sc1
    v_lshlrev_b32 v36, 16, v81
    v_and_b32 v37, s62, v81
    v_lshlrev_b32 v38, 16, v73
    v_and_b32 v39, s62, v73
    v_pk_mul_f32 v[36:37], v[36:37], v[38:39]
    v_cvt_pk_bf16_f32 v89, v36, v37
    buffer_store_dword v89, v17, s[28:31], 0 offen offset:3072 nt sc0 sc1
    v_lshlrev_b32 v40, 16, v82
    v_and_b32 v41, s62, v82
    v_lshlrev_b32 v42, 16, v74
    v_and_b32 v43, s62, v74
    v_pk_mul_f32 v[40:41], v[40:41], v[42:43]
    v_cvt_pk_bf16_f32 v90, v40, v41
    buffer_store_dword v90, v17, s[28:31], s47 offen offset:1024 nt sc0 sc1
    v_lshlrev_b32 v44, 16, v83
    v_and_b32 v45, s62, v83
    v_lshlrev_b32 v46, 16, v75
    v_and_b32 v47, s62, v75
    v_pk_mul_f32 v[44:45], v[44:45], v[46:47]
    v_cvt_pk_bf16_f32 v91, v44, v45
    buffer_store_dword v91, v17, s[28:31], s47 offen offset:3072 nt sc0 sc1
    v_lshlrev_b32 v32, 16, v84
    v_and_b32 v33, s62, v84
    v_lshlrev_b32 v34, 16, v76
    v_and_b32 v35, s62, v76
    v_pk_mul_f32 v[32:33], v[32:33], v[34:35]
    v_cvt_pk_bf16_f32 v92, v32, v33
    buffer_store_dword v92, v17, s[28:31], s48 offen offset:1024 nt sc0 sc1
    v_lshlrev_b32 v36, 16, v85
    v_and_b32 v37, s62, v85
    v_lshlrev_b32 v38, 16, v77
    v_and_b32 v39, s62, v77
    v_pk_mul_f32 v[36:37], v[36:37], v[38:39]
    v_cvt_pk_bf16_f32 v93, v36, v37
    buffer_store_dword v93, v17, s[28:31], s48 offen offset:3072 nt sc0 sc1
    v_lshlrev_b32 v40, 16, v86
    v_and_b32 v41, s62, v86
    v_lshlrev_b32 v42, 16, v78
    v_and_b32 v43, s62, v78
    v_pk_mul_f32 v[40:41], v[40:41], v[42:43]
    v_cvt_pk_bf16_f32 v94, v40, v41
    buffer_store_dword v94, v17, s[28:31], s49 offen offset:1024 nt sc0 sc1
    v_lshlrev_b32 v44, 16, v87
    v_and_b32 v45, s62, v87
    v_lshlrev_b32 v46, 16, v79
    v_and_b32 v47, s62, v79
    v_pk_mul_f32 v[44:45], v[44:45], v[46:47]
    v_cvt_pk_bf16_f32 v95, v44, v45
    buffer_store_dword v95, v17, s[28:31], s49 offen offset:3072 nt sc0 sc1
    s_cmp_eq_u32 s61, 6
    s_cbranch_scc0 SND11
    ds_read_b32 v18, v0 offset:6144
    s_waitcnt lgkmcnt(0)
    v_cmp_eq_u32 vcc, s52, v18
    s_cbranch_vccnz SND11
    ds_read_b32 v5, v9 offset:6144
    ds_read_b32 v7, v9 offset:6400
    ds_read_b32 v8, v9 offset:6656
    ds_read_b32 v18, v9 offset:6912
    ds_read_b128 v[32:35], v14 offset:49152
    ds_read_b128 v[36:39], v14 offset:50176
    ds_read_b128 v[40:43], v14 offset:51200
    ds_read_b128 v[44:47], v14 offset:52224
    ds_read_b128 v[48:51], v14 offset:53248
    ds_read_b128 v[52:55], v14 offset:54272
    ds_read_b128 v[56:59], v14 offset:55296
    ds_read_b128 v[60:63], v14 offset:56320
    s_waitcnt lgkmcnt(8)
    v_add_f32 v5, v5, v7
    v_add_f32 v8, v8, v18
    v_add_f32 v5, v5, v8
    v_rcp_f32 v8, v5
    s_waitcnt lgkmcnt(4)
    v_pk_add_f32 v[32:33], v[32:33], v[40:41]
    v_pk_add_f32 v[34:35], v[34:35], v[42:43]
    v_pk_add_f32 v[36:37], v[36:37], v[44:45]
    v_pk_add_f32 v[38:39], v[38:39], v[46:47]
    v_max_f32 v7, v5, v8
    v_cmp_ge_f32 vcc, s55, v7
    v_cndmask_b32 v8, v15, v8, vcc
    s_waitcnt lgkmcnt(0)
    v_pk_add_f32 v[48:49], v[48:49], v[56:57]
    v_pk_add_f32 v[50:51], v[50:51], v[58:59]
    v_pk_add_f32 v[52:53], v[52:53], v[60:61]
    v_pk_add_f32 v[54:55], v[54:55], v[62:63]
    v_pk_add_f32 v[32:33], v[32:33], v[48:49]
    v_pk_add_f32 v[34:35], v[34:35], v[50:51]
    v_pk_add_f32 v[36:37], v[36:37], v[52:53]
    v_pk_add_f32 v[38:39], v[38:39], v[54:55]
    v_pk_mul_f32 v[32:33], v[32:33], v[8:9] op_sel_hi:[1,0]
    v_pk_mul_f32 v[34:35], v[34:35], v[8:9] op_sel_hi:[1,0]
    v_pk_mul_f32 v[36:37], v[36:37], v[8:9] op_sel_hi:[1,0]
    v_pk_mul_f32 v[38:39], v[38:39], v[8:9] op_sel_hi:[1,0]
    v_cvt_pk_bf16_f32 v28, v32, v33
    v_cvt_pk_bf16_f32 v29, v34, v35
    v_cvt_pk_bf16_f32 v30, v36, v37
    v_cvt_pk_bf16_f32 v31, v38, v39
    s_add_u32 s44, s32, 7
    s_and_b32 s44, s44, 7
    s_and_b32 s45, s32, 0xf8
    s_add_u32 s44, s44, s45
    s_lshl_b32 s44, s44, 13
    s_add_u32 s44, s44, 6144
    s_add_u32 s61, s61, 4
    buffer_store_dwordx4 v[28:31], v0, s[16:19], s44 offen sc1
SND11:
    s_waitcnt vmcnt(8)
    v_cmp_eq_u32 vcc, -1, v24
    s_cbranch_vccnz OSLOW5
OOK5:
    s_setprio 0
    v_smfmac_f32_16x16x64_bf16 v[96:99], v[24:27], v[192:199], v13
    s_add_u32 s51, s50, 0
    s_and_b32 s51, s51, 0x7ffff
    buffer_load_dwordx4 v[192:195], v0, s[12:15], s51 offen offset:0 sc1
    buffer_load_dwordx4 v[196:199], v0, s[12:15], s51 offen offset:1024 sc1
    v_smfmac_f32_16x16x64_bf16 v[100:103], v[24:27], v[200:207], v13
    buffer_load_dwordx4 v[200:203], v0, s[12:15], s51 offen offset:2048 sc1
    buffer_load_dwordx4 v[204:207], v0, s[12:15], s51 offen offset:3072 sc1
    v_smfmac_f32_16x16x64_bf16 v[104:107], v[24:27], v[208:215], v13
    s_add_u32 s51, s50, 4096
    s_and_b32 s51, s51, 0x7ffff
    buffer_load_dwordx4 v[208:211], v0, s[12:15], s51 offen offset:0 sc1
    buffer_load_dwordx4 v[212:215], v0, s[12:15], s51 offen offset:1024 sc1
    v_smfmac_f32_16x16x64_bf16 v[108:111], v[24:27], v[216:223], v13
    buffer_load_dwordx4 v[216:219], v0, s[12:15], s51 offen offset:2048 sc1
    buffer_load_dwordx4 v[220:223], v0, s[12:15], s51 offen offset:3072 sc1
    v_smfmac_f32_16x16x64_bf16 v[112:115], v[24:27], v[224:231], v13
    s_add_u32 s51, s50, 8192
    s_and_b32 s51, s51, 0x7ffff
    buffer_load_dwordx4 v[224:227], v0, s[12:15], s51 offen offset:0 sc1
    buffer_load_dwordx4 v[228:231], v0, s[12:15], s51 offen offset:1024 sc1
    v_smfmac_f32_16x16x64_bf16 v[116:119], v[24:27], v[232:239], v13
    buffer_load_dwordx4 v[232:235], v0, s[12:15], s51 offen offset:2048 sc1
    buffer_load_dwordx4 v[236:239], v0, s[12:15], s51 offen offset:3072 sc1
    v_smfmac_f32_16x16x64_bf16 v[120:123], v[24:27], v[240:247], v13
    s_add_u32 s51, s50, 12288
    s_and_b32 s51, s51, 0x7ffff
    buffer_load_dwordx4 v[240:243], v0, s[12:15], s51 offen offset:0 sc1
    buffer_load_dwordx4 v[244:247], v0, s[12:15], s51 offen offset:1024 sc1
    v_smfmac_f32_16x16x64_bf16 v[124:127], v[24:27], v[248:255], v13
    buffer_load_dwordx4 v[248:251], v0, s[12:15], s51 offen offset:2048 sc1
    buffer_load_dwordx4 v[252:255], v0, s[12:15], s51 offen offset:3072 sc1
    s_setprio 2
    s_cmp_eq_u32 s61, 6
    s_cbranch_scc0 SND12
    s_branch POLL6
POLLW6:
    s_nop 15
    s_nop 15
    s_nop 15
    s_nop 15
POLL6:
    ds_read_b32 v18, v0 offset:6144
    s_sub_u32 s56, s56, 1
    s_cmp_lt_i32 s56, 0
    s_cbranch_scc1 POLLX6
    s_waitcnt lgkmcnt(0)
    v_cmp_eq_u32 vcc, s52, v18
    s_cbranch_vccnz POLLW6
POLLX6:
    ds_read_b32 v5, v9 offset:6144
    ds_read_b32 v7, v9 offset:6400
    ds_read_b32 v8, v9 offset:6656
    ds_read_b32 v18, v9 offset:6912
    ds_read_b128 v[32:35], v14 offset:49152
    ds_read_b128 v[36:39], v14 offset:50176
    ds_read_b128 v[40:43], v14 offset:51200
    ds_read_b128 v[44:47], v14 offset:52224
    ds_read_b128 v[48:51], v14 offset:53248
    ds_read_b128 v[52:55], v14 offset:54272
    ds_read_b128 v[56:59], v14 offset:55296
    ds_read_b128 v[60:63], v14 offset:56320
    s_waitcnt lgkmcnt(8)
    v_add_f32 v5, v5, v7
    v_add_f32 v8, v8, v18
    v_add_f32 v5, v5, v8
    v_rcp_f32 v8, v5
    s_waitcnt lgkmcnt(4)
    v_pk_add_f32 v[32:33], v[32:33], v[40:41]
    v_pk_add_f32 v[34:35], v[34:35], v[42:43]
    v_pk_add_f32 v[36:37], v[36:37], v[44:45]
    v_pk_add_f32 v[38:39], v[38:39], v[46:47]
    v_max_f32 v7, v5, v8
    v_cmp_ge_f32 vcc, s55, v7
    v_cndmask_b32 v8, v15, v8, vcc
    s_waitcnt lgkmcnt(0)
    v_pk_add_f32 v[48:49], v[48:49], v[56:57]
    v_pk_add_f32 v[50:51], v[50:51], v[58:59]
    v_pk_add_f32 v[52:53], v[52:53], v[60:61]
    v_pk_add_f32 v[54:55], v[54:55], v[62:63]
    v_pk_add_f32 v[32:33], v[32:33], v[48:49]
    v_pk_add_f32 v[34:35], v[34:35], v[50:51]
    v_pk_add_f32 v[36:37], v[36:37], v[52:53]
    v_pk_add_f32 v[38:39], v[38:39], v[54:55]
    v_pk_mul_f32 v[32:33], v[32:33], v[8:9] op_sel_hi:[1,0]
    v_pk_mul_f32 v[34:35], v[34:35], v[8:9] op_sel_hi:[1,0]
    v_pk_mul_f32 v[36:37], v[36:37], v[8:9] op_sel_hi:[1,0]
    v_pk_mul_f32 v[38:39], v[38:39], v[8:9] op_sel_hi:[1,0]
    v_cvt_pk_bf16_f32 v28, v32, v33
    v_cvt_pk_bf16_f32 v29, v34, v35
    v_cvt_pk_bf16_f32 v30, v36, v37
    v_cvt_pk_bf16_f32 v31, v38, v39
    s_add_u32 s44, s32, 7
    s_and_b32 s44, s44, 7
    s_and_b32 s45, s32, 0xf8
    s_add_u32 s44, s44, s45
    s_lshl_b32 s44, s44, 13
    s_add_u32 s44, s44, 6144
    s_add_u32 s61, s61, 4
    buffer_store_dwordx4 v[28:31], v0, s[16:19], s44 offen sc1
SND12:
    s_branch POLLI6
POLLWI6:
    s_nop 15
    s_nop 15
    s_nop 15
    s_nop 15
POLLI6:
    ds_read_b32 v18, v0 offset:6144
    s_sub_u32 s56, s56, 1
    s_cmp_lt_i32 s56, 0
    s_cbranch_scc1 POLLXI6
    s_waitcnt lgkmcnt(0)
    v_cmp_eq_u32 vcc, s52, v18
    s_cbranch_vccnz POLLWI6
POLLXI6:
    s_lshl_b32 s44, s32, 14
    s_lshl_b32 s45, s33, 8
    s_add_u32 s44, s44, s45
    v_bfe_u32 v12, v6, 4, 1
    v_lshrrev_b32 v5, 5, v6
    v_and_b32 v7, 15, v6
    v_lshl_add_u32 v12, v12, 13, s44
    v_lshl_add_u32 v12, v5, 12, v12
    v_lshl_add_u32 v12, v7, 4, v12
    s_nop 15
    s_nop 15
    s_nop 15
    s_nop 15
    buffer_load_dwordx4 v[20:23], v0, s[16:19], s63 offen offset:2048 sc1
    s_waitcnt vmcnt(0)
    v_cmp_eq_u32 vcc, -1, v20
    s_cbranch_vccnz OSLOW6
OOK6:
    s_setprio 0
    v_smfmac_f32_16x16x64_bf16 v[96:99], v[20:23], v[128:135], v13
    v_smfmac_f32_16x16x64_bf16 v[100:103], v[20:23], v[136:143], v13
    v_smfmac_f32_16x16x64_bf16 v[104:107], v[20:23], v[144:151], v13
    v_smfmac_f32_16x16x64_bf16 v[108:111], v[20:23], v[152:159], v13
    v_smfmac_f32_16x16x64_bf16 v[112:115], v[20:23], v[160:167], v13
    v_smfmac_f32_16x16x64_bf16 v[116:119], v[20:23], v[168:175], v13
    v_smfmac_f32_16x16x64_bf16 v[120:123], v[20:23], v[176:183], v13
    v_smfmac_f32_16x16x64_bf16 v[124:127], v[20:23], v[184:191], v13
    s_setprio 2
    s_barrier
    ds_read_b32 v5, v9 offset:7168
    ds_read_b32 v7, v9 offset:7424
    ds_read_b32 v8, v9 offset:7680
    ds_read_b32 v18, v9 offset:7936
    ds_read_b128 v[32:35], v14 offset:57344
    ds_read_b128 v[36:39], v14 offset:58368
    ds_read_b128 v[40:43], v14 offset:59392
    ds_read_b128 v[44:47], v14 offset:60416
    ds_read_b128 v[48:51], v14 offset:61440
    ds_read_b128 v[52:55], v14 offset:62464
    ds_read_b128 v[56:59], v14 offset:63488
    ds_read_b128 v[60:63], v14 offset:64512
    s_waitcnt lgkmcnt(8)
    v_add_f32 v5, v5, v7
    v_add_f32 v8, v8, v18
    v_add_f32 v5, v5, v8
    v_rcp_f32 v8, v5
    s_waitcnt lgkmcnt(4)
    v_pk_add_f32 v[32:33], v[32:33], v[40:41]
    v_pk_add_f32 v[34:35], v[34:35], v[42:43]
    v_pk_add_f32 v[36:37], v[36:37], v[44:45]
    v_pk_add_f32 v[38:39], v[38:39], v[46:47]
    v_max_f32 v15, v5, v8
    s_waitcnt lgkmcnt(0)
    v_pk_add_f32 v[48:49], v[48:49], v[56:57]
    v_pk_add_f32 v[50:51], v[50:51], v[58:59]
    v_pk_add_f32 v[52:53], v[52:53], v[60:61]
    v_pk_add_f32 v[54:55], v[54:55], v[62:63]
    v_pk_add_f32 v[32:33], v[32:33], v[48:49]
    v_pk_add_f32 v[34:35], v[34:35], v[50:51]
    v_pk_add_f32 v[36:37], v[36:37], v[52:53]
    v_pk_add_f32 v[38:39], v[38:39], v[54:55]
    v_pk_mul_f32 v[32:33], v[32:33], v[8:9] op_sel_hi:[1,0]
    v_pk_mul_f32 v[34:35], v[34:35], v[8:9] op_sel_hi:[1,0]
    v_pk_mul_f32 v[36:37], v[36:37], v[8:9] op_sel_hi:[1,0]
    v_pk_mul_f32 v[38:39], v[38:39], v[8:9] op_sel_hi:[1,0]
    v_cvt_pk_bf16_f32 v28, v32, v33
    v_cvt_pk_bf16_f32 v29, v34, v35
    v_cvt_pk_bf16_f32 v30, v36, v37
    v_cvt_pk_bf16_f32 v31, v38, v39
    s_nop 1
    v_smfmac_f32_16x16x64_bf16 v[96:99], v[28:31], v[192:199], v13
    v_smfmac_f32_16x16x64_bf16 v[100:103], v[28:31], v[200:207], v13
    v_smfmac_f32_16x16x64_bf16 v[104:107], v[28:31], v[208:215], v13
    v_smfmac_f32_16x16x64_bf16 v[108:111], v[28:31], v[216:223], v13
    v_smfmac_f32_16x16x64_bf16 v[112:115], v[28:31], v[224:231], v13
    v_smfmac_f32_16x16x64_bf16 v[116:119], v[28:31], v[232:239], v13
    v_smfmac_f32_16x16x64_bf16 v[120:123], v[28:31], v[240:247], v13
    v_smfmac_f32_16x16x64_bf16 v[124:127], v[28:31], v[248:255], v13
OFINAL:
    s_nop 7
    v_permlane32_swap_b32 v96, v98
    v_permlane32_swap_b32 v97, v99
    v_permlane32_swap_b32 v100, v102
    v_permlane32_swap_b32 v101, v103
    v_permlane32_swap_b32 v104, v106
    v_permlane32_swap_b32 v105, v107
    v_permlane32_swap_b32 v108, v110
    v_permlane32_swap_b32 v109, v111
    v_permlane32_swap_b32 v112, v114
    v_permlane32_swap_b32 v113, v115
    v_permlane32_swap_b32 v116, v118
    v_permlane32_swap_b32 v117, v119
    v_permlane32_swap_b32 v120, v122
    v_permlane32_swap_b32 v121, v123
    v_permlane32_swap_b32 v124, v126
    v_permlane32_swap_b32 v125, v127
    v_pk_add_f32 v[96:97], v[96:97], v[98:99]
    v_pk_add_f32 v[100:101], v[100:101], v[102:103]
    v_pk_add_f32 v[104:105], v[104:105], v[106:107]
    v_pk_add_f32 v[108:109], v[108:109], v[110:111]
    v_pk_add_f32 v[112:113], v[112:113], v[114:115]
    v_pk_add_f32 v[116:117], v[116:117], v[118:119]
    v_pk_add_f32 v[120:121], v[120:121], v[122:123]
    v_pk_add_f32 v[124:125], v[124:125], v[126:127]
    v_cvt_pk_bf16_f32 v32, v96, v100
    v_cvt_pk_bf16_f32 v33, v104, v108
    v_cvt_pk_bf16_f32 v34, v112, v116
    v_cvt_pk_bf16_f32 v35, v120, v124
    buffer_store_dwordx4 v[32:35], v12, s[28:31], 0 offen offset:0 nt sc0 sc1
    v_cvt_pk_bf16_f32 v36, v97, v101
    v_cvt_pk_bf16_f32 v37, v105, v109
    v_cvt_pk_bf16_f32 v38, v113, v117
    v_cvt_pk_bf16_f32 v39, v121, v125
    buffer_store_dwordx4 v[36:39], v12, s[28:31], 0 offen offset:2048 nt sc0 sc1
OF2:
    s_cmp_lg_u32 s53, 0
    s_cbranch_scc1 K_END
    v_pk_add_f32 v[96:97], v[96:97], v[100:101]
    v_pk_add_f32 v[96:97], v[96:97], v[104:105]
    v_pk_add_f32 v[96:97], v[96:97], v[108:109]
    v_pk_add_f32 v[96:97], v[96:97], v[112:113]
    v_pk_add_f32 v[96:97], v[96:97], v[116:117]
    v_pk_add_f32 v[96:97], v[96:97], v[120:121]
    v_pk_add_f32 v[96:97], v[96:97], v[124:125]
    v_add_f32 v96, v96, v97
    v_mov_b32 v19, 0x207
    v_cmp_class_f32 vcc, v96, v19
    v_cmp_nge_f32 s[44:45], s55, v15
    s_or_b64 vcc, vcc, s[44:45]
    s_cbranch_vccz K2_HOK
    v_mov_b32 v18, 148480
    v_mov_b32 v19, 1
    ds_write_b32 v18, v19
K2_HOK:
    s_waitcnt lgkmcnt(0)
    s_barrier
    v_mov_b32 v18, 148480
    ds_read_b32 v19, v18
    s_waitcnt lgkmcnt(0)
    v_readfirstlane_b32 s54, v19
    s_cmp_eq_u32 s54, 0
    s_cbranch_scc1 K_END
    s_setprio 0
    s_load_dwordx2 s[64:65], s[0:1], 0
    s_load_dwordx2 s[84:85], s[0:1], 8
    s_load_dwordx2 s[68:69], s[0:1], 32
    s_waitcnt vmcnt(0) lgkmcnt(0)
    s_mov_b32 s63, 0
FBK_H:
    s_lshr_b32 s60, s63, 3
    s_and_b32 s61, s63, 7
    v_lshrrev_b32 v174, 4, v6
    v_and_b32 v175, 15, v6
    v_xor_b32 v175, v175, v174
    s_lshl_b32 s44, s60, 16
    v_lshl_add_u32 v176, v174, 10, s44
    s_and_b32 s51, s61, 6
    s_lshl_b32 s93, s33, 12
    s_mul_i32 s89, s33, 3
    s_lshl_b32 s51, s51, 1
    s_add_u32 s44, s89, 4
    s_and_b32 s45, s44, 3
    s_lshl_b32 s45, s45, 2
    s_add_u32 s44, s44, s51
    s_and_b32 s44, s44, 15
    s_lshl_b32 s44, s44, 12
    v_xor_b32 v177, s45, v175
    v_lshl_add_u32 v128, v177, 4, v176
    v_add_u32 v128, s44, v128
    s_add_u32 s44, s89, 5
    s_and_b32 s45, s44, 3
    s_lshl_b32 s45, s45, 2
    s_add_u32 s44, s44, s51
    s_and_b32 s44, s44, 15
    s_lshl_b32 s44, s44, 12
    v_xor_b32 v177, s45, v175
    v_lshl_add_u32 v129, v177, 4, v176
    v_add_u32 v129, s44, v129
    s_add_u32 s44, s89, 6
    s_and_b32 s45, s44, 3
    s_lshl_b32 s45, s45, 2
    s_add_u32 s44, s44, s51
    s_and_b32 s44, s44, 15
    s_lshl_b32 s44, s44, 12
    v_xor_b32 v177, s45, v175
    v_lshl_add_u32 v130, v177, 4, v176
    v_add_u32 v130, s44, v130
    s_lshl_b32 s89, s89, 10
    v_lshrrev_b32 v177, 3, v6
    v_and_b32 v178, 7, v6
    v_and_b32 v174, 1, v174
    v_lshlrev_b32 v174, 2, v174
    v_xor_b32 v178, v178, v174
    s_lshl_b32 s44, s33, 15
    s_lshl_b32 s45, s61, 7
    s_add_u32 s44, s44, s45
    v_lshlrev_b32 v177, 10, v177
    v_lshl_add_u32 v177, v178, 4, v177
    v_add_u32 v131, s44, v177
    v_add_u32 v132, 7168, v131
    v_add_u32 v133, 14336, v131
    v_add_u32 v134, 21504, v131
    s_mov_b32 s66, 2097152
    s_mov_b32 s67, 0x20000
    s_mov_b32 s86, 524288
    s_mov_b32 s87, 0x20000
    s_add_u32 m0, s93, 16384
    s_mov_b32 s45, 0
    buffer_load_dwordx4 v131, s[84:87], s45 offen offset:0 lds
    buffer_load_dwordx4 v132, s[84:87], s45 offen offset:1024 lds
    buffer_load_dwordx4 v133, s[84:87], s45 offen offset:2048 lds
    buffer_load_dwordx4 v134, s[84:87], s45 offen offset:3072 lds
    s_add_u32 m0, s89, 4096
    s_movk_i32 s44, 0
    buffer_load_dwordx4 v128, s[64:67], s44 offen lds
    s_add_u32 m0, s89, 5120
    s_movk_i32 s44, 0
    buffer_load_dwordx4 v129, s[64:67], s44 offen lds
    s_add_u32 m0, s89, 6144
    s_movk_i32 s44, 0
    buffer_load_dwordx4 v130, s[64:67], s44 offen lds
    s_add_u32 m0, s93, 53248
    s_mov_b32 s45, 131072
    buffer_load_dwordx4 v131, s[84:87], s45 offen offset:0 lds
    buffer_load_dwordx4 v132, s[84:87], s45 offen offset:1024 lds
    buffer_load_dwordx4 v133, s[84:87], s45 offen offset:2048 lds
    buffer_load_dwordx4 v134, s[84:87], s45 offen offset:3072 lds
    s_add_u32 m0, s89, 40960
    s_movk_i32 s44, 256
    buffer_load_dwordx4 v128, s[64:67], s44 offen lds
    s_add_u32 m0, s89, 41984
    s_movk_i32 s44, 256
    buffer_load_dwordx4 v129, s[64:67], s44 offen lds
    s_add_u32 m0, s89, 43008
    s_movk_i32 s44, 256
    buffer_load_dwordx4 v130, s[64:67], s44 offen lds
    s_add_u32 m0, s93, 90112
    s_mov_b32 s45, 262144
    buffer_load_dwordx4 v131, s[84:87], s45 offen offset:0 lds
    buffer_load_dwordx4 v132, s[84:87], s45 offen offset:1024 lds
    buffer_load_dwordx4 v133, s[84:87], s45 offen offset:2048 lds
    buffer_load_dwordx4 v134, s[84:87], s45 offen offset:3072 lds
    s_add_u32 m0, s89, 77824
    s_movk_i32 s44, 512
    buffer_load_dwordx4 v128, s[64:67], s44 offen lds
    s_add_u32 m0, s89, 78848
    s_movk_i32 s44, 512
    buffer_load_dwordx4 v129, s[64:67], s44 offen lds
    s_add_u32 m0, s89, 79872
    s_movk_i32 s44, 512
    buffer_load_dwordx4 v130, s[64:67], s44 offen lds
    s_add_u32 m0, s93, 126976
    s_mov_b32 s45, 393216
    buffer_load_dwordx4 v131, s[84:87], s45 offen offset:0 lds
    buffer_load_dwordx4 v132, s[84:87], s45 offen offset:1024 lds
    buffer_load_dwordx4 v133, s[84:87], s45 offen offset:2048 lds
    buffer_load_dwordx4 v134, s[84:87], s45 offen offset:3072 lds
    s_add_u32 m0, s89, 114688
    s_movk_i32 s44, 768
    buffer_load_dwordx4 v128, s[64:67], s44 offen lds
    s_add_u32 m0, s89, 115712
    s_movk_i32 s44, 768
    buffer_load_dwordx4 v129, s[64:67], s44 offen lds
    s_add_u32 m0, s89, 116736
    s_movk_i32 s44, 768
    buffer_load_dwordx4 v130, s[64:67], s44 offen lds
    s_lshr_b32 s44, s63, 5
    s_lshl_b32 s44, s44, 3
    s_and_b32 s45, s63, 7
    s_add_u32 s44, s44, s45
    s_lshl_b32 s44, s44, 13
    s_bfe_u32 s45, s63, 0x20003
    s_lshl_b32 s45, s45, 8
    s_add_u32 s44, s44, s45
    v_lshl_add_u32 v136, v6, 2, s44
    s_lshr_b32 s44, s63, 3
    s_lshl_b32 s44, s44, 14
    s_and_b32 s45, s63, 7
    s_lshl_b32 s45, s45, 8
    s_add_u32 s44, s44, s45
    s_add_u32 s44, s44, 2228224
    v_and_b32 v174, 3, v6
    v_lshl_add_u32 v174, v174, 12, s44
    v_lshrrev_b32 v175, 2, v6
    v_lshl_add_u32 v137, v175, 4, v174
    s_movk_i32 s45, 4096
    s_mov_b32 s70, 524288
    s_mov_b32 s71, 0x20000
    buffer_load_dword v140, v136, s[68:71], 0 offen offset:0
    buffer_load_dword v141, v136, s[68:71], 0 offen offset:1024
    buffer_load_dword v142, v136, s[68:71], 0 offen offset:2048
    buffer_load_dword v143, v136, s[68:71], 0 offen offset:3072
    buffer_load_dword v144, v136, s[68:71], s45 offen offset:0
    buffer_load_dword v145, v136, s[68:71], s45 offen offset:1024
    buffer_load_dword v146, v136, s[68:71], s45 offen offset:2048
    buffer_load_dword v147, v136, s[68:71], s45 offen offset:3072
    s_waitcnt vmcnt(0)
    s_mov_b32 s44, 0x05040100
    s_mov_b32 s45, 0x07060302
    v_perm_b32 v148, v141, v140, s44
    v_perm_b32 v152, v141, v140, s45
    v_perm_b32 v149, v145, v144, s44
    v_perm_b32 v153, v145, v144, s45
    v_perm_b32 v150, v143, v142, s44
    v_perm_b32 v154, v143, v142, s45
    v_perm_b32 v151, v147, v146, s44
    v_perm_b32 v155, v147, v146, s45
    buffer_store_dwordx4 v[148:151], v137, s[16:19], 0 offen sc1
    buffer_store_dwordx4 v[152:155], v137, s[16:19], 0 offen offset:2048 sc1
    s_barrier
    s_barrier
    s_barrier
    s_barrier
    s_barrier
    s_barrier
    s_add_u32 s63, s63, 1
    s_cmp_lt_u32 s63, 256
    s_cbranch_scc1 FBK_H
    s_waitcnt vmcnt(0)
    s_barrier
    v_mov_b64 v[96:97], 0
    v_mov_b64 v[98:99], 0
    v_mov_b64 v[100:101], 0
    v_mov_b64 v[102:103], 0
    v_mov_b64 v[104:105], 0
    v_mov_b64 v[106:107], 0
    v_mov_b64 v[108:109], 0
    v_mov_b64 v[110:111], 0
    v_mov_b64 v[112:113], 0
    v_mov_b64 v[114:115], 0
    v_mov_b64 v[116:117], 0
    v_mov_b64 v[118:119], 0
    v_mov_b64 v[120:121], 0
    v_mov_b64 v[122:123], 0
    v_mov_b64 v[124:125], 0
    v_mov_b64 v[126:127], 0
    s_barrier
    s_barrier
    s_barrier
    s_barrier
    s_barrier
    s_barrier
    s_barrier
    s_barrier
    s_barrier
    s_mov_b32 s53, 0
FB_O:
    s_add_u32 s51, s50, 0
    s_and_b32 s51, s51, 0x7ffff
    buffer_load_dwordx4 v[128:131], v0, s[12:15], s51 offen offset:0 sc1
    buffer_load_dwordx4 v[132:135], v0, s[12:15], s51 offen offset:1024 sc1
    buffer_load_dwordx4 v[136:139], v0, s[12:15], s51 offen offset:2048 sc1
    buffer_load_dwordx4 v[140:143], v0, s[12:15], s51 offen offset:3072 sc1
    s_add_u32 s51, s50, 4096
    s_and_b32 s51, s51, 0x7ffff
    buffer_load_dwordx4 v[144:147], v0, s[12:15], s51 offen offset:0 sc1
    buffer_load_dwordx4 v[148:151], v0, s[12:15], s51 offen offset:1024 sc1
    buffer_load_dwordx4 v[152:155], v0, s[12:15], s51 offen offset:2048 sc1
    buffer_load_dwordx4 v[156:159], v0, s[12:15], s51 offen offset:3072 sc1
    s_add_u32 s51, s50, 8192
    s_and_b32 s51, s51, 0x7ffff
    buffer_load_dwordx4 v[160:163], v0, s[12:15], s51 offen offset:0 sc1
    buffer_load_dwordx4 v[164:167], v0, s[12:15], s51 offen offset:1024 sc1
    buffer_load_dwordx4 v[168:171], v0, s[12:15], s51 offen offset:2048 sc1
    buffer_load_dwordx4 v[172:175], v0, s[12:15], s51 offen offset:3072 sc1
    s_add_u32 s51, s50, 12288
    s_and_b32 s51, s51, 0x7ffff
    buffer_load_dwordx4 v[176:179], v0, s[12:15], s51 offen offset:0 sc1
    buffer_load_dwordx4 v[180:183], v0, s[12:15], s51 offen offset:1024 sc1
    buffer_load_dwordx4 v[184:187], v0, s[12:15], s51 offen offset:2048 sc1
    buffer_load_dwordx4 v[188:191], v0, s[12:15], s51 offen offset:3072 sc1
    ds_read_b32 v5, v9 offset:0
    ds_read_b32 v7, v9 offset:256
    ds_read_b32 v8, v9 offset:512
    ds_read_b32 v18, v9 offset:768
    ds_read_b128 v[32:35], v14 offset:0
    ds_read_b128 v[36:39], v14 offset:1024
    ds_read_b128 v[40:43], v14 offset:2048
    ds_read_b128 v[44:47], v14 offset:3072
    ds_read_b128 v[48:51], v14 offset:4096
    ds_read_b128 v[52:55], v14 offset:5120
    ds_read_b128 v[56:59], v14 offset:6144
    ds_read_b128 v[60:63], v14 offset:7168
    s_waitcnt lgkmcnt(8)
    v_add_f32 v5, v5, v7
    v_add_f32 v8, v8, v18
    v_add_f32 v5, v5, v8
    v_rcp_f32 v8, v5
    s_waitcnt lgkmcnt(4)
    v_pk_add_f32 v[32:33], v[32:33], v[40:41]
    v_pk_add_f32 v[34:35], v[34:35], v[42:43]
    v_pk_add_f32 v[36:37], v[36:37], v[44:45]
    v_pk_add_f32 v[38:39], v[38:39], v[46:47]
    v_max_f32 v15, v5, v8
    s_waitcnt lgkmcnt(0)
    v_pk_add_f32 v[48:49], v[48:49], v[56:57]
    v_pk_add_f32 v[50:51], v[50:51], v[58:59]
    v_pk_add_f32 v[52:53], v[52:53], v[60:61]
    v_pk_add_f32 v[54:55], v[54:55], v[62:63]
    v_pk_add_f32 v[32:33], v[32:33], v[48:49]
    v_pk_add_f32 v[34:35], v[34:35], v[50:51]
    v_pk_add_f32 v[36:37], v[36:37], v[52:53]
    v_pk_add_f32 v[38:39], v[38:39], v[54:55]
    v_pk_mul_f32 v[32:33], v[32:33], v[8:9] op_sel_hi:[1,0]
    v_pk_mul_f32 v[34:35], v[34:35], v[8:9] op_sel_hi:[1,0]
    v_pk_mul_f32 v[36:37], v[36:37], v[8:9] op_sel_hi:[1,0]
    v_pk_mul_f32 v[38:39], v[38:39], v[8:9] op_sel_hi:[1,0]
    v_cvt_pk_bf16_f32 v28, v32, v33
    v_cvt_pk_bf16_f32 v29, v34, v35
    v_cvt_pk_bf16_f32 v30, v36, v37
    v_cvt_pk_bf16_f32 v31, v38, v39
    s_waitcnt vmcnt(0)
    s_nop 0
    v_smfmac_f32_16x16x64_bf16 v[96:99], v[28:31], v[128:135], v13
    v_smfmac_f32_16x16x64_bf16 v[100:103], v[28:31], v[136:143], v13
    v_smfmac_f32_16x16x64_bf16 v[104:107], v[28:31], v[144:151], v13
    v_smfmac_f32_16x16x64_bf16 v[108:111], v[28:31], v[152:159], v13
    v_smfmac_f32_16x16x64_bf16 v[112:115], v[28:31], v[160:167], v13
    v_smfmac_f32_16x16x64_bf16 v[116:119], v[28:31], v[168:175], v13
    v_smfmac_f32_16x16x64_bf16 v[120:123], v[28:31], v[176:183], v13
    v_smfmac_f32_16x16x64_bf16 v[124:127], v[28:31], v[184:191], v13
    v_add_u32 v9, 1024, v9
    v_add_u32 v14, 8192, v14
    s_add_u32 s50, s50, 65536
    s_add_u32 s53, s53, 1
    s_cmp_lt_u32 s53, 8
    s_cbranch_scc1 FB_O
    s_branch OFINAL
OSLOW0:
    s_sub_i32 s60, s60, 1
    s_cmp_lt_i32 s60, 0
    s_cbranch_scc1 OOK0
    buffer_load_dwordx4 v[20:23], v0, s[16:19], s54 offen offset:0 sc1
    s_waitcnt vmcnt(0)
    v_cmp_eq_u32 vcc, -1, v20
    s_cbranch_vccnz OSLOW0
    s_branch OOK0
OSLOW1:
    s_sub_i32 s60, s60, 1
    s_cmp_lt_i32 s60, 0
    s_cbranch_scc1 OOK1
    buffer_load_dwordx4 v[24:27], v0, s[16:19], s54 offen offset:1024 sc1
    s_waitcnt vmcnt(0)
    v_cmp_eq_u32 vcc, -1, v24
    s_cbranch_vccnz OSLOW1
    s_branch OOK1
OSLOW2:
    s_sub_i32 s60, s60, 1
    s_cmp_lt_i32 s60, 0
    s_cbranch_scc1 OOK2
    buffer_load_dwordx4 v[20:23], v0, s[16:19], s54 offen offset:2048 sc1
    s_waitcnt vmcnt(0)
    v_cmp_eq_u32 vcc, -1, v20
    s_cbranch_vccnz OSLOW2
    s_branch OOK2
OSLOW3:
    s_sub_i32 s60, s60, 1
    s_cmp_lt_i32 s60, 0
    s_cbranch_scc1 OOK3
    buffer_load_dwordx4 v[24:27], v0, s[16:19], s54 offen offset:3072 sc1
    s_waitcnt vmcnt(0)
    v_cmp_eq_u32 vcc, -1, v24
    s_cbranch_vccnz OSLOW3
    s_branch OOK3
OSLOW4:
    s_sub_i32 s60, s60, 1
    s_cmp_lt_i32 s60, 0
    s_cbranch_scc1 OOK4
    buffer_load_dwordx4 v[20:23], v0, s[16:19], s63 offen offset:0 sc1
    s_waitcnt vmcnt(0)
    v_cmp_eq_u32 vcc, -1, v20
    s_cbranch_vccnz OSLOW4
    s_branch OOK4
OSLOW5:
    s_sub_i32 s60, s60, 1
    s_cmp_lt_i32 s60, 0
    s_cbranch_scc1 OOK5
    buffer_load_dwordx4 v[24:27], v0, s[16:19], s63 offen offset:1024 sc1
    s_waitcnt vmcnt(0)
    v_cmp_eq_u32 vcc, -1, v24
    s_cbranch_vccnz OSLOW5
    s_branch OOK5
OSLOW6:
    s_sub_i32 s60, s60, 1
    s_cmp_lt_i32 s60, 0
    s_cbranch_scc1 OOK6
    buffer_load_dwordx4 v[20:23], v0, s[16:19], s63 offen offset:2048 sc1
    s_waitcnt vmcnt(0)
    v_cmp_eq_u32 vcc, -1, v20
    s_cbranch_vccnz OSLOW6
    s_branch OOK6
WSLOW:
    s_movk_i32 s45, 300
WSLOW1:
    s_sub_u32 s45, s45, 1
    s_cbranch_scc1 WBAD
    buffer_load_dword v190, v191, s[16:19], 0 offen sc1
    s_waitcnt vmcnt(0)
    v_cmp_eq_u32 vcc, v189, v190
    s_cbranch_vccnz WSLOW1
    s_branch WOK
WBAD:
    v_mov_b32 v18, 148480
    v_mov_b32 v19, 1
    ds_write_b32 v18, v19
    s_branch WOK
YSLOW:
    s_movk_i32 s45, 2000
YSLOW1:
    s_sub_u32 s45, s45, 1
    s_cbranch_scc1 YSELF
    buffer_load_dwordx4 v[80:83], v11, s[16:19], 0 offen offset:0 sc1
    buffer_load_dwordx4 v[84:87], v11, s[16:19], 0 offen offset:16 sc1
    s_waitcnt vmcnt(0)
    v_max_u32 v5, v80, v84
    v_cmp_eq_u32 vcc, -1, v5
    s_cbranch_vccnz YSLOW1
    s_branch YOK
YSELF:
    s_waitcnt vmcnt(0) lgkmcnt(0)
    s_mov_b32 s64, s4
    s_mov_b32 s65, s5
    s_mov_b32 s66, 2097152
    s_mov_b32 s67, 0x20000
    s_mov_b32 s68, s6
    s_mov_b32 s69, s7
    s_mov_b32 s70, 1024
    s_mov_b32 s71, 0x20000
    v_and_b32 v74, 1023, v17
    v_lshrrev_b32 v75, 11, v17
    v_lshlrev_b32 v76, 2, v74
    buffer_load_dwordx4 v[66:69], v76, s[80:83], 0 offen
    buffer_load_dword v70, v74, s[68:71], 0 offen
    v_lshlrev_b32 v76, 11, v74
    s_waitcnt vmcnt(0)
    v_lshlrev_b32 v88, 16, v70
    v_and_b32 v89, s62, v70
    v_lshlrev_b32 v48, 16, v66
    v_lshlrev_b32 v49, 16, v68
    v_and_b32 v50, s62, v66
    v_and_b32 v51, s62, v68
    v_lshlrev_b32 v52, 16, v67
    v_lshlrev_b32 v53, 16, v69
    v_and_b32 v54, s62, v67
    v_and_b32 v55, s62, v69
    v_mov_b64 v[32:33], 0
    v_mov_b64 v[34:35], 0
    v_mov_b64 v[36:37], 0
    v_mov_b64 v[38:39], 0
    v_mov_b64 v[40:41], 0
    v_mov_b64 v[42:43], 0
    v_mov_b64 v[44:45], 0
    v_mov_b64 v[46:47], 0
    v_mov_b64 v[56:57], 0
    v_mov_b64 v[58:59], 0
    v_mov_b64 v[60:61], 0
    v_mov_b64 v[62:63], 0
    s_mov_b32 s44, 0
YSELF1:
    s_lshl_b32 s45, s44, 10
    buffer_load_dword v77, v74, s[72:75], s45 offen
    buffer_load_dword v78, v74, s[76:79], s45 offen
    v_mov_b64 v[62:63], v[60:61]
    v_mov_b64 v[60:61], v[58:59]
    v_mov_b64 v[58:59], v[56:57]
    s_waitcnt vmcnt(0)
    v_lshlrev_b32 v56, 16, v77
    v_and_b32 v57, s62, v77
    v_pk_mul_f32 v[64:65], v[56:57], v[48:49]
    v_pk_fma_f32 v[64:65], v[58:59], v[50:51], v[64:65]
    v_pk_fma_f32 v[64:65], v[60:61], v[52:53], v[64:65]
    v_pk_fma_f32 v[64:65], v[62:63], v[54:55], v[64:65]
    v_lshlrev_b32 v66, 16, v78
    v_and_b32 v67, s62, v78
    v_pk_mul_f32 v[64:65], v[64:65], v[66:67]
    v_subrev_u32 v77, s44, v75
    v_add_u32 v77, 0, v77
    v_lshl_add_u32 v78, v77, 1, v76
    v_cmp_gt_i32 vcc, 0, v77
    v_mov_b32 v79, 0x7fff0000
    v_cndmask_b32 v78, v78, v79, vcc
    buffer_load_ushort v66, v78, s[64:67], 0 offen
    buffer_load_ushort v67, v78, s[64:67], s47 offen
    v_cmp_eq_u32 vcc, 0, v77
    v_cndmask_b32 v68, 0, v88, vcc
    v_cndmask_b32 v69, 0, v89, vcc
    s_waitcnt vmcnt(0)
    v_lshlrev_b32 v66, 16, v66
    v_lshlrev_b32 v67, 16, v67
    v_pk_add_f32 v[66:67], v[66:67], v[68:69]
    v_pk_fma_f32 v[32:33], v[66:67], v[64:65], v[32:33]
    v_subrev_u32 v77, s44, v75
    v_add_u32 v77, 1, v77
    v_lshl_add_u32 v78, v77, 1, v76
    v_cmp_gt_i32 vcc, 0, v77
    v_mov_b32 v79, 0x7fff0000
    v_cndmask_b32 v78, v78, v79, vcc
    buffer_load_ushort v66, v78, s[64:67], 0 offen
    buffer_load_ushort v67, v78, s[64:67], s47 offen
    v_cmp_eq_u32 vcc, 0, v77
    v_cndmask_b32 v68, 0, v88, vcc
    v_cndmask_b32 v69, 0, v89, vcc
    s_waitcnt vmcnt(0)
    v_lshlrev_b32 v66, 16, v66
    v_lshlrev_b32 v67, 16, v67
    v_pk_add_f32 v[66:67], v[66:67], v[68:69]
    v_pk_fma_f32 v[34:35], v[66:67], v[64:65], v[34:35]
    v_subrev_u32 v77, s44, v75
    v_add_u32 v77, 2, v77
    v_lshl_add_u32 v78, v77, 1, v76
    v_cmp_gt_i32 vcc, 0, v77
    v_mov_b32 v79, 0x7fff0000
    v_cndmask_b32 v78, v78, v79, vcc
    buffer_load_ushort v66, v78, s[64:67], 0 offen
    buffer_load_ushort v67, v78, s[64:67], s47 offen
    v_cmp_eq_u32 vcc, 0, v77
    v_cndmask_b32 v68, 0, v88, vcc
    v_cndmask_b32 v69, 0, v89, vcc
    s_waitcnt vmcnt(0)
    v_lshlrev_b32 v66, 16, v66
    v_lshlrev_b32 v67, 16, v67
    v_pk_add_f32 v[66:67], v[66:67], v[68:69]
    v_pk_fma_f32 v[36:37], v[66:67], v[64:65], v[36:37]
    v_subrev_u32 v77, s44, v75
    v_add_u32 v77, 3, v77
    v_lshl_add_u32 v78, v77, 1, v76
    v_cmp_gt_i32 vcc, 0, v77
    v_mov_b32 v79, 0x7fff0000
    v_cndmask_b32 v78, v78, v79, vcc
    buffer_load_ushort v66, v78, s[64:67], 0 offen
    buffer_load_ushort v67, v78, s[64:67], s47 offen
    v_cmp_eq_u32 vcc, 0, v77
    v_cndmask_b32 v68, 0, v88, vcc
    v_cndmask_b32 v69, 0, v89, vcc
    s_waitcnt vmcnt(0)
    v_lshlrev_b32 v66, 16, v66
    v_lshlrev_b32 v67, 16, v67
    v_pk_add_f32 v[66:67], v[66:67], v[68:69]
    v_pk_fma_f32 v[38:39], v[66:67], v[64:65], v[38:39]
    v_subrev_u32 v77, s44, v75
    v_add_u32 v77, 16, v77
    v_lshl_add_u32 v78, v77, 1, v76
    v_cmp_gt_i32 vcc, 0, v77
    v_mov_b32 v79, 0x7fff0000
    v_cndmask_b32 v78, v78, v79, vcc
    buffer_load_ushort v66, v78, s[64:67], 0 offen
    buffer_load_ushort v67, v78, s[64:67], s47 offen
    v_cmp_eq_u32 vcc, 0, v77
    v_cndmask_b32 v68, 0, v88, vcc
    v_cndmask_b32 v69, 0, v89, vcc
    s_waitcnt vmcnt(0)
    v_lshlrev_b32 v66, 16, v66
    v_lshlrev_b32 v67, 16, v67
    v_pk_add_f32 v[66:67], v[66:67], v[68:69]
    v_pk_fma_f32 v[40:41], v[66:67], v[64:65], v[40:41]
    v_subrev_u32 v77, s44, v75
    v_add_u32 v77, 17, v77
    v_lshl_add_u32 v78, v77, 1, v76
    v_cmp_gt_i32 vcc, 0, v77
    v_mov_b32 v79, 0x7fff0000
    v_cndmask_b32 v78, v78, v79, vcc
    buffer_load_ushort v66, v78, s[64:67], 0 offen
    buffer_load_ushort v67, v78, s[64:67], s47 offen
    v_cmp_eq_u32 vcc, 0, v77
    v_cndmask_b32 v68, 0, v88, vcc
    v_cndmask_b32 v69, 0, v89, vcc
    s_waitcnt vmcnt(0)
    v_lshlrev_b32 v66, 16, v66
    v_lshlrev_b32 v67, 16, v67
    v_pk_add_f32 v[66:67], v[66:67], v[68:69]
    v_pk_fma_f32 v[42:43], v[66:67], v[64:65], v[42:43]
    v_subrev_u32 v77, s44, v75
    v_add_u32 v77, 18, v77
    v_lshl_add_u32 v78, v77, 1, v76
    v_cmp_gt_i32 vcc, 0, v77
    v_mov_b32 v79, 0x7fff0000
    v_cndmask_b32 v78, v78, v79, vcc
    buffer_load_ushort v66, v78, s[64:67], 0 offen
    buffer_load_ushort v67, v78, s[64:67], s47 offen
    v_cmp_eq_u32 vcc, 0, v77
    v_cndmask_b32 v68, 0, v88, vcc
    v_cndmask_b32 v69, 0, v89, vcc
    s_waitcnt vmcnt(0)
    v_lshlrev_b32 v66, 16, v66
    v_lshlrev_b32 v67, 16, v67
    v_pk_add_f32 v[66:67], v[66:67], v[68:69]
    v_pk_fma_f32 v[44:45], v[66:67], v[64:65], v[44:45]
    v_subrev_u32 v77, s44, v75
    v_add_u32 v77, 19, v77
    v_lshl_add_u32 v78, v77, 1, v76
    v_cmp_gt_i32 vcc, 0, v77
    v_mov_b32 v79, 0x7fff0000
    v_cndmask_b32 v78, v78, v79, vcc
    buffer_load_ushort v66, v78, s[64:67], 0 offen
    buffer_load_ushort v67, v78, s[64:67], s47 offen
    v_cmp_eq_u32 vcc, 0, v77
    v_cndmask_b32 v68, 0, v88, vcc
    v_cndmask_b32 v69, 0, v89, vcc
    s_waitcnt vmcnt(0)
    v_lshlrev_b32 v66, 16, v66
    v_lshlrev_b32 v67, 16, v67
    v_pk_add_f32 v[66:67], v[66:67], v[68:69]
    v_pk_fma_f32 v[46:47], v[66:67], v[64:65], v[46:47]
    s_add_u32 s44, s44, 1
    s_cmp_lt_u32 s44, 2048
    s_cbranch_scc1 YSELF1
    v_cvt_pk_bf16_f32 v80, v32, v33
    v_cvt_pk_bf16_f32 v81, v34, v35
    v_cvt_pk_bf16_f32 v82, v36, v37
    v_cvt_pk_bf16_f32 v83, v38, v39
    v_cvt_pk_bf16_f32 v84, v40, v41
    v_cvt_pk_bf16_f32 v85, v42, v43
    v_cvt_pk_bf16_f32 v86, v44, v45
    v_cvt_pk_bf16_f32 v87, v46, v47
    ds_read_b32 v72, v16 offset:0
    ds_read_b32 v73, v16 offset:128
    ds_read_b32 v74, v16 offset:256
    ds_read_b32 v75, v16 offset:384
    ds_read_b32 v76, v16 offset:512
    ds_read_b32 v77, v16 offset:640
    ds_read_b32 v78, v16 offset:768
    ds_read_b32 v79, v16 offset:896
    s_waitcnt vmcnt(0)
    s_branch YOK
USLOW:
    s_movk_i32 s45, 150
USLOW1:
    s_sub_u32 s45, s45, 1
    s_cbranch_scc1 USELF
    buffer_load_dwordx4 v[80:83], v0, s[16:19], s57 offen offset:0 sc1
    buffer_load_dwordx4 v[84:87], v0, s[16:19], s57 offen offset:1024 sc1
    s_waitcnt vmcnt(0)
    v_max3_u32 v5, v80, v82, v84
    v_max_u32 v5, v5, v86
    v_cmp_eq_u32 vcc, -1, v5
    s_cbranch_vccnz USLOW1
    s_branch UOK
USELF:
    s_lshr_b32 s68, s59, 3
    s_mov_b32 s69, 0
USELF1:
    s_waitcnt vmcnt(0)
    v_and_b32 v251, 7, v6
    v_and_b32 v252, 56, v6
    s_lshl_b32 s44, s58, 7
    s_lshl_b32 s45, s68, 5
    s_add_u32 s44, s44, s45
    v_lshl_add_u32 v251, v251, 2, s44
    s_lshl_b32 s44, s69, 16
    v_lshlrev_b32 v247, 10, v252
    v_add3_u32 v246, v251, v247, s44
    v_subrev_u32 v247, 3072, v246
    v_lshlrev_b32 v248, 2, v251
    buffer_load_dword v195, v246, s[72:75], 0 offen offset:0
    buffer_load_dword v196, v246, s[72:75], 0 offen offset:1024
    buffer_load_dword v197, v246, s[72:75], 0 offen offset:2048
    buffer_load_dword v198, v246, s[72:75], 0 offen offset:3072
    buffer_load_dword v199, v246, s[72:75], s47 offen offset:0
    buffer_load_dword v200, v246, s[72:75], s47 offen offset:1024
    buffer_load_dword v201, v246, s[72:75], s47 offen offset:2048
    buffer_load_dword v202, v246, s[72:75], s47 offen offset:3072
    buffer_load_dword v192, v247, s[72:75], 0 offen offset:0
    buffer_load_dword v193, v247, s[72:75], 0 offen offset:1024
    buffer_load_dword v194, v247, s[72:75], 0 offen offset:2048
    buffer_load_dwordx4 v[212:215], v248, s[80:83], 0 offen
    buffer_load_dword v204, v246, s[76:79], 0 offen offset:0
    buffer_load_dword v205, v246, s[76:79], 0 offen offset:1024
    buffer_load_dword v206, v246, s[76:79], 0 offen offset:2048
    buffer_load_dword v207, v246, s[76:79], 0 offen offset:3072
    buffer_load_dword v208, v246, s[76:79], s47 offen offset:0
    buffer_load_dword v209, v246, s[76:79], s47 offen offset:1024
    buffer_load_dword v210, v246, s[76:79], s47 offen offset:2048
    buffer_load_dword v211, v246, s[76:79], s47 offen offset:3072
    v_mul_u32_u24 v249, 2112, v251
    s_lshl_b32 s44, s69, 7
    s_sub_u32 s44, 2772976, s44
    v_lshlrev_b32 v252, 1, v252
    v_sub_u32 v249, v249, v252
    v_add_u32 v249, s44, v249
    v_add_u32 v250, 4224, v249
    s_waitcnt vmcnt(8)
    v_lshlrev_b32 v216, 16, v212
    v_lshlrev_b32 v217, 16, v214
    v_and_b32 v218, s62, v212
    v_and_b32 v219, s62, v214
    v_lshlrev_b32 v220, 16, v213
    v_lshlrev_b32 v221, 16, v215
    v_and_b32 v222, s62, v213
    v_and_b32 v223, s62, v215
    v_lshlrev_b32 v224, 16, v192
    v_and_b32 v225, s62, v192
    v_lshlrev_b32 v226, 16, v193
    v_and_b32 v227, s62, v193
    v_lshlrev_b32 v228, 16, v194
    v_and_b32 v229, s62, v194
    v_lshlrev_b32 v230, 16, v195
    v_and_b32 v231, s62, v195
    v_lshlrev_b32 v232, 16, v196
    v_and_b32 v233, s62, v196
    v_lshlrev_b32 v234, 16, v197
    v_and_b32 v235, s62, v197
    v_lshlrev_b32 v236, 16, v198
    v_and_b32 v237, s62, v198
    v_lshlrev_b32 v238, 16, v199
    v_and_b32 v239, s62, v199
    v_lshlrev_b32 v240, 16, v200
    v_and_b32 v241, s62, v200
    v_lshlrev_b32 v242, 16, v201
    v_and_b32 v243, s62, v201
    v_lshlrev_b32 v244, 16, v202
    v_and_b32 v245, s62, v202
    v_pk_mul_f32 v[64:65], v[230:231], v[216:217]
    v_pk_mul_f32 v[66:67], v[232:233], v[216:217]
    v_pk_mul_f32 v[68:69], v[234:235], v[216:217]
    v_pk_mul_f32 v[70:71], v[236:237], v[216:217]
    v_pk_mul_f32 v[72:73], v[238:239], v[216:217]
    v_pk_mul_f32 v[74:75], v[240:241], v[216:217]
    v_pk_mul_f32 v[76:77], v[242:243], v[216:217]
    v_pk_mul_f32 v[78:79], v[244:245], v[216:217]
    v_pk_fma_f32 v[64:65], v[228:229], v[218:219], v[64:65]
    v_pk_fma_f32 v[66:67], v[230:231], v[218:219], v[66:67]
    v_pk_fma_f32 v[68:69], v[232:233], v[218:219], v[68:69]
    v_pk_fma_f32 v[70:71], v[234:235], v[218:219], v[70:71]
    v_pk_fma_f32 v[72:73], v[236:237], v[218:219], v[72:73]
    v_pk_fma_f32 v[74:75], v[238:239], v[218:219], v[74:75]
    v_pk_fma_f32 v[76:77], v[240:241], v[218:219], v[76:77]
    v_pk_fma_f32 v[78:79], v[242:243], v[218:219], v[78:79]
    v_pk_fma_f32 v[64:65], v[226:227], v[220:221], v[64:65]
    v_pk_fma_f32 v[66:67], v[228:229], v[220:221], v[66:67]
    v_pk_fma_f32 v[68:69], v[230:231], v[220:221], v[68:69]
    v_pk_fma_f32 v[70:71], v[232:233], v[220:221], v[70:71]
    v_pk_fma_f32 v[72:73], v[234:235], v[220:221], v[72:73]
    v_pk_fma_f32 v[74:75], v[236:237], v[220:221], v[74:75]
    v_pk_fma_f32 v[76:77], v[238:239], v[220:221], v[76:77]
    v_pk_fma_f32 v[78:79], v[240:241], v[220:221], v[78:79]
    v_pk_fma_f32 v[64:65], v[224:225], v[222:223], v[64:65]
    v_pk_fma_f32 v[66:67], v[226:227], v[222:223], v[66:67]
    v_pk_fma_f32 v[68:69], v[228:229], v[222:223], v[68:69]
    v_pk_fma_f32 v[70:71], v[230:231], v[222:223], v[70:71]
    v_pk_fma_f32 v[72:73], v[232:233], v[222:223], v[72:73]
    v_pk_fma_f32 v[74:75], v[234:235], v[222:223], v[74:75]
    v_pk_fma_f32 v[76:77], v[236:237], v[222:223], v[76:77]
    v_pk_fma_f32 v[78:79], v[238:239], v[222:223], v[78:79]
    s_waitcnt vmcnt(0)
    v_lshlrev_b32 v224, 16, v204
    v_and_b32 v225, s62, v204
    v_lshlrev_b32 v226, 16, v205
    v_and_b32 v227, s62, v205
    v_lshlrev_b32 v228, 16, v206
    v_and_b32 v229, s62, v206
    v_lshlrev_b32 v230, 16, v207
    v_and_b32 v231, s62, v207
    v_lshlrev_b32 v232, 16, v208
    v_and_b32 v233, s62, v208
    v_lshlrev_b32 v234, 16, v209
    v_and_b32 v235, s62, v209
    v_lshlrev_b32 v236, 16, v210
    v_and_b32 v237, s62, v210
    v_lshlrev_b32 v238, 16, v211
    v_and_b32 v239, s62, v211
    v_pk_mul_f32 v[64:65], v[64:65], v[224:225]
    v_pk_mul_f32 v[66:67], v[66:67], v[226:227]
    v_pk_mul_f32 v[68:69], v[68:69], v[228:229]
    v_pk_mul_f32 v[70:71], v[70:71], v[230:231]
    v_pk_mul_f32 v[72:73], v[72:73], v[232:233]
    v_pk_mul_f32 v[74:75], v[74:75], v[234:235]
    v_pk_mul_f32 v[76:77], v[76:77], v[236:237]
    v_pk_mul_f32 v[78:79], v[78:79], v[238:239]
    v_cvt_pk_bf16_f32 v192, v78, v76
    v_cvt_pk_bf16_f32 v193, v74, v72
    v_cvt_pk_bf16_f32 v194, v70, v68
    v_cvt_pk_bf16_f32 v195, v66, v64
    v_cvt_pk_bf16_f32 v196, v79, v77
    v_cvt_pk_bf16_f32 v197, v75, v73
    v_cvt_pk_bf16_f32 v198, v71, v69
    v_cvt_pk_bf16_f32 v199, v67, v65
    buffer_store_dwordx4 v[192:195], v249, s[16:19], 0 offen sc1
    buffer_store_dwordx4 v[196:199], v250, s[16:19], 0 offen sc1
    s_add_u32 s69, s69, 1
    s_cmp_lt_u32 s69, 32
    s_cbranch_scc1 USELF1
    s_waitcnt vmcnt(0)
    buffer_load_dwordx4 v[80:83], v0, s[16:19], s57 offen offset:0 sc1
    buffer_load_dwordx4 v[84:87], v0, s[16:19], s57 offen offset:1024 sc1
    s_waitcnt vmcnt(0)
    s_branch UOK
K_END:
    s_endpgm
K_CEND:
.section .rodata,"a"
.p2align 6
.amdhsa_kernel concat_heads__grouped_kv_mqa__ssm_conv_h3__prompt_kernel
  .amdhsa_next_free_vgpr 256
  .amdhsa_next_free_sgpr 102
  .amdhsa_accum_offset 256
  .amdhsa_group_segment_fixed_size 0
  .amdhsa_kernarg_size 112
  .amdhsa_user_sgpr_count 2
  .amdhsa_user_sgpr_kernarg_segment_ptr 1
  .amdhsa_system_sgpr_workgroup_id_x 1
.end_amdhsa_kernel
```
